```python
import torch

def _softmax(x, axis=-1):
    return torch.softmax(x, dim=axis)
def _gelu(x):
    return torch.nn.functional.gelu(x, approximate="tanh")
def _silu(x):
    return torch.nn.functional.silu(x)
def _sigmoid(x):
    return torch.sigmoid(x)
def _layernorm(x, axis=-1, eps=1e-5):
    m = x.mean(dim=axis, keepdim=True)
    v = x.var(dim=axis, keepdim=True, unbiased=False)
    return (x - m) / torch.sqrt(v + eps)
def _scatter_add(tgt, idx, src, axis=0):
    return tgt.clone().index_add_(axis, idx, src)
def _segment_sum(src, seg, n):
    out = torch.zeros((n,) + src.shape[1:], dtype=src.dtype)
    return out.index_add_(0, seg, src)
def _pad(x, pw):
    flat = tuple(v for pair in reversed(pw) for v in pair)
    return torch.nn.functional.pad(x, flat)

kernel_name = 'sequential_preLN__grouped_kv_mqa__mixer_s_mlp__prompt'

def setup_inputs():

    _w = (lambda a: (lambda t: t.to(torch.bfloat16) if t.is_floating_point() else t)(torch.as_tensor(a)))
    def _A_setup():
        B, S, D, H = 1, 2048, 512, 32
        Dh = D // H
        return {
            "x": _w((lambda *s: torch.randn(*s, dtype=torch.bfloat16) * 0.05)(B, S, D)),
            "wq": _w((lambda *s: torch.randn(*s, dtype=torch.bfloat16) * 0.05)(D, H * Dh)),
            "wk": _w((lambda *s: torch.randn(*s, dtype=torch.bfloat16) * 0.05)(D, Dh)),
            "wv": _w((lambda *s: torch.randn(*s, dtype=torch.bfloat16) * 0.05)(D, Dh)),
            "wo": _w((lambda *s: torch.randn(*s, dtype=torch.bfloat16) * 0.05)(H * Dh, D)),
        }
    _A_in = _A_setup()

    def _B_setup():
        B, S, D, F = 1, 2048, 512, 1792
        return {
            "x":  _w((lambda *s: torch.randn(*s, dtype=torch.bfloat16) * 0.05)(B, S, D)),
            "w1": _w((lambda *s: torch.randn(*s, dtype=torch.bfloat16) * 3.2)(D, D) * (D ** -0.5)),
            "w2": _w((lambda *s: torch.randn(*s, dtype=torch.bfloat16) * 3.2)(D, D) * (D ** -0.5)),
            "w3": _w((lambda *s: torch.randn(*s, dtype=torch.bfloat16) * 3.2)(D, F) * (D ** -0.5)),
            "w4": _w((lambda *s: torch.randn(*s, dtype=torch.bfloat16) * 1.6)(F, D) * (F ** -0.5)),
        }
    _B_in = _B_setup()

    return {
        "A_x": _A_in["x"],
        "A_wq": _A_in["wq"],
        "A_wk": _A_in["wk"],
        "A_wv": _A_in["wv"],
        "A_wo": _A_in["wo"],
        "B_x": _B_in["x"],
        "B_w1": _B_in["w1"],
        "B_w2": _B_in["w2"],
        "B_w3": _B_in["w3"],
        "B_w4": _B_in["w4"],
    }

def reference(A_x, A_wq, A_wk, A_wv, A_wo, B_x, B_w1, B_w2, B_w3, B_w4):
    def _A_ref(x, wq, wk, wv, wo):
        B, S, D = x.shape
        H = 32
        Dh = D // H
        q = (lambda x, *d: x.permute(*d))((x @ wq).reshape(B, S, H, Dh), 0, 2, 1, 3)
        k = x @ wk
        v = x @ wv
        scores = torch.einsum("bhqd,bkd->bhqk", q, k) * (Dh ** -0.5)
        p = _softmax(scores, axis=-1)
        o = torch.einsum("bhqk,bkd->bhqd", p, v)
        return (lambda x, *d: x.permute(*d))(o, 0, 2, 1, 3).reshape(B, S, H * Dh) @ wo

    def _B_ref(x, w1, w2, w3, w4):
        B, S, D = x.shape
        h = _gelu(_layernorm(x, axis=-1) @ w1)
        c = D // 4
        g0 = _pad(h[:, :, 0*c:1*c], ((0, 0), (1, 0), (0, 0)))[:, :S, :]
        g1 = _pad(h[:, :, 1*c:2*c], ((0, 0), (0, 1), (0, 0)))[:, 1:, :]
        g2 = _pad(h[:, :, 2*c:3*c], ((0, 0), (2, 0), (0, 0)))[:, :S, :]
        g3 = _pad(h[:, :, 3*c:   ], ((0, 0), (0, 2), (0, 0)))[:, 2:, :]
        hs = torch.concatenate([g0, g1, g2, g3], axis=-1) @ w2
        x1 = x + hs
        h2 = _gelu(_layernorm(x1, axis=-1) @ w3) @ w4
        return x1 + h2

    x = A_x
    h = x + _A_ref(_layernorm(x, axis=-1), A_wq, A_wk, A_wv, A_wo)
    h2 = h + _B_ref(_layernorm(h, axis=-1), B_w1, B_w2, B_w3, B_w4)
    return h2
```

```asm
; @launch grid=(256,1,1) block=(512,1,1) lds=163840
.amdgcn_target "amdgcn-amd-amdhsa--gfx950"
.text
.globl sequential_preLN__grouped_kv_mqa__mixer_s_mlp__prompt_kernel
.p2align 12
.type sequential_preLN__grouped_kv_mqa__mixer_s_mlp__prompt_kernel,@function
sequential_preLN__grouped_kv_mqa__mixer_s_mlp__prompt_kernel:
main_kernel:
    s_cmp_ge_u32 s2, 256
    s_cbranch_scc1 main_exit
    s_load_dwordx2 s[4:5], s[0:1], 96
    s_load_dwordx2 s[8:9], s[0:1], 0
    s_load_dwordx2 s[12:13], s[0:1], 80
    s_load_dwordx2 s[56:57], s[0:1], 8
    s_load_dwordx4 s[32:35], s[0:1], 16
    s_load_dwordx2 s[46:47], s[0:1], 32
    s_load_dwordx8 s[48:55], s[0:1], 48
    v_lshrrev_b32 v1, 6, v0
    v_and_b32 v0, 63, v0
    v_readfirstlane_b32 s44, v1
    s_and_b32 s20, s2, 7
    s_lshr_b32 s21, s2, 3
    s_lshl_b32 s16, s20, 2
    s_lshr_b32 s22, s21, 3
    s_add_u32 s16, s16, s22
    s_and_b32 s17, s21, 7
    s_and_b32 s3, s44, 3
    s_mul_i32 s31, s16, 0x50000
    s_lshl_b32 s38, s17, 2
    s_add_u32 s38, s38, s3
    v_lshlrev_b32 v1, 4, v0
    s_getpc_b64 s[42:43]
L_pc0:
    s_sub_u32 s42, s42, L_pc0-main_kernel
    s_subb_u32 s43, s43, 0
    s_lshl_b32 s21, s21, 3
    s_add_u32 s21, s21, s44
    s_lshl_b32 s21, s21, 8
    v_and_b32 v9, 1, v0
    v_lshlrev_b32 v9, 7, v9
    v_add_u32 v9, s21, v9
    v_min_u32 v9, main_end-main_kernel-4, v9
    global_load_dword v255, v9, s[42:43]
    s_mov_b32 s6, 0x1a40000
    s_mov_b32 s7, 0x20000
    v_lshrrev_b32 v8, 3, v0
    s_mov_b32 s10, 0x200000
    s_mov_b32 s11, 0x20000
    s_mov_b32 s59, 0x20000
    s_cmp_ge_u32 s44, 4
    s_cbranch_scc1 H_entry
    v_bfe_u32 v9, v0, 4, 1
    s_and_b32 s20, s3, 1
    s_lshl_b32 s20, s20, 1
    v_or_b32 v9, s20, v9
    v_bfe_u32 v10, v0, 1, 2
    v_xor_b32 v9, v9, v10
    v_lshlrev_b32 v9, 5, v9
    v_and_b32 v10, 1, v0
    v_lshl_add_u32 v9, v10, 4, v9
    v_lshl_add_u32 v134, v8, 10, v9
    s_mov_b32 s58, 0x80000
    s_lshl_b32 s26, s3, 13
    s_lshl_b32 s20, s17, 7
    s_add_u32 s26, s26, s20
    s_lshl_b32 s27, s3, 10
    s_add_u32 s27, s27, 98304
    s_waitcnt lgkmcnt(0)
    s_and_b32 s57, s57, 0xffff
L_wq:
    s_mov_b32 m0, s27
    s_add_u32 s27, s27, 4096
    buffer_load_dwordx4 v134, s[56:59], s26 offen lds
    s_add_u32 s26, s26, 32768
    s_cmp_lt_u32 s27, 163840
    s_cbranch_scc1 L_wq
    s_branch C_entry
H_entry:
    s_setprio 3
    v_and_b32 v9, 7, v0
    v_xor_b32 v9, v9, v8
    v_lshlrev_b32 v9, 4, v9
    v_lshl_add_u32 v19, v8, 10, v9
    s_lshl_b32 s28, s16, 16
    s_lshl_b32 s20, s3, 14
    s_add_u32 s28, s28, s20
    s_lshl_b32 s27, s3, 11
    s_add_u32 s27, s27, 32768
    s_lshr_b32 s40, s17, 1
    s_mov_b32 s58, 16384
    v_mov_b32 v7, 0
    s_bitcmp1_b32 s17, 0
    s_waitcnt lgkmcnt(0)
    s_cselect_b64 s[56:57], s[34:35], s[32:33]
    s_and_b32 s5, s5, 0xffff
    s_and_b32 s9, s9, 0xffff
    s_and_b32 s13, s13, 0xffff
    s_and_b32 s57, s57, 0xffff
    s_mov_b32 s20, 0x19af000
    buffer_load_dword v47, v7, s[4:7], s20 offen sc1
    s_cmp_lg_u32 s40, s3
    s_cbranch_scc1 L_nokv1_3
    s_mov_b32 s20, 0
L_wk:
    s_mov_b32 m0, s20
    s_nop 0
    buffer_load_dwordx4 v1, s[56:59], s20 offen offset:0 lds
    buffer_load_dwordx4 v1, s[56:59], s20 offen offset:1024 lds
    buffer_load_dwordx4 v1, s[56:59], s20 offen offset:2048 lds
    buffer_load_dwordx4 v1, s[56:59], s20 offen offset:3072 lds
    s_add_u32 s20, s20, 4096
    s_cmp_lt_u32 s20, 16384
    s_cbranch_scc1 L_wk
L_nokv1_3:
    s_mov_b32 s21, s17
    s_add_u32 s22, s17, 8
L_x:
    s_and_b32 s20, s21, 7
    s_lshl_b32 s26, s20, 7
    s_add_u32 s26, s26, s28
    s_lshl_b32 s20, s20, 13
    s_add_u32 m0, s20, s27
    s_add_u32 s21, s21, 1
    buffer_load_dwordx4 v19, s[8:11], s26 offen lds
    s_add_u32 s26, s26, 7168
    s_cmp_lt_u32 s21, s22
    buffer_load_dwordx4 v19, s[8:11], s26 offen offset:1024 lds
    s_cbranch_scc1 L_x
    s_mov_b32 s14, 0x200000
    s_mov_b32 s15, 0x20000
    s_getreg_b32 s45, hwreg(HW_REG_XCC_ID, 0, 3)
    v_and_b32 v16, 15, v0
    v_lshrrev_b32 v17, 4, v0
    v_lshlrev_b32 v2, 10, v17
    v_lshl_add_u32 v2, v16, 4, v2
    v_add_u32 v2, 65536, v2
    v_lshrrev_b32 v3, 1, v17
    v_lshlrev_b32 v3, 10, v3
    v_lshl_add_u32 v3, v16, 4, v3
    v_and_b32 v18, 1, v17
    v_lshl_add_u32 v3, v18, 3, v3
    s_lshl_b32 s20, s38, 2
    v_mov_b32 v4, s20
    s_lshl_b32 s30, s16, 8
    s_add_u32 s30, s30, 0x19a0000
    v_lshlrev_b32 v18, 10, v16
    v_lshl_add_u32 v5, v17, 3, v18
    s_and_b32 s39, s3, 1
    s_lshl_b32 s39, s39, 8
    v_lshrrev_b32 v42, 4, v0
    v_and_b32 v43, 7, v0
    v_xor_b32 v43, v43, v42
    v_lshlrev_b32 v43, 4, v43
    v_lshl_add_u32 v40, v16, 7, v43
    v_add_u32 v40, 32768, v40
    s_lshl_b32 s20, s3, 11
    v_add_u32 v40, s20, v40
    v_xor_b32 v41, 64, v40
    v_mov_b32 v60, 0x3f803f80
    v_mov_b32 v61, 0x3f803f80
    v_mov_b32 v62, 0x3f803f80
    v_mov_b32 v63, 0x3f803f80
    s_cmp_lg_u32 s40, s3
    s_cbranch_scc1 L_noinit_4
    v_mov_b32 v48, 0
    v_mov_b32 v49, 0
    v_mov_b32 v50, 0
    v_mov_b32 v51, 0
    v_lshrrev_b32 v52, 1, v0
    v_lshlrev_b32 v52, 13, v52
    v_and_b32 v53, 1, v0
    v_lshl_add_u32 v52, v53, 4, v52
    s_lshl_b32 s20, s17, 5
    s_add_u32 s20, s20, s30
    s_mov_b64 exec, 0x3fff
    buffer_store_dwordx4 v[48:51], v52, s[4:7], s20 offen sc1
    s_lshl_b32 s20, s2, 7
    s_add_u32 s20, s20, 0x19b0000
    s_mov_b64 exec, 1
    buffer_store_dword v48, v7, s[4:7], s20 offen sc1
    s_mov_b64 exec, -1
    v_mov_b32 v52, -1
    v_mov_b32 v53, -1
    v_mov_b32 v54, -1
    v_mov_b32 v55, -1
    s_lshl_b32 s20, s17, 10
    s_add_u32 s20, s20, s31
    s_add_u32 s20, s20, 0x49000
    buffer_store_dwordx4 v[52:55], v1, s[4:7], s20 offen sc1
    s_bfe_u32 s21, s17, 0x10001
    s_mul_i32 s21, s21, 31
    s_cmp_eq_u32 s21, s16
    s_cselect_b32 s21, 0, -1
    v_mov_b32 v56, s21
    v_mov_b32 v57, s21
    v_mov_b32 v58, s21
    v_mov_b32 v59, s21
    s_lshl_b32 s20, s17, 8
    s_add_u32 s20, s20, s31
    s_add_u32 s20, s20, 0x48000
    s_mov_b64 exec, 0xffff
    buffer_store_dwordx4 v[56:59], v1, s[4:7], s20 offen sc1
    s_mov_b64 exec, -1
    v_bfe_u32 v42, v0, 2, 2
    v_lshl_add_u32 v42, v17, 3, v42
    v_lshlrev_b32 v42, 5, v42
    v_and_b32 v43, 3, v0
    v_lshl_add_u32 v42, v43, 3, v42
    s_waitcnt vmcnt(20)
    ds_read_b64_tr_b16 v[128:129], v42 offset:0
    ds_read_b64_tr_b16 v[130:131], v42 offset:128
    ds_read_b64_tr_b16 v[132:133], v42 offset:1024
    ds_read_b64_tr_b16 v[134:135], v42 offset:1152
    ds_read_b64_tr_b16 v[136:137], v42 offset:2048
    ds_read_b64_tr_b16 v[138:139], v42 offset:2176
    ds_read_b64_tr_b16 v[140:141], v42 offset:3072
    ds_read_b64_tr_b16 v[142:143], v42 offset:3200
    ds_read_b64_tr_b16 v[144:145], v42 offset:4096
    ds_read_b64_tr_b16 v[146:147], v42 offset:4224
    ds_read_b64_tr_b16 v[148:149], v42 offset:5120
    ds_read_b64_tr_b16 v[150:151], v42 offset:5248
    ds_read_b64_tr_b16 v[152:153], v42 offset:6144
    ds_read_b64_tr_b16 v[154:155], v42 offset:6272
    ds_read_b64_tr_b16 v[156:157], v42 offset:7168
    ds_read_b64_tr_b16 v[158:159], v42 offset:7296
    ds_read_b64_tr_b16 v[160:161], v42 offset:8192
    ds_read_b64_tr_b16 v[162:163], v42 offset:8320
    ds_read_b64_tr_b16 v[164:165], v42 offset:9216
    ds_read_b64_tr_b16 v[166:167], v42 offset:9344
    ds_read_b64_tr_b16 v[168:169], v42 offset:10240
    ds_read_b64_tr_b16 v[170:171], v42 offset:10368
    ds_read_b64_tr_b16 v[172:173], v42 offset:11264
    ds_read_b64_tr_b16 v[174:175], v42 offset:11392
    ds_read_b64_tr_b16 v[176:177], v42 offset:12288
    ds_read_b64_tr_b16 v[178:179], v42 offset:12416
    ds_read_b64_tr_b16 v[180:181], v42 offset:13312
    ds_read_b64_tr_b16 v[182:183], v42 offset:13440
    ds_read_b64_tr_b16 v[184:185], v42 offset:14336
    ds_read_b64_tr_b16 v[186:187], v42 offset:14464
    ds_read_b64_tr_b16 v[188:189], v42 offset:15360
    ds_read_b64_tr_b16 v[190:191], v42 offset:15488
    s_waitcnt lgkmcnt(0)
    v_mfma_f32_16x16x32_bf16 v[192:195], v[128:131], v[60:63], 0
    v_mfma_f32_16x16x32_bf16 v[196:199], v[60:63], v[128:131], 0
    v_mfma_f32_16x16x32_bf16 v[192:195], v[132:135], v[60:63], v[192:195]
    v_mfma_f32_16x16x32_bf16 v[196:199], v[60:63], v[132:135], v[196:199]
    v_mfma_f32_16x16x32_bf16 v[192:195], v[136:139], v[60:63], v[192:195]
    v_mfma_f32_16x16x32_bf16 v[196:199], v[60:63], v[136:139], v[196:199]
    v_mfma_f32_16x16x32_bf16 v[192:195], v[140:143], v[60:63], v[192:195]
    v_mfma_f32_16x16x32_bf16 v[196:199], v[60:63], v[140:143], v[196:199]
    v_mfma_f32_16x16x32_bf16 v[192:195], v[144:147], v[60:63], v[192:195]
    v_mfma_f32_16x16x32_bf16 v[196:199], v[60:63], v[144:147], v[196:199]
    v_mfma_f32_16x16x32_bf16 v[192:195], v[148:151], v[60:63], v[192:195]
    v_mfma_f32_16x16x32_bf16 v[196:199], v[60:63], v[148:151], v[196:199]
    v_mfma_f32_16x16x32_bf16 v[192:195], v[152:155], v[60:63], v[192:195]
    v_mfma_f32_16x16x32_bf16 v[196:199], v[60:63], v[152:155], v[196:199]
    v_mfma_f32_16x16x32_bf16 v[192:195], v[156:159], v[60:63], v[192:195]
    v_mfma_f32_16x16x32_bf16 v[196:199], v[60:63], v[156:159], v[196:199]
    v_mfma_f32_16x16x32_bf16 v[192:195], v[160:163], v[60:63], v[192:195]
    v_mfma_f32_16x16x32_bf16 v[196:199], v[60:63], v[160:163], v[196:199]
    v_mfma_f32_16x16x32_bf16 v[192:195], v[164:167], v[60:63], v[192:195]
    v_mfma_f32_16x16x32_bf16 v[196:199], v[60:63], v[164:167], v[196:199]
    v_mfma_f32_16x16x32_bf16 v[192:195], v[168:171], v[60:63], v[192:195]
    v_mfma_f32_16x16x32_bf16 v[196:199], v[60:63], v[168:171], v[196:199]
    v_mfma_f32_16x16x32_bf16 v[192:195], v[172:175], v[60:63], v[192:195]
    v_mfma_f32_16x16x32_bf16 v[196:199], v[60:63], v[172:175], v[196:199]
    v_mfma_f32_16x16x32_bf16 v[192:195], v[176:179], v[60:63], v[192:195]
    v_mfma_f32_16x16x32_bf16 v[196:199], v[60:63], v[176:179], v[196:199]
    v_mfma_f32_16x16x32_bf16 v[192:195], v[180:183], v[60:63], v[192:195]
    v_mfma_f32_16x16x32_bf16 v[196:199], v[60:63], v[180:183], v[196:199]
    v_mfma_f32_16x16x32_bf16 v[192:195], v[184:187], v[60:63], v[192:195]
    v_mfma_f32_16x16x32_bf16 v[196:199], v[60:63], v[184:187], v[196:199]
    v_mfma_f32_16x16x32_bf16 v[192:195], v[188:191], v[60:63], v[192:195]
    v_mfma_f32_16x16x32_bf16 v[196:199], v[60:63], v[188:191], v[196:199]
    s_waitcnt vmcnt(4)
    s_branch L_initd_5
L_noinit_4:
    s_waitcnt vmcnt(0)
L_initd_5:
    ds_read_b128 v[64:67], v40 offset:0
    ds_read_b128 v[68:71], v41 offset:0
    ds_read_b128 v[72:75], v40 offset:8192
    ds_read_b128 v[76:79], v41 offset:8192
    ds_read_b128 v[80:83], v40 offset:16384
    ds_read_b128 v[84:87], v41 offset:16384
    ds_read_b128 v[88:91], v40 offset:24576
    ds_read_b128 v[92:95], v41 offset:24576
    ds_read_b128 v[96:99], v40 offset:32768
    ds_read_b128 v[100:103], v41 offset:32768
    ds_read_b128 v[104:107], v40 offset:40960
    ds_read_b128 v[108:111], v41 offset:40960
    ds_read_b128 v[112:115], v40 offset:49152
    ds_read_b128 v[116:119], v41 offset:49152
    ds_read_b128 v[120:123], v40 offset:57344
    ds_read_b128 v[124:127], v41 offset:57344
    s_bitcmp1_b32 s17, 0
    s_cbranch_scc1 L_ori_6
    s_waitcnt lgkmcnt(14)
    v_mfma_f32_16x16x32_bf16 v[36:39], v[60:63], v[64:67], 0
    v_mfma_f32_16x16x32_bf16 v[32:35], v[64:67], v[64:67], 0
    v_mfma_f32_16x16x32_bf16 v[48:51], v[128:131], v[64:67], 0
    v_mfma_f32_16x16x32_bf16 v[36:39], v[60:63], v[68:71], v[36:39]
    v_mfma_f32_16x16x32_bf16 v[32:35], v[68:71], v[68:71], v[32:35]
    v_mfma_f32_16x16x32_bf16 v[48:51], v[132:135], v[68:71], v[48:51]
    s_waitcnt lgkmcnt(12)
    v_mfma_f32_16x16x32_bf16 v[36:39], v[60:63], v[72:75], v[36:39]
    v_mfma_f32_16x16x32_bf16 v[32:35], v[72:75], v[72:75], v[32:35]
    v_mfma_f32_16x16x32_bf16 v[48:51], v[136:139], v[72:75], v[48:51]
    v_mfma_f32_16x16x32_bf16 v[36:39], v[60:63], v[76:79], v[36:39]
    v_mfma_f32_16x16x32_bf16 v[32:35], v[76:79], v[76:79], v[32:35]
    v_mfma_f32_16x16x32_bf16 v[48:51], v[140:143], v[76:79], v[48:51]
    s_waitcnt lgkmcnt(10)
    v_mfma_f32_16x16x32_bf16 v[36:39], v[60:63], v[80:83], v[36:39]
    v_mfma_f32_16x16x32_bf16 v[32:35], v[80:83], v[80:83], v[32:35]
    v_mfma_f32_16x16x32_bf16 v[48:51], v[144:147], v[80:83], v[48:51]
    v_mfma_f32_16x16x32_bf16 v[36:39], v[60:63], v[84:87], v[36:39]
    v_mfma_f32_16x16x32_bf16 v[32:35], v[84:87], v[84:87], v[32:35]
    v_mfma_f32_16x16x32_bf16 v[48:51], v[148:151], v[84:87], v[48:51]
    s_waitcnt lgkmcnt(8)
    v_mfma_f32_16x16x32_bf16 v[36:39], v[60:63], v[88:91], v[36:39]
    v_mfma_f32_16x16x32_bf16 v[32:35], v[88:91], v[88:91], v[32:35]
    v_mfma_f32_16x16x32_bf16 v[48:51], v[152:155], v[88:91], v[48:51]
    v_mfma_f32_16x16x32_bf16 v[36:39], v[60:63], v[92:95], v[36:39]
    v_mfma_f32_16x16x32_bf16 v[32:35], v[92:95], v[92:95], v[32:35]
    v_mfma_f32_16x16x32_bf16 v[48:51], v[156:159], v[92:95], v[48:51]
    s_waitcnt lgkmcnt(6)
    v_mfma_f32_16x16x32_bf16 v[36:39], v[60:63], v[96:99], v[36:39]
    v_mfma_f32_16x16x32_bf16 v[32:35], v[96:99], v[96:99], v[32:35]
    v_mfma_f32_16x16x32_bf16 v[48:51], v[160:163], v[96:99], v[48:51]
    v_mfma_f32_16x16x32_bf16 v[36:39], v[60:63], v[100:103], v[36:39]
    v_mfma_f32_16x16x32_bf16 v[32:35], v[100:103], v[100:103], v[32:35]
    v_mfma_f32_16x16x32_bf16 v[48:51], v[164:167], v[100:103], v[48:51]
    s_waitcnt lgkmcnt(4)
    v_mfma_f32_16x16x32_bf16 v[36:39], v[60:63], v[104:107], v[36:39]
    v_mfma_f32_16x16x32_bf16 v[32:35], v[104:107], v[104:107], v[32:35]
    v_mfma_f32_16x16x32_bf16 v[48:51], v[168:171], v[104:107], v[48:51]
    v_mfma_f32_16x16x32_bf16 v[36:39], v[60:63], v[108:111], v[36:39]
    v_mfma_f32_16x16x32_bf16 v[32:35], v[108:111], v[108:111], v[32:35]
    v_mfma_f32_16x16x32_bf16 v[48:51], v[172:175], v[108:111], v[48:51]
    s_waitcnt lgkmcnt(2)
    v_mfma_f32_16x16x32_bf16 v[36:39], v[60:63], v[112:115], v[36:39]
    v_mfma_f32_16x16x32_bf16 v[32:35], v[112:115], v[112:115], v[32:35]
    v_mfma_f32_16x16x32_bf16 v[48:51], v[176:179], v[112:115], v[48:51]
    v_mfma_f32_16x16x32_bf16 v[36:39], v[60:63], v[116:119], v[36:39]
    v_mfma_f32_16x16x32_bf16 v[32:35], v[116:119], v[116:119], v[32:35]
    v_mfma_f32_16x16x32_bf16 v[48:51], v[180:183], v[116:119], v[48:51]
    s_waitcnt lgkmcnt(0)
    v_mfma_f32_16x16x32_bf16 v[36:39], v[60:63], v[120:123], v[36:39]
    v_mfma_f32_16x16x32_bf16 v[32:35], v[120:123], v[120:123], v[32:35]
    v_mfma_f32_16x16x32_bf16 v[48:51], v[184:187], v[120:123], v[48:51]
    v_mfma_f32_16x16x32_bf16 v[36:39], v[60:63], v[124:127], v[36:39]
    v_mfma_f32_16x16x32_bf16 v[32:35], v[124:127], v[124:127], v[32:35]
    v_mfma_f32_16x16x32_bf16 v[48:51], v[188:191], v[124:127], v[48:51]
    s_branch L_orj_7
L_ori_6:
    s_waitcnt lgkmcnt(14)
    s_nop 3
    v_mfma_f32_16x16x32_bf16 v[36:39], v[60:63], v[64:67], 0
    v_mfma_f32_16x16x32_bf16 v[32:35], v[64:67], v[64:67], 0
    v_mfma_f32_16x16x32_bf16 v[48:51], v[64:67], v[128:131], 0
    v_mfma_f32_16x16x32_bf16 v[36:39], v[60:63], v[68:71], v[36:39]
    v_mfma_f32_16x16x32_bf16 v[32:35], v[68:71], v[68:71], v[32:35]
    v_mfma_f32_16x16x32_bf16 v[48:51], v[68:71], v[132:135], v[48:51]
    s_waitcnt lgkmcnt(12)
    v_mfma_f32_16x16x32_bf16 v[36:39], v[60:63], v[72:75], v[36:39]
    v_mfma_f32_16x16x32_bf16 v[32:35], v[72:75], v[72:75], v[32:35]
    v_mfma_f32_16x16x32_bf16 v[48:51], v[72:75], v[136:139], v[48:51]
    v_mfma_f32_16x16x32_bf16 v[36:39], v[60:63], v[76:79], v[36:39]
    v_mfma_f32_16x16x32_bf16 v[32:35], v[76:79], v[76:79], v[32:35]
    v_mfma_f32_16x16x32_bf16 v[48:51], v[76:79], v[140:143], v[48:51]
    s_waitcnt lgkmcnt(10)
    v_mfma_f32_16x16x32_bf16 v[36:39], v[60:63], v[80:83], v[36:39]
    v_mfma_f32_16x16x32_bf16 v[32:35], v[80:83], v[80:83], v[32:35]
    v_mfma_f32_16x16x32_bf16 v[48:51], v[80:83], v[144:147], v[48:51]
    v_mfma_f32_16x16x32_bf16 v[36:39], v[60:63], v[84:87], v[36:39]
    v_mfma_f32_16x16x32_bf16 v[32:35], v[84:87], v[84:87], v[32:35]
    v_mfma_f32_16x16x32_bf16 v[48:51], v[84:87], v[148:151], v[48:51]
    s_waitcnt lgkmcnt(8)
    v_mfma_f32_16x16x32_bf16 v[36:39], v[60:63], v[88:91], v[36:39]
    v_mfma_f32_16x16x32_bf16 v[32:35], v[88:91], v[88:91], v[32:35]
    v_mfma_f32_16x16x32_bf16 v[48:51], v[88:91], v[152:155], v[48:51]
    v_mfma_f32_16x16x32_bf16 v[36:39], v[60:63], v[92:95], v[36:39]
    v_mfma_f32_16x16x32_bf16 v[32:35], v[92:95], v[92:95], v[32:35]
    v_mfma_f32_16x16x32_bf16 v[48:51], v[92:95], v[156:159], v[48:51]
    s_waitcnt lgkmcnt(6)
    v_mfma_f32_16x16x32_bf16 v[36:39], v[60:63], v[96:99], v[36:39]
    v_mfma_f32_16x16x32_bf16 v[32:35], v[96:99], v[96:99], v[32:35]
    v_mfma_f32_16x16x32_bf16 v[48:51], v[96:99], v[160:163], v[48:51]
    v_mfma_f32_16x16x32_bf16 v[36:39], v[60:63], v[100:103], v[36:39]
    v_mfma_f32_16x16x32_bf16 v[32:35], v[100:103], v[100:103], v[32:35]
    v_mfma_f32_16x16x32_bf16 v[48:51], v[100:103], v[164:167], v[48:51]
    s_waitcnt lgkmcnt(4)
    v_mfma_f32_16x16x32_bf16 v[36:39], v[60:63], v[104:107], v[36:39]
    v_mfma_f32_16x16x32_bf16 v[32:35], v[104:107], v[104:107], v[32:35]
    v_mfma_f32_16x16x32_bf16 v[48:51], v[104:107], v[168:171], v[48:51]
    v_mfma_f32_16x16x32_bf16 v[36:39], v[60:63], v[108:111], v[36:39]
    v_mfma_f32_16x16x32_bf16 v[32:35], v[108:111], v[108:111], v[32:35]
    v_mfma_f32_16x16x32_bf16 v[48:51], v[108:111], v[172:175], v[48:51]
    s_waitcnt lgkmcnt(2)
    v_mfma_f32_16x16x32_bf16 v[36:39], v[60:63], v[112:115], v[36:39]
    v_mfma_f32_16x16x32_bf16 v[32:35], v[112:115], v[112:115], v[32:35]
    v_mfma_f32_16x16x32_bf16 v[48:51], v[112:115], v[176:179], v[48:51]
    v_mfma_f32_16x16x32_bf16 v[36:39], v[60:63], v[116:119], v[36:39]
    v_mfma_f32_16x16x32_bf16 v[32:35], v[116:119], v[116:119], v[32:35]
    v_mfma_f32_16x16x32_bf16 v[48:51], v[116:119], v[180:183], v[48:51]
    s_waitcnt lgkmcnt(0)
    v_mfma_f32_16x16x32_bf16 v[36:39], v[60:63], v[120:123], v[36:39]
    v_mfma_f32_16x16x32_bf16 v[32:35], v[120:123], v[120:123], v[32:35]
    v_mfma_f32_16x16x32_bf16 v[48:51], v[120:123], v[184:187], v[48:51]
    v_mfma_f32_16x16x32_bf16 v[36:39], v[60:63], v[124:127], v[36:39]
    v_mfma_f32_16x16x32_bf16 v[32:35], v[124:127], v[124:127], v[32:35]
    v_mfma_f32_16x16x32_bf16 v[48:51], v[124:127], v[188:191], v[48:51]
L_orj_7:
    v_mov_b32 v45, 0
    s_mov_b32 vcc_lo, 0x100001
    s_mov_b32 vcc_hi, 0x10000100
    s_nop 3
    v_cndmask_b32 v45, v45, v32, vcc
    s_mov_b32 vcc_lo, 0x200002
    s_mov_b32 vcc_hi, 0x20000200
    v_cndmask_b32 v45, v45, v33, vcc
    s_mov_b32 vcc_lo, 0x400004
    s_mov_b32 vcc_hi, 0x40000400
    v_cndmask_b32 v45, v45, v34, vcc
    s_mov_b32 vcc_lo, 0x800008
    s_mov_b32 vcc_hi, 0x80000800
    v_cndmask_b32 v45, v45, v35, vcc
    v_mov_b32 v44, v45
    s_nop 1
    v_permlane32_swap_b32 v44, v45
    v_add_f32 v45, v44, v45
    v_mov_b32 v44, v45
    s_nop 1
    v_permlane16_swap_b32 v44, v45
    v_add_f32 v45, v44, v45
    v_mul_f32 v44, 0x3b000000, v36
    v_mul_f32 v45, 0x3b000000, v45
    v_fma_f32 v45, -v44, v44, v45
    v_max_f32 v45, 0, v45
    v_add_f32 v45, 0x3727c5ac, v45
    v_rsq_f32 v45, v45
    s_lshl_b32 s20, s3, 7
    v_lshl_add_u32 v46, v16, 3, s20
    ds_write_b64 v46, v[44:45] offset:16384
    v_readfirstlane_b32 s41, v47
    s_nop 0
    s_add_u32 s41, s41, 1
    s_waitcnt lgkmcnt(0)
    s_cmp_lg_u32 s40, s3
    s_cbranch_scc1 L_nokv3_8
    s_lshl_b32 s21, s16, 1
    s_lshr_b32 s22, s3, 1
    s_add_u32 s21, s21, s22
    s_lshl_b32 s21, s21, 11
    s_add_u32 s21, s21, 0x1980000
    v_lshrrev_b32 v42, 1, v17
    v_and_b32 v43, 0xff, v3
    s_bitcmp1_b32 s17, 0
    s_cbranch_scc1 L_isv_9
    s_add_u32 s21, s21, s39
    v_lshl_add_u32 v43, v42, 9, v43
    v_fma_f32 v48, -v44, v192, v48
    v_fma_f32 v49, -v44, v193, v49
    v_fma_f32 v50, -v44, v194, v50
    v_fma_f32 v51, -v44, v195, v51
    v_mul_f32 v48, v48, v45
    v_mul_f32 v49, v49, v45
    v_mul_f32 v50, v50, v45
    v_mul_f32 v51, v51, v45
    v_cvt_pk_bf16_f32 v52, v48, v49
    v_cvt_pk_bf16_f32 v53, v50, v51
    v_mov_b32 v57, 0
    buffer_store_dwordx2 v[52:53], v43, s[4:7], s21 offen sc1
    v_dot2_f32_bf16 v57, v52, v52, v57
    v_dot2_f32_bf16 v57, v53, v53, v57
    s_nop 2
    v_mov_b32 v58, v57
    s_nop 1
    v_permlane32_swap_b32 v57, v58
    v_add_f32 v57, v57, v58
    v_mov_b32 v58, v57
    s_nop 1
    v_permlane16_swap_b32 v57, v58
    v_add_f32 v57, v57, v58
    s_nop 1
    v_max_f32_dpp v57, v57, v57 row_ror:8 row_mask:0xf bank_mask:0xf
    s_nop 1
    v_max_f32_dpp v57, v57, v57 row_ror:4 row_mask:0xf bank_mask:0xf
    s_nop 1
    v_max_f32_dpp v57, v57, v57 row_ror:2 row_mask:0xf bank_mask:0xf
    s_nop 1
    v_max_f32_dpp v57, v57, v57 row_ror:1 row_mask:0xf bank_mask:0xf
    s_branch L_pub_10
L_isv_9:
    v_lshl_add_u32 v46, v17, 5, s20
    ds_read_b128 v[32:35], v46 offset:16384
    ds_read_b128 v[36:39], v46 offset:16400
    s_lshl_b32 s22, s39, 1
    s_add_u32 s21, s21, s22
    v_lshl_add_u32 v43, v42, 8, v43
    s_waitcnt lgkmcnt(0)
    v_fma_f32 v48, -v32, v196, v48
    v_fma_f32 v49, -v34, v197, v49
    v_fma_f32 v50, -v36, v198, v50
    v_fma_f32 v51, -v38, v199, v51
    v_mul_f32 v48, v48, v33
    v_mul_f32 v49, v49, v35
    v_mul_f32 v50, v50, v37
    v_mul_f32 v51, v51, v39
    v_cvt_pk_bf16_f32 v52, v48, v49
    v_cvt_pk_bf16_f32 v53, v50, v51
    v_mov_b32 v57, 0
    buffer_store_dwordx2 v[52:53], v43, s[4:7], s21 offen offset:1024 sc1
L_pub_10:
    v_mov_b32 v56, s41
    v_mov_b32 v58, s45
    v_mov_b32 v59, s41
    s_lshl_b32 s20, s16, 3
    s_add_u32 s20, s20, s17
    s_lshl_b32 s20, s20, 7
    s_add_u32 s20, s20, 0x19b8000
L_nokv3_8:
    s_barrier
    s_cmp_lg_u32 s40, s3
    s_cbranch_scc1 L_nokv4_11
    s_waitcnt vmcnt(0)
    s_mov_b64 exec, 1
    buffer_store_dwordx4 v[56:59], v7, s[4:7], s20 offen sc1
    s_mov_b64 exec, -1
L_nokv4_11:
    s_setprio 0
    v_lshrrev_b32 v209, 4, v0
    v_and_b32 v210, 0xff, v1
    v_lshl_add_u32 v204, v209, 14, v210
    v_lshrrev_b32 v207, 3, v0
    v_and_b32 v208, 0x7f, v1
    v_lshl_add_u32 v200, v207, 10, v208
    v_mul_u32_u24 v201, 3584, v207
    v_add_u32 v201, v201, v208
    s_mul_i32 s21, s2, 2341
    s_lshr_b32 s21, s21, 16
    s_mul_i32 s22, s21, 28
    s_sub_u32 s22, s2, s22
    s_lshl_b32 s23, s21, 2
    s_add_u32 s23, s23, s3
    s_mul_i32 s60, s23, 28672
    s_lshl_b32 s23, s22, 7
    s_add_u32 s60, s60, s23
    s_lshl_b32 s22, s22, 6
    s_add_u32 s22, s22, s21
    s_lshl_b32 s65, s22, 10
    s_lshl_b32 s23, s3, 8
    s_add_u32 s65, s65, s23
    s_add_u32 s65, s65, 0x1600000
    s_lshr_b32 s21, s2, 3
    s_and_b32 s22, s2, 7
    s_lshl_b32 s61, s21, 15
    s_lshl_b32 s23, s22, 7
    s_add_u32 s61, s61, s23
    s_lshl_b32 s23, s3, 13
    s_add_u32 s61, s61, s23
    s_mul_i32 s22, s22, 56
    s_add_u32 s22, s22, s21
    s_lshl_b32 s22, s22, 2
    s_mul_i32 s21, s21, 9363
    s_lshr_b32 s21, s21, 16
    v_subrev_u32 v205, s21, v209
    v_and_b32 v205, 3, v205
    v_lshl_add_u32 v205, v205, 10, v210
    s_lshl_b32 s66, s22, 10
    s_lshl_b32 s23, s3, 8
    s_add_u32 s66, s66, s23
    s_add_u32 s66, s66, 0x17c0000
    s_cmp_ge_u32 s2, 192
    s_cbranch_scc1 L_pwo_12
    s_add_u32 s20, s2, 256
    s_mul_i32 s21, s20, 2341
    s_lshr_b32 s21, s21, 16
    s_mul_i32 s22, s21, 28
    s_sub_u32 s22, s20, s22
    s_lshl_b32 s23, s21, 2
    s_add_u32 s23, s23, s3
    s_mul_i32 s62, s23, 28672
    s_lshl_b32 s23, s22, 7
    s_add_u32 s62, s62, s23
    s_lshl_b32 s22, s22, 6
    s_add_u32 s22, s22, s21
    s_lshl_b32 s67, s22, 10
    s_lshl_b32 s23, s3, 8
    s_add_u32 s67, s67, s23
    s_add_u32 s67, s67, 0x1600000
    s_lshr_b32 s21, s20, 3
    s_and_b32 s22, s20, 7
    s_lshl_b32 s63, s21, 15
    s_lshl_b32 s23, s22, 7
    s_add_u32 s63, s63, s23
    s_lshl_b32 s23, s3, 13
    s_add_u32 s63, s63, s23
    s_mul_i32 s22, s22, 56
    s_add_u32 s22, s22, s21
    s_lshl_b32 s22, s22, 2
    s_mul_i32 s21, s21, 9363
    s_lshr_b32 s21, s21, 16
    v_subrev_u32 v206, s21, v209
    v_and_b32 v206, 3, v206
    v_lshl_add_u32 v206, v206, 10, v210
    s_lshl_b32 s68, s22, 10
    s_lshl_b32 s23, s3, 8
    s_add_u32 s68, s68, s23
    s_add_u32 s68, s68, 0x17c0000
    v_mov_b32 v202, v201
    v_mov_b32 v203, v200
    s_branch L_pend_13
L_pwo_12:
    s_sub_u32 s20, s2, 192
    s_lshr_b32 s21, s20, 3
    s_and_b32 s22, s20, 7
    s_lshl_b32 s62, s21, 15
    s_lshl_b32 s23, s22, 7
    s_add_u32 s62, s62, s23
    s_lshl_b32 s22, s22, 6
    s_add_u32 s22, s22, s21
    s_lshl_b32 s67, s22, 10
    s_lshl_b32 s23, s3, 8
    s_add_u32 s67, s67, s23
    s_add_u32 s67, s67, 0x1480000
    s_sub_u32 s20, s2, 128
    s_lshr_b32 s21, s20, 3
    s_and_b32 s22, s20, 7
    s_lshl_b32 s63, s21, 15
    s_lshl_b32 s23, s22, 7
    s_add_u32 s63, s63, s23
    s_lshl_b32 s22, s22, 6
    s_add_u32 s22, s22, s21
    s_lshl_b32 s68, s22, 10
    s_lshl_b32 s23, s3, 8
    s_add_u32 s68, s68, s23
    s_add_u32 s68, s68, 0x1480000
    s_lshr_b32 s21, s3, 1
    s_lshl_b32 s21, s21, 4
    s_and_b32 s22, s3, 1
    s_lshl_b32 s22, s22, 2
    s_add_u32 s21, s21, s22
    v_and_b32 v202, 4, v207
    v_add3_u32 v202, v202, v207, s21
    v_lshl_add_u32 v202, v202, 10, v208
    v_mov_b32 v203, v202
    v_mov_b32 v206, v204
L_pend_13:
    s_and_b32 s20, s2, 127
    s_lshr_b32 s21, s20, 3
    s_and_b32 s22, s20, 7
    s_lshl_b32 s64, s21, 15
    s_lshl_b32 s23, s22, 7
    s_add_u32 s64, s64, s23
    s_lshl_b32 s23, s3, 13
    s_add_u32 s64, s64, s23
    s_lshl_b32 s22, s22, 6
    s_add_u32 s22, s22, s21
    s_lshl_b32 s69, s22, 10
    s_lshl_b32 s23, s3, 8
    s_add_u32 s69, s69, s23
    s_add_u32 s69, s69, 0x1500000
    s_lshr_b32 s20, s2, 7
    s_lshl_b32 s20, s20, 19
    s_add_u32 s69, s69, s20
    s_mul_i32 s20, s3, 5120
    s_add_u32 s20, s20, 131072
    v_add_u32 v207, s20, v1
    v_bfe_u32 v208, v0, 2, 2
    v_lshlrev_b32 v208, 7, v208
    v_lshl_add_u32 v208, v209, 5, v208
    v_and_b32 v209, 3, v0
    v_lshl_add_u32 v208, v209, 3, v208
    v_add_u32 v208, s20, v208
    v_lshlrev_b32 v18, 7, v0
    v_and_b32 v46, 0xfff, v18
    s_lshr_b32 s33, s16, 2
    s_cmp_lg_u32 s3, 0
    s_cbranch_scc1 L_nopoll_14
    s_lshl_b32 s20, s33, 12
    s_add_u32 s20, s20, 0x19b8000
    s_mov_b32 s29, 0
L_kp_15:
    buffer_load_dwordx4 v[48:51], v46, s[4:7], s20 offen sc1
    s_add_u32 s29, s29, 1
    s_cmp_gt_u32 s29, 262144
    s_cbranch_scc1 main_exit
    s_waitcnt vmcnt(0)
    v_cmp_ne_u32 vcc, s41, v48
    v_cmp_ne_u32 s[36:37], s41, v51
    s_nop 0
    s_or_b64 vcc, vcc, s[36:37]
    s_cbranch_vccnz L_kp_15
    s_lshl_b32 s43, s33, 14
    s_add_u32 s43, s43, 0x1980000
    s_mov_b32 m0, 0
    s_nop 0
    buffer_load_dwordx4 v1, s[4:7], s43 offen offset:0 sc1 lds
    buffer_load_dwordx4 v1, s[4:7], s43 offen offset:1024 sc1 lds
    buffer_load_dwordx4 v1, s[4:7], s43 offen offset:2048 sc1 lds
    buffer_load_dwordx4 v1, s[4:7], s43 offen offset:3072 sc1 lds
    s_add_u32 s43, s43, 4096
    s_mov_b32 m0, 4096
    s_nop 0
    buffer_load_dwordx4 v1, s[4:7], s43 offen offset:0 sc1 lds
    buffer_load_dwordx4 v1, s[4:7], s43 offen offset:1024 sc1 lds
    buffer_load_dwordx4 v1, s[4:7], s43 offen offset:2048 sc1 lds
    buffer_load_dwordx4 v1, s[4:7], s43 offen offset:3072 sc1 lds
    s_add_u32 s43, s43, 4096
    s_mov_b32 m0, 8192
    s_nop 0
    buffer_load_dwordx4 v1, s[4:7], s43 offen offset:0 sc1 lds
    buffer_load_dwordx4 v1, s[4:7], s43 offen offset:1024 sc1 lds
    buffer_load_dwordx4 v1, s[4:7], s43 offen offset:2048 sc1 lds
    buffer_load_dwordx4 v1, s[4:7], s43 offen offset:3072 sc1 lds
    s_add_u32 s43, s43, 4096
    s_mov_b32 m0, 12288
    s_nop 0
    buffer_load_dwordx4 v1, s[4:7], s43 offen offset:0 sc1 lds
    buffer_load_dwordx4 v1, s[4:7], s43 offen offset:1024 sc1 lds
    buffer_load_dwordx4 v1, s[4:7], s43 offen offset:2048 sc1 lds
    buffer_load_dwordx4 v1, s[4:7], s43 offen offset:3072 sc1 lds
    s_add_u32 s43, s43, 4096
    s_and_b32 s20, s16, 3
    s_lshl_b32 s20, s20, 3
    s_lshl_b32 s20, 0xff, s20
    v_cmp_ne_u32 vcc, s45, v50
    s_nop 0
    s_and_b32 s20, s20, vcc_lo
    s_cselect_b64 s[18:19], -1, 0
    v_max_f32_dpp v49, v49, v49 row_ror:8 row_mask:0xf bank_mask:0xf
    s_nop 1
    v_max_f32_dpp v49, v49, v49 row_ror:4 row_mask:0xf bank_mask:0xf
    s_nop 1
    v_max_f32_dpp v49, v49, v49 row_ror:2 row_mask:0xf bank_mask:0xf
    s_nop 1
    v_max_f32_dpp v49, v49, v49 row_ror:1 row_mask:0xf bank_mask:0xf
    v_mov_b32 v50, v49
    s_nop 1
    v_permlane16_swap_b32 v49, v50
    v_max_f32 v49, v49, v50
    v_sqrt_f32 v49, v49
    v_mov_b32 v51, s18
    v_mul_f32 v50, -1.0, v49
    v_mov_b32 v46, 16896
    ds_write_b64 v46, v[50:51]
    s_waitcnt lgkmcnt(0)
L_nopoll_14:
    s_add_u32 s33, s33, 1
    s_and_b32 s33, s33, 7
    s_barrier
    v_mov_b32 v46, 16896
    ds_read_b64 v[50:51], v46
    s_waitcnt lgkmcnt(0)
    v_readfirstlane_b32 s18, v51
    s_nop 0
    s_mov_b32 s19, s18
    v_mov_b32 v27, 163824
    v_mov_b32 v6, 0
    ds_write_b64 v27, v[6:7]
    ds_write_b32 v27, v6 offset:8
    s_waitcnt lgkmcnt(0)
    s_waitcnt vmcnt(0)
    s_barrier
    v_and_b32 v46, 0xfff, v18
    ds_read_b64_tr_b16 v[224:225], v208 offset:0
    ds_read_b64_tr_b16 v[226:227], v208 offset:512
    ds_read_b64_tr_b16 v[228:229], v208 offset:1024
    ds_read_b64_tr_b16 v[230:231], v208 offset:1536
    ds_read_b64_tr_b16 v[232:233], v208 offset:2048
    ds_read_b64_tr_b16 v[234:235], v208 offset:2560
    ds_read_b64_tr_b16 v[236:237], v208 offset:3072
    ds_read_b64_tr_b16 v[238:239], v208 offset:3584
    ds_read_b64_tr_b16 v[240:241], v208 offset:4096
    ds_read_b64_tr_b16 v[242:243], v208 offset:4608
    s_lshl_b32 s20, s33, 12
    s_add_u32 s20, s20, 0x19b8000
    s_mov_b32 s29, 0
L_kp_20:
    buffer_load_dwordx4 v[48:51], v46, s[4:7], s20 offen sc1
    s_add_u32 s29, s29, 1
    s_cmp_gt_u32 s29, 262144
    s_cbranch_scc1 main_exit
    s_waitcnt vmcnt(0)
    v_cmp_ne_u32 vcc, s41, v48
    v_cmp_ne_u32 s[36:37], s41, v51
    s_nop 0
    s_or_b64 vcc, vcc, s[36:37]
    s_cbranch_vccnz L_kp_20
    s_lshl_b32 s43, s33, 14
    s_lshl_b32 s42, s3, 12
    s_add_u32 s43, s43, s42
    s_add_u32 s43, s43, 0x1980000
    s_add_u32 m0, s42, 16384
    s_add_u32 s33, s33, 1
    s_and_b32 s33, s33, 7
    buffer_load_dwordx4 v1, s[4:7], s43 offen offset:0 sc1 lds
    buffer_load_dwordx4 v1, s[4:7], s43 offen offset:1024 sc1 lds
    buffer_load_dwordx4 v1, s[4:7], s43 offen offset:2048 sc1 lds
    buffer_load_dwordx4 v1, s[4:7], s43 offen offset:3072 sc1 lds
    s_waitcnt lgkmcnt(0)
    buffer_store_dwordx4 v[224:227], v204, s[4:7], s65 offen sc1
    buffer_store_dwordx4 v[228:231], v205, s[4:7], s66 offen sc1
    buffer_store_dwordx4 v[232:235], v204, s[4:7], s67 offen sc1
    buffer_store_dwordx4 v[236:239], v206, s[4:7], s68 offen sc1
    buffer_store_dwordx4 v[240:243], v204, s[4:7], s69 offen sc1
    s_waitcnt vmcnt(5)
    s_barrier
    s_mov_b32 s29, 0
    s_lshl_b32 s20, s3, 13
    s_add_u32 s20, s20, 0x19b8000
L_kall_21:
    buffer_load_dword v48, v18, s[4:7], s20 offen sc1
    s_add_u32 s29, s29, 1
    s_cmp_gt_u32 s29, 262144
    s_cbranch_scc1 main_exit
    s_waitcnt vmcnt(0)
    v_cmp_ne_u32 vcc, s41, v48
    s_nop 0
    s_mov_b64 exec, vcc
    s_cbranch_vccnz L_kall_21
    s_mov_b64 exec, -1
    v_mov_b32 v6, 1
    s_mov_b64 exec, 1
    ds_add_u32 v27, v6 offset:8
    s_mov_b64 exec, -1
    s_mov_b32 s29, 0
L_hs_22:
    s_sleep 1
    ds_read_b32 v6, v27 offset:8
    s_add_u32 s29, s29, 1
    s_cmp_gt_u32 s29, 4194304
    s_cbranch_scc1 main_exit
    s_waitcnt lgkmcnt(0)
    v_cmp_gt_u32 vcc, 4, v6
    s_nop 1
    s_cbranch_vccnz L_hs_22
    s_cmp_lg_u32 s3, 3
    s_cbranch_scc1 L_nopf_23
    s_lshl_b32 s20, s2, 7
    s_add_u32 s20, s20, 0x19b0000
    v_mov_b32 v6, 1
    s_mov_b64 exec, 1
    buffer_store_dword v6, v7, s[4:7], s20 offen sc1
    s_mov_b64 exec, -1
L_nopf_23:
    s_lshl_b32 s43, s33, 14
    s_lshl_b32 s42, s3, 12
    s_add_u32 s43, s43, s42
    s_add_u32 s43, s43, 0x1980000
    s_add_u32 m0, s42, 32768
    s_add_u32 s33, s33, 1
    s_and_b32 s33, s33, 7
    buffer_load_dwordx4 v1, s[4:7], s43 offen offset:0 sc1 lds
    buffer_load_dwordx4 v1, s[4:7], s43 offen offset:1024 sc1 lds
    buffer_load_dwordx4 v1, s[4:7], s43 offen offset:2048 sc1 lds
    buffer_load_dwordx4 v1, s[4:7], s43 offen offset:3072 sc1 lds
    s_lshl_b32 s43, s33, 14
    s_lshl_b32 s42, s3, 12
    s_add_u32 s43, s43, s42
    s_add_u32 s43, s43, 0x1980000
    s_add_u32 m0, s42, 49152
    s_add_u32 s33, s33, 1
    s_and_b32 s33, s33, 7
    buffer_load_dwordx4 v1, s[4:7], s43 offen offset:0 sc1 lds
    buffer_load_dwordx4 v1, s[4:7], s43 offen offset:1024 sc1 lds
    buffer_load_dwordx4 v1, s[4:7], s43 offen offset:2048 sc1 lds
    buffer_load_dwordx4 v1, s[4:7], s43 offen offset:3072 sc1 lds
    s_lshl_b32 s43, s33, 14
    s_lshl_b32 s42, s3, 12
    s_add_u32 s43, s43, s42
    s_add_u32 s43, s43, 0x1980000
    s_add_u32 m0, s42, 65536
    s_add_u32 s33, s33, 1
    s_and_b32 s33, s33, 7
    buffer_load_dwordx4 v1, s[4:7], s43 offen offset:0 sc1 lds
    buffer_load_dwordx4 v1, s[4:7], s43 offen offset:1024 sc1 lds
    buffer_load_dwordx4 v1, s[4:7], s43 offen offset:2048 sc1 lds
    buffer_load_dwordx4 v1, s[4:7], s43 offen offset:3072 sc1 lds
    s_lshl_b32 s43, s33, 14
    s_lshl_b32 s42, s3, 12
    s_add_u32 s43, s43, s42
    s_add_u32 s43, s43, 0x1980000
    s_add_u32 m0, s42, 81920
    s_add_u32 s33, s33, 1
    s_and_b32 s33, s33, 7
    buffer_load_dwordx4 v1, s[4:7], s43 offen offset:0 sc1 lds
    buffer_load_dwordx4 v1, s[4:7], s43 offen offset:1024 sc1 lds
    buffer_load_dwordx4 v1, s[4:7], s43 offen offset:2048 sc1 lds
    buffer_load_dwordx4 v1, s[4:7], s43 offen offset:3072 sc1 lds
    s_lshl_b32 s43, s33, 14
    s_lshl_b32 s42, s3, 12
    s_add_u32 s43, s43, s42
    s_add_u32 s43, s43, 0x1980000
    s_add_u32 m0, s42, 98304
    s_add_u32 s33, s33, 1
    s_and_b32 s33, s33, 7
    buffer_load_dwordx4 v1, s[4:7], s43 offen offset:0 sc1 lds
    buffer_load_dwordx4 v1, s[4:7], s43 offen offset:1024 sc1 lds
    buffer_load_dwordx4 v1, s[4:7], s43 offen offset:2048 sc1 lds
    buffer_load_dwordx4 v1, s[4:7], s43 offen offset:3072 sc1 lds
    s_lshl_b32 s43, s33, 14
    s_lshl_b32 s42, s3, 12
    s_add_u32 s43, s43, s42
    s_add_u32 s43, s43, 0x1980000
    s_add_u32 m0, s42, 114688
    s_add_u32 s33, s33, 1
    s_and_b32 s33, s33, 7
    buffer_load_dwordx4 v1, s[4:7], s43 offen offset:0 sc1 lds
    buffer_load_dwordx4 v1, s[4:7], s43 offen offset:1024 sc1 lds
    buffer_load_dwordx4 v1, s[4:7], s43 offen offset:2048 sc1 lds
    buffer_load_dwordx4 v1, s[4:7], s43 offen offset:3072 sc1 lds
    s_waitcnt vmcnt(0)
    s_barrier
    s_getpc_b64 s[36:37]
L_pc_24:
    s_sub_u32 s36, s36, L_pc_24-main_kernel
    s_subb_u32 s37, s37, 0
    s_and_b32 s21, s16, 3
    s_lshl_b32 s21, s21, 5
    s_add_u32 s21, s21, s38
    s_lshl_b32 s21, s21, 9
    v_and_b32 v22, 0x1ff, v18
    v_add_u32 v22, s21, v22
    v_min_u32 v22, main_end-main_kernel-4, v22
    global_load_dword v19, v22, s[36:37]
    s_lshl_b32 s60, s3, 13
    s_add_u32 s60, s60, 0x19b0000
    s_mov_b32 s29, 0
L_pchk_25:
    buffer_load_dword v28, v18, s[4:7], s60 offen sc1
    s_add_u32 s29, s29, 1
    s_cmp_gt_u32 s29, 262144
    s_cbranch_scc1 main_exit
    s_waitcnt vmcnt(0)
    v_cmp_ne_u32 vcc, 1, v28
    s_nop 0
    s_mov_b64 exec, vcc
    s_sleep 2
    s_cbranch_vccnz L_pchk_25
    s_mov_b64 exec, -1
    v_mov_b32 v6, 1
    s_mov_b64 exec, 1
    ds_add_u32 v27, v6 offset:4
    s_mov_b64 exec, -1
    s_mov_b32 s29, 0
L_hs_26:
    s_sleep 1
    ds_read_b32 v6, v27 offset:4
    s_add_u32 s29, s29, 1
    s_cmp_gt_u32 s29, 4194304
    s_cbranch_scc1 main_exit
    s_waitcnt lgkmcnt(0)
    v_cmp_gt_u32 vcc, 4, v6
    s_nop 1
    s_cbranch_vccnz L_hs_26
    v_mov_b32 v6, 1
    s_mov_b64 exec, 1
    ds_add_u32 v27, v6 offset:4
    s_mov_b64 exec, -1
    s_or_b32 s20, s2, s3
    s_cmp_lg_u32 s20, 0
    s_cbranch_scc1 L_notag_27
    v_mov_b32 v6, s41
    s_mov_b32 s20, 0x19af000
    s_mov_b64 exec, 1
    buffer_store_dword v6, v7, s[4:7], s20 offen sc1
    s_mov_b64 exec, -1
L_notag_27:
    s_mul_i32 s43, s38, 16384
    s_add_u32 s43, s43, 0x1480000
    buffer_load_dwordx4 v[64:67], v1, s[4:7], s43 offen offset:0 sc1
    buffer_load_dwordx4 v[68:71], v1, s[4:7], s43 offen offset:1024 sc1
    buffer_load_dwordx4 v[72:75], v1, s[4:7], s43 offen offset:2048 sc1
    buffer_load_dwordx4 v[76:79], v1, s[4:7], s43 offen offset:3072 sc1
    s_add_u32 s43, s43, 4096
    buffer_load_dwordx4 v[80:83], v1, s[4:7], s43 offen offset:0 sc1
    buffer_load_dwordx4 v[84:87], v1, s[4:7], s43 offen offset:1024 sc1
    buffer_load_dwordx4 v[88:91], v1, s[4:7], s43 offen offset:2048 sc1
    buffer_load_dwordx4 v[92:95], v1, s[4:7], s43 offen offset:3072 sc1
    s_add_u32 s43, s43, 4096
    buffer_load_dwordx4 v[96:99], v1, s[4:7], s43 offen offset:0 sc1
    buffer_load_dwordx4 v[100:103], v1, s[4:7], s43 offen offset:1024 sc1
    buffer_load_dwordx4 v[104:107], v1, s[4:7], s43 offen offset:2048 sc1
    buffer_load_dwordx4 v[108:111], v1, s[4:7], s43 offen offset:3072 sc1
    s_add_u32 s43, s43, 4096
    buffer_load_dwordx4 v[112:115], v1, s[4:7], s43 offen offset:0 sc1
    buffer_load_dwordx4 v[116:119], v1, s[4:7], s43 offen offset:1024 sc1
    buffer_load_dwordx4 v[120:123], v1, s[4:7], s43 offen offset:2048 sc1
    buffer_load_dwordx4 v[124:127], v1, s[4:7], s43 offen offset:3072 sc1
    s_add_u32 s43, s43, 4096
    s_mul_i32 s43, s38, 16384
    s_add_u32 s43, s43, 0x1500000
    buffer_load_dwordx4 v[128:131], v1, s[4:7], s43 offen offset:0 sc1
    buffer_load_dwordx4 v[132:135], v1, s[4:7], s43 offen offset:1024 sc1
    buffer_load_dwordx4 v[136:139], v1, s[4:7], s43 offen offset:2048 sc1
    buffer_load_dwordx4 v[140:143], v1, s[4:7], s43 offen offset:3072 sc1
    s_add_u32 s43, s43, 4096
    buffer_load_dwordx4 v[144:147], v1, s[4:7], s43 offen offset:0 sc1
    buffer_load_dwordx4 v[148:151], v1, s[4:7], s43 offen offset:1024 sc1
    buffer_load_dwordx4 v[152:155], v1, s[4:7], s43 offen offset:2048 sc1
    buffer_load_dwordx4 v[156:159], v1, s[4:7], s43 offen offset:3072 sc1
    s_add_u32 s43, s43, 4096
    buffer_load_dwordx4 v[160:163], v1, s[4:7], s43 offen offset:0 sc1
    buffer_load_dwordx4 v[164:167], v1, s[4:7], s43 offen offset:1024 sc1
    buffer_load_dwordx4 v[168:171], v1, s[4:7], s43 offen offset:2048 sc1
    buffer_load_dwordx4 v[172:175], v1, s[4:7], s43 offen offset:3072 sc1
    s_add_u32 s43, s43, 4096
    buffer_load_dwordx4 v[176:179], v1, s[4:7], s43 offen offset:0 sc1
    buffer_load_dwordx4 v[180:183], v1, s[4:7], s43 offen offset:1024 sc1
    buffer_load_dwordx4 v[184:187], v1, s[4:7], s43 offen offset:2048 sc1
    buffer_load_dwordx4 v[188:191], v1, s[4:7], s43 offen offset:3072 sc1
    s_add_u32 s43, s43, 4096
    s_mul_i32 s43, s38, 16384
    s_add_u32 s43, s43, 0x1580000
    buffer_load_dwordx4 v[192:195], v1, s[4:7], s43 offen offset:0 sc1
    buffer_load_dwordx4 v[196:199], v1, s[4:7], s43 offen offset:1024 sc1
    buffer_load_dwordx4 v[200:203], v1, s[4:7], s43 offen offset:2048 sc1
    buffer_load_dwordx4 v[204:207], v1, s[4:7], s43 offen offset:3072 sc1
    s_add_u32 s43, s43, 4096
    buffer_load_dwordx4 v[208:211], v1, s[4:7], s43 offen offset:0 sc1
    buffer_load_dwordx4 v[212:215], v1, s[4:7], s43 offen offset:1024 sc1
    buffer_load_dwordx4 v[216:219], v1, s[4:7], s43 offen offset:2048 sc1
    buffer_load_dwordx4 v[220:223], v1, s[4:7], s43 offen offset:3072 sc1
    s_add_u32 s43, s43, 4096
    buffer_load_dwordx4 v[224:227], v1, s[4:7], s43 offen offset:0 sc1
    buffer_load_dwordx4 v[228:231], v1, s[4:7], s43 offen offset:1024 sc1
    buffer_load_dwordx4 v[232:235], v1, s[4:7], s43 offen offset:2048 sc1
    buffer_load_dwordx4 v[236:239], v1, s[4:7], s43 offen offset:3072 sc1
    s_add_u32 s43, s43, 4096
    buffer_load_dwordx4 v[240:243], v1, s[4:7], s43 offen offset:0 sc1
    buffer_load_dwordx4 v[244:247], v1, s[4:7], s43 offen offset:1024 sc1
    buffer_load_dwordx4 v[248:251], v1, s[4:7], s43 offen offset:2048 sc1
    buffer_load_dwordx4 v[252:255], v1, s[4:7], s43 offen offset:3072 sc1
    s_add_u32 s43, s43, 4096
    s_cmp_lg_u32 s3, 3
    s_cbranch_scc1 L_ack_28
    s_mov_b32 s29, 0
L_hs_29:
    s_sleep 1
    ds_read_b32 v6, v27 offset:4
    s_add_u32 s29, s29, 1
    s_cmp_gt_u32 s29, 4194304
    s_cbranch_scc1 main_exit
    s_waitcnt lgkmcnt(0)
    v_cmp_gt_u32 vcc, 8, v6
    s_nop 1
    s_cbranch_vccnz L_hs_29
L_ack_28:
    s_mul_i32 s28, s3, 3
    s_add_u32 s28, s28, 0
    s_mul_i32 s25, s17, 14
    s_add_u32 s28, s28, s25
    s_lshl_b32 s28, s28, 14
    s_add_u32 s28, s28, 0x1600000
    s_lshl_b32 s42, s3, 13
    s_add_u32 s42, s42, 131072
    s_mov_b32 m0, s42
    s_nop 0
    buffer_load_dwordx4 v1, s[4:7], s28 offen offset:0 sc1 lds
    s_mov_b32 m0, s42
    s_nop 0
    buffer_load_dwordx4 v1, s[4:7], s28 offen offset:1024 sc1 lds
    s_mov_b32 m0, s42
    s_nop 0
    buffer_load_dwordx4 v1, s[4:7], s28 offen offset:2048 sc1 lds
    s_mov_b32 m0, s42
    s_nop 0
    buffer_load_dwordx4 v1, s[4:7], s28 offen offset:3072 sc1 lds
    s_add_u32 s28, s28, 4096
    s_add_u32 s42, s42, 4096
    s_mov_b32 m0, s42
    s_nop 0
    buffer_load_dwordx4 v1, s[4:7], s28 offen offset:0 sc1 lds
    s_mov_b32 m0, s42
    s_nop 0
    buffer_load_dwordx4 v1, s[4:7], s28 offen offset:1024 sc1 lds
    s_mov_b32 m0, s42
    s_nop 0
    buffer_load_dwordx4 v1, s[4:7], s28 offen offset:2048 sc1 lds
    s_mov_b32 m0, s42
    s_nop 0
    buffer_load_dwordx4 v1, s[4:7], s28 offen offset:3072 sc1 lds
    s_add_u32 s28, s28, 4096
    s_add_u32 s42, s42, 4096
    s_getpc_b64 s[36:37]
L_pc_30:
    s_sub_u32 s36, s36, L_pc_30-main_kernel
    s_subb_u32 s37, s37, 0
    s_and_b32 s21, s16, 3
    s_lshl_b32 s21, s21, 5
    s_add_u32 s21, s21, s38
    s_lshl_b32 s21, s21, 9
    v_and_b32 v22, 0x1ff, v18
    v_add_u32 v22, s21, v22
    v_min_u32 v22, main_end-main_kernel-4, v22
    global_load_dword v19, v22, s[36:37]
    s_lshl_b32 s21, s38, 5
    s_lshl_b32 s25, s16, 16
    s_add_u32 s21, s21, s25
    buffer_load_dwordx2 v[8:9], v5, s[8:11], s21 offen
    s_add_u32 s21, s21, 16384
    buffer_load_dwordx2 v[10:11], v5, s[8:11], s21 offen
    s_add_u32 s21, s21, 16384
    buffer_load_dwordx2 v[12:13], v5, s[8:11], s21 offen
    s_add_u32 s21, s21, 16384
    buffer_load_dwordx2 v[14:15], v5, s[8:11], s21 offen
    s_and_b32 s21, s16, 3
    s_mul_i32 s21, s21, 6144
    s_add_u32 s35, s28, s21
    s_mov_b32 exec_hi, 0xffff
    buffer_load_dword v19, v18, s[4:7], s35 offen
    s_mov_b64 exec, -1
    s_waitcnt vmcnt(6)
    s_barrier
    s_lshl_b32 s42, s3, 14
    s_mov_b32 m0, s42
    s_nop 0
    buffer_load_dwordx4 v1, s[4:7], s28 offen offset:0 sc1 lds
    s_mov_b32 m0, s42
    s_nop 0
    buffer_load_dwordx4 v1, s[4:7], s28 offen offset:1024 sc1 lds
    s_mov_b32 m0, s42
    s_nop 0
    buffer_load_dwordx4 v1, s[4:7], s28 offen offset:2048 sc1 lds
    s_mov_b32 m0, s42
    s_nop 0
    buffer_load_dwordx4 v1, s[4:7], s28 offen offset:3072 sc1 lds
    s_add_u32 s28, s28, 4096
    s_add_u32 s42, s42, 4096
    s_mov_b32 m0, s42
    s_nop 0
    buffer_load_dwordx4 v1, s[4:7], s28 offen offset:0 sc1 lds
    s_mov_b32 m0, s42
    s_nop 0
    buffer_load_dwordx4 v1, s[4:7], s28 offen offset:1024 sc1 lds
    s_mov_b32 m0, s42
    s_nop 0
    buffer_load_dwordx4 v1, s[4:7], s28 offen offset:2048 sc1 lds
    s_mov_b32 m0, s42
    s_nop 0
    buffer_load_dwordx4 v1, s[4:7], s28 offen offset:3072 sc1 lds
    s_add_u32 s28, s28, 4096
    s_add_u32 s42, s42, 4096
    s_mov_b32 m0, s42
    s_nop 0
    buffer_load_dwordx4 v1, s[4:7], s28 offen offset:0 sc1 lds
    s_mov_b32 m0, s42
    s_nop 0
    buffer_load_dwordx4 v1, s[4:7], s28 offen offset:1024 sc1 lds
    s_mov_b32 m0, s42
    s_nop 0
    buffer_load_dwordx4 v1, s[4:7], s28 offen offset:2048 sc1 lds
    s_mov_b32 m0, s42
    s_nop 0
    buffer_load_dwordx4 v1, s[4:7], s28 offen offset:3072 sc1 lds
    s_add_u32 s28, s28, 4096
    s_add_u32 s42, s42, 4096
    s_mov_b32 m0, s42
    s_nop 0
    buffer_load_dwordx4 v1, s[4:7], s28 offen offset:0 sc1 lds
    s_mov_b32 m0, s42
    s_nop 0
    buffer_load_dwordx4 v1, s[4:7], s28 offen offset:1024 sc1 lds
    s_mov_b32 m0, s42
    s_nop 0
    buffer_load_dwordx4 v1, s[4:7], s28 offen offset:2048 sc1 lds
    s_mov_b32 m0, s42
    s_nop 0
    buffer_load_dwordx4 v1, s[4:7], s28 offen offset:3072 sc1 lds
    s_add_u32 s28, s28, 4096
    s_add_u32 s42, s42, 4096
    s_getpc_b64 s[36:37]
L_pc_31:
    s_sub_u32 s36, s36, L_pc_31-main_kernel
    s_subb_u32 s37, s37, 0
    s_and_b32 s21, s16, 3
    s_lshl_b32 s21, s21, 5
    s_add_u32 s21, s21, s38
    s_lshl_b32 s21, s21, 9
    v_and_b32 v22, 0x1ff, v18
    v_add_u32 v22, s21, v22
    v_min_u32 v22, main_end-main_kernel-4, v22
    global_load_dword v19, v22, s[36:37]
    s_and_b32 s21, s16, 3
    s_lshl_b32 s35, s21, 5
    s_add_u32 s35, s35, s38
    s_mul_i32 s35, s35, 14336
    s_add_u32 s35, s35, 0x17c0000
    buffer_load_dword v19, v18, s[4:7], s35 offen
    s_waitcnt vmcnt(2)
    s_barrier
    s_lshl_b32 s42, s3, 13
    s_add_u32 s42, s42, 131072
    s_mov_b32 m0, s42
    s_nop 0
    buffer_load_dwordx4 v1, s[4:7], s28 offen offset:0 sc1 lds
    s_mov_b32 m0, s42
    s_nop 0
    buffer_load_dwordx4 v1, s[4:7], s28 offen offset:1024 sc1 lds
    s_mov_b32 m0, s42
    s_nop 0
    buffer_load_dwordx4 v1, s[4:7], s28 offen offset:2048 sc1 lds
    s_mov_b32 m0, s42
    s_nop 0
    buffer_load_dwordx4 v1, s[4:7], s28 offen offset:3072 sc1 lds
    s_add_u32 s28, s28, 4096
    s_add_u32 s42, s42, 4096
    s_mov_b32 m0, s42
    s_nop 0
    buffer_load_dwordx4 v1, s[4:7], s28 offen offset:0 sc1 lds
    s_mov_b32 m0, s42
    s_nop 0
    buffer_load_dwordx4 v1, s[4:7], s28 offen offset:1024 sc1 lds
    s_mov_b32 m0, s42
    s_nop 0
    buffer_load_dwordx4 v1, s[4:7], s28 offen offset:2048 sc1 lds
    s_mov_b32 m0, s42
    s_nop 0
    buffer_load_dwordx4 v1, s[4:7], s28 offen offset:3072 sc1 lds
    s_add_u32 s28, s28, 4096
    s_add_u32 s42, s42, 4096
    s_add_u32 s35, s35, 6144
    buffer_load_dword v19, v18, s[4:7], s35 offen
    s_waitcnt vmcnt(1)
    s_barrier
    s_barrier
    s_lshl_b32 s42, s3, 14
    s_mov_b32 m0, s42
    s_nop 0
    buffer_load_dwordx4 v1, s[4:7], s28 offen offset:0 sc1 lds
    s_mov_b32 m0, s42
    s_nop 0
    buffer_load_dwordx4 v1, s[4:7], s28 offen offset:1024 sc1 lds
    s_mov_b32 m0, s42
    s_nop 0
    buffer_load_dwordx4 v1, s[4:7], s28 offen offset:2048 sc1 lds
    s_mov_b32 m0, s42
    s_nop 0
    buffer_load_dwordx4 v1, s[4:7], s28 offen offset:3072 sc1 lds
    s_add_u32 s28, s28, 4096
    s_add_u32 s42, s42, 4096
    s_mov_b32 m0, s42
    s_nop 0
    buffer_load_dwordx4 v1, s[4:7], s28 offen offset:0 sc1 lds
    s_mov_b32 m0, s42
    s_nop 0
    buffer_load_dwordx4 v1, s[4:7], s28 offen offset:1024 sc1 lds
    s_mov_b32 m0, s42
    s_nop 0
    buffer_load_dwordx4 v1, s[4:7], s28 offen offset:2048 sc1 lds
    s_mov_b32 m0, s42
    s_nop 0
    buffer_load_dwordx4 v1, s[4:7], s28 offen offset:3072 sc1 lds
    s_add_u32 s28, s28, 4096
    s_add_u32 s42, s42, 4096
    s_mov_b32 m0, s42
    s_nop 0
    buffer_load_dwordx4 v1, s[4:7], s28 offen offset:0 sc1 lds
    s_mov_b32 m0, s42
    s_nop 0
    buffer_load_dwordx4 v1, s[4:7], s28 offen offset:1024 sc1 lds
    s_mov_b32 m0, s42
    s_nop 0
    buffer_load_dwordx4 v1, s[4:7], s28 offen offset:2048 sc1 lds
    s_mov_b32 m0, s42
    s_nop 0
    buffer_load_dwordx4 v1, s[4:7], s28 offen offset:3072 sc1 lds
    s_add_u32 s28, s28, 4096
    s_add_u32 s42, s42, 4096
    s_mov_b32 m0, s42
    s_nop 0
    buffer_load_dwordx4 v1, s[4:7], s28 offen offset:0 sc1 lds
    s_mov_b32 m0, s42
    s_nop 0
    buffer_load_dwordx4 v1, s[4:7], s28 offen offset:1024 sc1 lds
    s_mov_b32 m0, s42
    s_nop 0
    buffer_load_dwordx4 v1, s[4:7], s28 offen offset:2048 sc1 lds
    s_mov_b32 m0, s42
    s_nop 0
    buffer_load_dwordx4 v1, s[4:7], s28 offen offset:3072 sc1 lds
    s_add_u32 s28, s28, 4096
    s_add_u32 s42, s42, 4096
    s_lshr_b32 s28, s3, 1
    s_add_u32 s28, s28, 12
    s_mul_i32 s25, s17, 14
    s_add_u32 s28, s28, s25
    s_lshl_b32 s28, s28, 14
    s_add_u32 s28, s28, 0x1600000
    s_lshl_b32 s25, s39, 5
    s_add_u32 s28, s28, s25
    s_lshl_b32 s42, s3, 13
    s_add_u32 s42, s42, 131072
    s_mov_b32 m0, s42
    s_nop 0
    buffer_load_dwordx4 v1, s[4:7], s28 offen offset:0 sc1 lds
    s_mov_b32 m0, s42
    s_nop 0
    buffer_load_dwordx4 v1, s[4:7], s28 offen offset:1024 sc1 lds
    s_mov_b32 m0, s42
    s_nop 0
    buffer_load_dwordx4 v1, s[4:7], s28 offen offset:2048 sc1 lds
    s_mov_b32 m0, s42
    s_nop 0
    buffer_load_dwordx4 v1, s[4:7], s28 offen offset:3072 sc1 lds
    s_add_u32 s28, s28, 4096
    s_add_u32 s42, s42, 4096
    s_mov_b32 m0, s42
    s_nop 0
    buffer_load_dwordx4 v1, s[4:7], s28 offen offset:0 sc1 lds
    s_mov_b32 m0, s42
    s_nop 0
    buffer_load_dwordx4 v1, s[4:7], s28 offen offset:1024 sc1 lds
    s_mov_b32 m0, s42
    s_nop 0
    buffer_load_dwordx4 v1, s[4:7], s28 offen offset:2048 sc1 lds
    s_mov_b32 m0, s42
    s_nop 0
    buffer_load_dwordx4 v1, s[4:7], s28 offen offset:3072 sc1 lds
    s_add_u32 s28, s28, 4096
    s_add_u32 s42, s42, 4096
    s_mul_i32 s35, s38, 9600
    s_add_u32 s35, s35, s31
    s_add_u32 s35, s35, 0x0
    buffer_load_dword v19, v18, s[4:7], s35 offen
    s_mov_b32 exec_lo, 0x7ff
    s_mov_b32 exec_hi, 0
    s_add_u32 s35, s35, 8192
    buffer_load_dword v19, v18, s[4:7], s35 offen
    s_mov_b64 exec, -1
    s_getpc_b64 s[36:37]
L_pc_32:
    s_sub_u32 s36, s36, L_pc_32-main_kernel
    s_subb_u32 s37, s37, 0
    s_and_b32 s21, s16, 3
    s_lshl_b32 s21, s21, 5
    s_add_u32 s21, s21, s38
    s_lshl_b32 s21, s21, 9
    v_and_b32 v22, 0x1ff, v18
    v_add_u32 v22, s21, v22
    v_min_u32 v22, main_end-main_kernel-4, v22
    global_load_dword v19, v22, s[36:37]
    s_waitcnt vmcnt(0)
    s_mov_b64 vcc, s[18:19]
    s_lshl_b32 s24, s38, 11
    s_add_u32 s24, s24, s31
    s_add_u32 s24, s24, 0x0
    s_setprio 1
    s_branch M_H_0
.p2align 12,,1792
M_H_0:
    v_lshlrev_b32 v16, 16, v8
    v_and_b32 v17, 0xffff0000, v8
    v_lshlrev_b32 v18, 16, v9
    v_and_b32 v19, 0xffff0000, v9
    v_lshlrev_b32 v20, 16, v10
    v_and_b32 v21, 0xffff0000, v10
    v_lshlrev_b32 v22, 16, v11
    v_and_b32 v23, 0xffff0000, v11
    v_lshlrev_b32 v24, 16, v12
    v_and_b32 v25, 0xffff0000, v12
    v_lshlrev_b32 v26, 16, v13
    v_and_b32 v27, 0xffff0000, v13
    v_lshlrev_b32 v28, 16, v14
    v_and_b32 v29, 0xffff0000, v14
    v_lshlrev_b32 v30, 16, v15
    v_and_b32 v31, 0xffff0000, v15
    s_barrier
    ds_read_b128 v[32:35], v2 offset:0
    ds_read_b128 v[36:39], v2 offset:256
    ds_read_b128 v[40:43], v2 offset:512
    ds_read_b128 v[44:47], v2 offset:768
    ds_read_b128 v[48:51], v2 offset:4096
    ds_read_b128 v[52:55], v2 offset:4352
    ds_read_b128 v[56:59], v2 offset:4608
    ds_read_b128 v[60:63], v2 offset:4864
    s_barrier
    s_waitcnt lgkmcnt(6)
    v_mfma_f32_16x16x32_bf16 v[16:19], v[64:67], v[32:35], v[16:19]
    ds_read_b128 v[32:35], v2 offset:8192
    v_mfma_f32_16x16x32_bf16 v[20:23], v[64:67], v[36:39], v[20:23]
    ds_read_b128 v[36:39], v2 offset:8448
    s_waitcnt lgkmcnt(6)
    v_mfma_f32_16x16x32_bf16 v[24:27], v[64:67], v[40:43], v[24:27]
    ds_read_b128 v[40:43], v2 offset:8704
    v_mfma_f32_16x16x32_bf16 v[28:31], v[64:67], v[44:47], v[28:31]
    ds_read_b128 v[44:47], v2 offset:8960
    s_waitcnt lgkmcnt(6)
    v_mfma_f32_16x16x32_bf16 v[16:19], v[68:71], v[48:51], v[16:19]
    ds_read_b128 v[48:51], v2 offset:12288
    v_mfma_f32_16x16x32_bf16 v[20:23], v[68:71], v[52:55], v[20:23]
    ds_read_b128 v[52:55], v2 offset:12544
    s_waitcnt lgkmcnt(6)
    v_mfma_f32_16x16x32_bf16 v[24:27], v[68:71], v[56:59], v[24:27]
    ds_read_b128 v[56:59], v2 offset:12800
    v_mfma_f32_16x16x32_bf16 v[28:31], v[68:71], v[60:63], v[28:31]
    ds_read_b128 v[60:63], v2 offset:13056
    s_barrier
    s_waitcnt lgkmcnt(6)
    v_mfma_f32_16x16x32_bf16 v[16:19], v[72:75], v[32:35], v[16:19]
    ds_read_b128 v[32:35], v2 offset:16384
    v_mfma_f32_16x16x32_bf16 v[20:23], v[72:75], v[36:39], v[20:23]
    ds_read_b128 v[36:39], v2 offset:16640
    s_waitcnt lgkmcnt(6)
    v_mfma_f32_16x16x32_bf16 v[24:27], v[72:75], v[40:43], v[24:27]
    ds_read_b128 v[40:43], v2 offset:16896
    v_mfma_f32_16x16x32_bf16 v[28:31], v[72:75], v[44:47], v[28:31]
    ds_read_b128 v[44:47], v2 offset:17152
    s_waitcnt lgkmcnt(6)
    v_mfma_f32_16x16x32_bf16 v[16:19], v[76:79], v[48:51], v[16:19]
    ds_read_b128 v[48:51], v2 offset:20480
    v_mfma_f32_16x16x32_bf16 v[20:23], v[76:79], v[52:55], v[20:23]
    ds_read_b128 v[52:55], v2 offset:20736
    s_waitcnt lgkmcnt(6)
    v_mfma_f32_16x16x32_bf16 v[24:27], v[76:79], v[56:59], v[24:27]
    ds_read_b128 v[56:59], v2 offset:20992
    v_mfma_f32_16x16x32_bf16 v[28:31], v[76:79], v[60:63], v[28:31]
    ds_read_b128 v[60:63], v2 offset:21248
    s_barrier
    s_waitcnt lgkmcnt(6)
    v_mfma_f32_16x16x32_bf16 v[16:19], v[80:83], v[32:35], v[16:19]
    ds_read_b128 v[32:35], v2 offset:24576
    v_mfma_f32_16x16x32_bf16 v[20:23], v[80:83], v[36:39], v[20:23]
    ds_read_b128 v[36:39], v2 offset:24832
    s_waitcnt lgkmcnt(6)
    v_mfma_f32_16x16x32_bf16 v[24:27], v[80:83], v[40:43], v[24:27]
    ds_read_b128 v[40:43], v2 offset:25088
    v_mfma_f32_16x16x32_bf16 v[28:31], v[80:83], v[44:47], v[28:31]
    ds_read_b128 v[44:47], v2 offset:25344
    s_waitcnt lgkmcnt(6)
    v_mfma_f32_16x16x32_bf16 v[16:19], v[84:87], v[48:51], v[16:19]
    ds_read_b128 v[48:51], v2 offset:28672
    v_mfma_f32_16x16x32_bf16 v[20:23], v[84:87], v[52:55], v[20:23]
    ds_read_b128 v[52:55], v2 offset:28928
    s_waitcnt lgkmcnt(6)
    v_mfma_f32_16x16x32_bf16 v[24:27], v[84:87], v[56:59], v[24:27]
    ds_read_b128 v[56:59], v2 offset:29184
    v_mfma_f32_16x16x32_bf16 v[28:31], v[84:87], v[60:63], v[28:31]
    ds_read_b128 v[60:63], v2 offset:29440
    s_barrier
    s_waitcnt lgkmcnt(6)
    v_mfma_f32_16x16x32_bf16 v[16:19], v[88:91], v[32:35], v[16:19]
    ds_read_b128 v[32:35], v2 offset:32768
    v_mfma_f32_16x16x32_bf16 v[20:23], v[88:91], v[36:39], v[20:23]
    ds_read_b128 v[36:39], v2 offset:33024
    s_waitcnt lgkmcnt(6)
    v_mfma_f32_16x16x32_bf16 v[24:27], v[88:91], v[40:43], v[24:27]
    ds_read_b128 v[40:43], v2 offset:33280
    v_mfma_f32_16x16x32_bf16 v[28:31], v[88:91], v[44:47], v[28:31]
    ds_read_b128 v[44:47], v2 offset:33536
    s_waitcnt lgkmcnt(6)
    v_mfma_f32_16x16x32_bf16 v[16:19], v[92:95], v[48:51], v[16:19]
    ds_read_b128 v[48:51], v2 offset:36864
    v_mfma_f32_16x16x32_bf16 v[20:23], v[92:95], v[52:55], v[20:23]
    ds_read_b128 v[52:55], v2 offset:37120
    s_waitcnt lgkmcnt(6)
    v_mfma_f32_16x16x32_bf16 v[24:27], v[92:95], v[56:59], v[24:27]
    ds_read_b128 v[56:59], v2 offset:37376
    v_mfma_f32_16x16x32_bf16 v[28:31], v[92:95], v[60:63], v[28:31]
    ds_read_b128 v[60:63], v2 offset:37632
    s_barrier
    s_waitcnt lgkmcnt(6)
    v_mfma_f32_16x16x32_bf16 v[16:19], v[96:99], v[32:35], v[16:19]
    ds_read_b128 v[32:35], v2 offset:40960
    v_mfma_f32_16x16x32_bf16 v[20:23], v[96:99], v[36:39], v[20:23]
    ds_read_b128 v[36:39], v2 offset:41216
    s_waitcnt lgkmcnt(6)
    v_mfma_f32_16x16x32_bf16 v[24:27], v[96:99], v[40:43], v[24:27]
    ds_read_b128 v[40:43], v2 offset:41472
    v_mfma_f32_16x16x32_bf16 v[28:31], v[96:99], v[44:47], v[28:31]
    ds_read_b128 v[44:47], v2 offset:41728
    s_waitcnt lgkmcnt(6)
    v_mfma_f32_16x16x32_bf16 v[16:19], v[100:103], v[48:51], v[16:19]
    ds_read_b128 v[48:51], v2 offset:45056
    v_mfma_f32_16x16x32_bf16 v[20:23], v[100:103], v[52:55], v[20:23]
    ds_read_b128 v[52:55], v2 offset:45312
    s_waitcnt lgkmcnt(6)
    v_mfma_f32_16x16x32_bf16 v[24:27], v[100:103], v[56:59], v[24:27]
    ds_read_b128 v[56:59], v2 offset:45568
    v_mfma_f32_16x16x32_bf16 v[28:31], v[100:103], v[60:63], v[28:31]
    ds_read_b128 v[60:63], v2 offset:45824
    s_barrier
    s_waitcnt lgkmcnt(6)
    v_mfma_f32_16x16x32_bf16 v[16:19], v[104:107], v[32:35], v[16:19]
    ds_read_b128 v[32:35], v2 offset:49152
    v_mfma_f32_16x16x32_bf16 v[20:23], v[104:107], v[36:39], v[20:23]
    ds_read_b128 v[36:39], v2 offset:49408
    s_waitcnt lgkmcnt(6)
    v_mfma_f32_16x16x32_bf16 v[24:27], v[104:107], v[40:43], v[24:27]
    ds_read_b128 v[40:43], v2 offset:49664
    v_mfma_f32_16x16x32_bf16 v[28:31], v[104:107], v[44:47], v[28:31]
    ds_read_b128 v[44:47], v2 offset:49920
    s_waitcnt lgkmcnt(6)
    v_mfma_f32_16x16x32_bf16 v[16:19], v[108:111], v[48:51], v[16:19]
    ds_read_b128 v[48:51], v2 offset:53248
    v_mfma_f32_16x16x32_bf16 v[20:23], v[108:111], v[52:55], v[20:23]
    ds_read_b128 v[52:55], v2 offset:53504
    s_waitcnt lgkmcnt(6)
    v_mfma_f32_16x16x32_bf16 v[24:27], v[108:111], v[56:59], v[24:27]
    ds_read_b128 v[56:59], v2 offset:53760
    v_mfma_f32_16x16x32_bf16 v[28:31], v[108:111], v[60:63], v[28:31]
    ds_read_b128 v[60:63], v2 offset:54016
    s_barrier
    s_waitcnt lgkmcnt(6)
    v_mfma_f32_16x16x32_bf16 v[16:19], v[112:115], v[32:35], v[16:19]
    ds_read_b128 v[32:35], v2 offset:57344
    v_mfma_f32_16x16x32_bf16 v[20:23], v[112:115], v[36:39], v[20:23]
    ds_read_b128 v[36:39], v2 offset:57600
    s_waitcnt lgkmcnt(6)
    v_mfma_f32_16x16x32_bf16 v[24:27], v[112:115], v[40:43], v[24:27]
    ds_read_b128 v[40:43], v2 offset:57856
    v_mfma_f32_16x16x32_bf16 v[28:31], v[112:115], v[44:47], v[28:31]
    ds_read_b128 v[44:47], v2 offset:58112
    s_waitcnt lgkmcnt(6)
    v_mfma_f32_16x16x32_bf16 v[16:19], v[116:119], v[48:51], v[16:19]
    ds_read_b128 v[48:51], v2 offset:61440
    v_mfma_f32_16x16x32_bf16 v[20:23], v[116:119], v[52:55], v[20:23]
    ds_read_b128 v[52:55], v2 offset:61696
    s_waitcnt lgkmcnt(6)
    v_mfma_f32_16x16x32_bf16 v[24:27], v[116:119], v[56:59], v[24:27]
    ds_read_b128 v[56:59], v2 offset:61952
    v_mfma_f32_16x16x32_bf16 v[28:31], v[116:119], v[60:63], v[28:31]
    ds_read_b128 v[60:63], v2 offset:62208
    s_waitcnt lgkmcnt(6)
    v_mfma_f32_16x16x32_bf16 v[16:19], v[120:123], v[32:35], v[16:19]
    v_mfma_f32_16x16x32_bf16 v[20:23], v[120:123], v[36:39], v[20:23]
    s_waitcnt lgkmcnt(4)
    v_mfma_f32_16x16x32_bf16 v[24:27], v[120:123], v[40:43], v[24:27]
    v_mfma_f32_16x16x32_bf16 v[28:31], v[120:123], v[44:47], v[28:31]
    s_waitcnt lgkmcnt(2)
    v_mfma_f32_16x16x32_bf16 v[16:19], v[124:127], v[48:51], v[16:19]
    v_mfma_f32_16x16x32_bf16 v[20:23], v[124:127], v[52:55], v[20:23]
    s_waitcnt lgkmcnt(0)
    v_mfma_f32_16x16x32_bf16 v[24:27], v[124:127], v[56:59], v[24:27]
    v_mfma_f32_16x16x32_bf16 v[28:31], v[124:127], v[60:63], v[28:31]
    s_nop 3
    v_cvt_pk_bf16_f32 v8, v16, v17
    v_cvt_pk_bf16_f32 v9, v18, v19
    v_cvt_pk_bf16_f32 v10, v20, v21
    v_cvt_pk_bf16_f32 v11, v22, v23
    v_cvt_pk_bf16_f32 v12, v24, v25
    v_cvt_pk_bf16_f32 v13, v26, v27
    v_cvt_pk_bf16_f32 v14, v28, v29
    v_cvt_pk_bf16_f32 v15, v30, v31
    s_cbranch_vccnz L_cs_35
    buffer_store_dwordx2 v[8:9], v3, s[4:7], s24 offen offset:0 nt
    buffer_store_dwordx2 v[10:11], v3, s[4:7], s24 offen offset:256 nt
    buffer_store_dwordx2 v[12:13], v3, s[4:7], s24 offen offset:512 nt
    buffer_store_dwordx2 v[14:15], v3, s[4:7], s24 offen offset:768 nt
L_ce_36:
    v_pk_add_f32 v[32:33], v[16:17], v[18:19]
    v_pk_add_f32 v[34:35], v[20:21], v[22:23]
    v_pk_add_f32 v[36:37], v[24:25], v[26:27]
    v_pk_add_f32 v[38:39], v[28:29], v[30:31]
    v_pk_mul_f32 v[40:41], v[16:17], v[16:17]
    v_pk_mul_f32 v[42:43], v[20:21], v[20:21]
    v_pk_mul_f32 v[44:45], v[24:25], v[24:25]
    v_pk_mul_f32 v[46:47], v[28:29], v[28:29]
    v_pk_fma_f32 v[40:41], v[18:19], v[18:19], v[40:41]
    v_pk_fma_f32 v[42:43], v[22:23], v[22:23], v[42:43]
    v_pk_fma_f32 v[44:45], v[26:27], v[26:27], v[44:45]
    v_pk_fma_f32 v[46:47], v[30:31], v[30:31], v[46:47]
    v_add_f32 v104, v32, v33
    v_add_f32 v105, v34, v35
    v_add_f32 v106, v36, v37
    v_add_f32 v107, v38, v39
    v_add_f32 v108, v40, v41
    v_add_f32 v109, v42, v43
    v_add_f32 v110, v44, v45
    v_add_f32 v111, v46, v47
    s_lshl_b32 s25, s3, 10
    s_add_u32 s25, s25, 106752
    v_permlane32_swap_b32 v104, v106
    v_permlane32_swap_b32 v105, v107
    v_permlane32_swap_b32 v108, v110
    v_permlane32_swap_b32 v109, v111
    v_pk_add_f32 v[104:105], v[104:105], v[106:107]
    v_pk_add_f32 v[108:109], v[108:109], v[110:111]
    v_lshl_add_u32 v32, v0, 3, s25
    v_permlane16_swap_b32 v104, v105
    v_permlane16_swap_b32 v108, v109
    v_add_f32 v104, v104, v105
    v_add_f32 v105, v108, v109
    ds_write_b64 v32, v[104:105]
    v_lshlrev_b32 v64, 16, v8
    v_and_b32 v65, 0xffff0000, v8
    v_lshlrev_b32 v66, 16, v9
    v_and_b32 v67, 0xffff0000, v9
    v_lshlrev_b32 v68, 16, v10
    v_and_b32 v69, 0xffff0000, v10
    v_lshlrev_b32 v70, 16, v11
    v_and_b32 v71, 0xffff0000, v11
    v_lshlrev_b32 v72, 16, v12
    v_and_b32 v73, 0xffff0000, v12
    v_lshlrev_b32 v74, 16, v13
    v_and_b32 v75, 0xffff0000, v13
    v_lshlrev_b32 v76, 16, v14
    v_and_b32 v77, 0xffff0000, v14
    v_lshlrev_b32 v78, 16, v15
    v_and_b32 v79, 0xffff0000, v15
    s_add_u32 s20, s30, 8192
    v_mov_b32 v6, 1
    s_waitcnt vmcnt(0)
    s_mov_b64 exec, 1
    s_cbranch_vccnz L_cs_37
    buffer_store_dword v6, v4, s[4:7], s20 offen
L_ce_38:
    s_mov_b64 exec, -1
    s_waitcnt lgkmcnt(0)
    s_barrier
    s_branch M_H_1
.p2align 12,,2296
M_H_1:
    v_mov_b32 v120, 0x3f803f80
    v_mov_b32 v121, 0x3f803f80
    v_mov_b32 v122, 0x3f803f80
    v_mov_b32 v123, 0x3f803f80
    s_nop 1
    v_mfma_f32_16x16x32_bf16 v[96:99], v[128:131], v[120:123], 0
    v_mfma_f32_16x16x32_bf16 v[96:99], v[132:135], v[120:123], v[96:99]
    v_mfma_f32_16x16x32_bf16 v[96:99], v[136:139], v[120:123], v[96:99]
    v_mfma_f32_16x16x32_bf16 v[96:99], v[140:143], v[120:123], v[96:99]
    v_mfma_f32_16x16x32_bf16 v[96:99], v[144:147], v[120:123], v[96:99]
    v_mfma_f32_16x16x32_bf16 v[96:99], v[148:151], v[120:123], v[96:99]
    v_mfma_f32_16x16x32_bf16 v[96:99], v[152:155], v[120:123], v[96:99]
    v_mfma_f32_16x16x32_bf16 v[96:99], v[156:159], v[120:123], v[96:99]
    v_mfma_f32_16x16x32_bf16 v[96:99], v[160:163], v[120:123], v[96:99]
    v_mfma_f32_16x16x32_bf16 v[96:99], v[164:167], v[120:123], v[96:99]
    v_mfma_f32_16x16x32_bf16 v[96:99], v[168:171], v[120:123], v[96:99]
    v_mfma_f32_16x16x32_bf16 v[96:99], v[172:175], v[120:123], v[96:99]
    v_mfma_f32_16x16x32_bf16 v[96:99], v[176:179], v[120:123], v[96:99]
    v_mfma_f32_16x16x32_bf16 v[96:99], v[180:183], v[120:123], v[96:99]
    v_mfma_f32_16x16x32_bf16 v[96:99], v[184:187], v[120:123], v[96:99]
    v_mfma_f32_16x16x32_bf16 v[96:99], v[188:191], v[120:123], v[96:99]
    s_lshl_b32 s24, s38, 11
    s_add_u32 s24, s24, s31
    s_add_u32 s24, s24, 0x10000
    v_lshrrev_b32 v6, 5, v0
    v_lshlrev_b32 v6, 5, v6
    v_and_b32 v7, 0x1f, v3
    v_add_u32 v124, v6, v7
    s_lshl_b32 s23, s38, 6
    s_add_u32 s23, s23, s31
    v_and_b32 v7, 0xff, v1
    v_add_u32 v7, 65536, v7
    s_barrier
    ds_read_b128 v[32:35], v2 offset:0
    ds_read_b128 v[36:39], v2 offset:256
    ds_read_b128 v[40:43], v2 offset:512
    ds_read_b128 v[44:47], v2 offset:768
    ds_read_b128 v[48:51], v2 offset:4096
    ds_read_b128 v[52:55], v2 offset:4352
    ds_read_b128 v[56:59], v2 offset:4608
    ds_read_b128 v[60:63], v2 offset:4864
    s_barrier
    s_waitcnt lgkmcnt(6)
    v_mfma_f32_16x16x32_bf16 v[16:19], v[128:131], v[32:35], 0
    ds_read_b128 v[32:35], v2 offset:8192
    v_mfma_f32_16x16x32_bf16 v[20:23], v[128:131], v[36:39], 0
    ds_read_b128 v[36:39], v2 offset:8448
    s_waitcnt lgkmcnt(6)
    v_mfma_f32_16x16x32_bf16 v[24:27], v[128:131], v[40:43], 0
    ds_read_b128 v[40:43], v2 offset:8704
    v_mfma_f32_16x16x32_bf16 v[28:31], v[128:131], v[44:47], 0
    ds_read_b128 v[44:47], v2 offset:8960
    s_waitcnt lgkmcnt(6)
    v_mfma_f32_16x16x32_bf16 v[16:19], v[132:135], v[48:51], v[16:19]
    ds_read_b128 v[48:51], v2 offset:12288
    v_mfma_f32_16x16x32_bf16 v[20:23], v[132:135], v[52:55], v[20:23]
    ds_read_b128 v[52:55], v2 offset:12544
    s_waitcnt lgkmcnt(6)
    v_mfma_f32_16x16x32_bf16 v[24:27], v[132:135], v[56:59], v[24:27]
    ds_read_b128 v[56:59], v2 offset:12800
    v_mfma_f32_16x16x32_bf16 v[28:31], v[132:135], v[60:63], v[28:31]
    ds_read_b128 v[60:63], v2 offset:13056
    s_barrier
    s_waitcnt lgkmcnt(6)
    v_mfma_f32_16x16x32_bf16 v[16:19], v[136:139], v[32:35], v[16:19]
    ds_read_b128 v[32:35], v2 offset:16384
    v_mfma_f32_16x16x32_bf16 v[20:23], v[136:139], v[36:39], v[20:23]
    ds_read_b128 v[36:39], v2 offset:16640
    s_waitcnt lgkmcnt(6)
    v_mfma_f32_16x16x32_bf16 v[24:27], v[136:139], v[40:43], v[24:27]
    ds_read_b128 v[40:43], v2 offset:16896
    v_mfma_f32_16x16x32_bf16 v[28:31], v[136:139], v[44:47], v[28:31]
    ds_read_b128 v[44:47], v2 offset:17152
    s_waitcnt lgkmcnt(6)
    v_mfma_f32_16x16x32_bf16 v[16:19], v[140:143], v[48:51], v[16:19]
    ds_read_b128 v[48:51], v2 offset:20480
    v_mfma_f32_16x16x32_bf16 v[20:23], v[140:143], v[52:55], v[20:23]
    ds_read_b128 v[52:55], v2 offset:20736
    s_waitcnt lgkmcnt(6)
    v_mfma_f32_16x16x32_bf16 v[24:27], v[140:143], v[56:59], v[24:27]
    ds_read_b128 v[56:59], v2 offset:20992
    v_mfma_f32_16x16x32_bf16 v[28:31], v[140:143], v[60:63], v[28:31]
    ds_read_b128 v[60:63], v2 offset:21248
    s_barrier
    s_waitcnt lgkmcnt(6)
    v_mfma_f32_16x16x32_bf16 v[16:19], v[144:147], v[32:35], v[16:19]
    ds_read_b128 v[32:35], v2 offset:24576
    v_mfma_f32_16x16x32_bf16 v[20:23], v[144:147], v[36:39], v[20:23]
    ds_read_b128 v[36:39], v2 offset:24832
    s_waitcnt lgkmcnt(6)
    v_mfma_f32_16x16x32_bf16 v[24:27], v[144:147], v[40:43], v[24:27]
    ds_read_b128 v[40:43], v2 offset:25088
    v_mfma_f32_16x16x32_bf16 v[28:31], v[144:147], v[44:47], v[28:31]
    ds_read_b128 v[44:47], v2 offset:25344
    s_waitcnt lgkmcnt(6)
    v_mfma_f32_16x16x32_bf16 v[16:19], v[148:151], v[48:51], v[16:19]
    ds_read_b128 v[48:51], v2 offset:28672
    v_mfma_f32_16x16x32_bf16 v[20:23], v[148:151], v[52:55], v[20:23]
    ds_read_b128 v[52:55], v2 offset:28928
    s_waitcnt lgkmcnt(6)
    v_mfma_f32_16x16x32_bf16 v[24:27], v[148:151], v[56:59], v[24:27]
    ds_read_b128 v[56:59], v2 offset:29184
    v_mfma_f32_16x16x32_bf16 v[28:31], v[148:151], v[60:63], v[28:31]
    ds_read_b128 v[60:63], v2 offset:29440
    s_barrier
    s_waitcnt lgkmcnt(6)
    v_mfma_f32_16x16x32_bf16 v[16:19], v[152:155], v[32:35], v[16:19]
    ds_read_b128 v[32:35], v2 offset:32768
    v_mfma_f32_16x16x32_bf16 v[20:23], v[152:155], v[36:39], v[20:23]
    ds_read_b128 v[36:39], v2 offset:33024
    s_waitcnt lgkmcnt(6)
    v_mfma_f32_16x16x32_bf16 v[24:27], v[152:155], v[40:43], v[24:27]
    ds_read_b128 v[40:43], v2 offset:33280
    v_mfma_f32_16x16x32_bf16 v[28:31], v[152:155], v[44:47], v[28:31]
    ds_read_b128 v[44:47], v2 offset:33536
    s_waitcnt lgkmcnt(6)
    v_mfma_f32_16x16x32_bf16 v[16:19], v[156:159], v[48:51], v[16:19]
    ds_read_b128 v[48:51], v2 offset:36864
    v_mfma_f32_16x16x32_bf16 v[20:23], v[156:159], v[52:55], v[20:23]
    ds_read_b128 v[52:55], v2 offset:37120
    s_waitcnt lgkmcnt(6)
    v_mfma_f32_16x16x32_bf16 v[24:27], v[156:159], v[56:59], v[24:27]
    ds_read_b128 v[56:59], v2 offset:37376
    v_mfma_f32_16x16x32_bf16 v[28:31], v[156:159], v[60:63], v[28:31]
    ds_read_b128 v[60:63], v2 offset:37632
    s_barrier
    s_waitcnt lgkmcnt(6)
    v_mfma_f32_16x16x32_bf16 v[16:19], v[160:163], v[32:35], v[16:19]
    ds_read_b128 v[32:35], v2 offset:40960
    v_mfma_f32_16x16x32_bf16 v[20:23], v[160:163], v[36:39], v[20:23]
    ds_read_b128 v[36:39], v2 offset:41216
    s_waitcnt lgkmcnt(6)
    v_mfma_f32_16x16x32_bf16 v[24:27], v[160:163], v[40:43], v[24:27]
    ds_read_b128 v[40:43], v2 offset:41472
    v_mfma_f32_16x16x32_bf16 v[28:31], v[160:163], v[44:47], v[28:31]
    ds_read_b128 v[44:47], v2 offset:41728
    s_waitcnt lgkmcnt(6)
    v_mfma_f32_16x16x32_bf16 v[16:19], v[164:167], v[48:51], v[16:19]
    ds_read_b128 v[48:51], v2 offset:45056
    v_mfma_f32_16x16x32_bf16 v[20:23], v[164:167], v[52:55], v[20:23]
    ds_read_b128 v[52:55], v2 offset:45312
    s_waitcnt lgkmcnt(6)
    v_mfma_f32_16x16x32_bf16 v[24:27], v[164:167], v[56:59], v[24:27]
    ds_read_b128 v[56:59], v2 offset:45568
    v_mfma_f32_16x16x32_bf16 v[28:31], v[164:167], v[60:63], v[28:31]
    ds_read_b128 v[60:63], v2 offset:45824
    s_barrier
    s_waitcnt lgkmcnt(6)
    v_mfma_f32_16x16x32_bf16 v[16:19], v[168:171], v[32:35], v[16:19]
    ds_read_b128 v[32:35], v2 offset:49152
    v_mfma_f32_16x16x32_bf16 v[20:23], v[168:171], v[36:39], v[20:23]
    ds_read_b128 v[36:39], v2 offset:49408
    s_waitcnt lgkmcnt(6)
    v_mfma_f32_16x16x32_bf16 v[24:27], v[168:171], v[40:43], v[24:27]
    ds_read_b128 v[40:43], v2 offset:49664
    v_mfma_f32_16x16x32_bf16 v[28:31], v[168:171], v[44:47], v[28:31]
    ds_read_b128 v[44:47], v2 offset:49920
    s_waitcnt lgkmcnt(6)
    v_mfma_f32_16x16x32_bf16 v[16:19], v[172:175], v[48:51], v[16:19]
    ds_read_b128 v[48:51], v2 offset:53248
    v_mfma_f32_16x16x32_bf16 v[20:23], v[172:175], v[52:55], v[20:23]
    ds_read_b128 v[52:55], v2 offset:53504
    s_waitcnt lgkmcnt(6)
    v_mfma_f32_16x16x32_bf16 v[24:27], v[172:175], v[56:59], v[24:27]
    ds_read_b128 v[56:59], v2 offset:53760
    v_mfma_f32_16x16x32_bf16 v[28:31], v[172:175], v[60:63], v[28:31]
    ds_read_b128 v[60:63], v2 offset:54016
    s_barrier
    s_waitcnt lgkmcnt(6)
    v_mfma_f32_16x16x32_bf16 v[16:19], v[176:179], v[32:35], v[16:19]
    ds_read_b128 v[32:35], v2 offset:57344
    ds_read_b128 v[80:83], v7 offset:0
    v_mfma_f32_16x16x32_bf16 v[20:23], v[176:179], v[36:39], v[20:23]
    ds_read_b128 v[36:39], v2 offset:57600
    ds_read_b128 v[84:87], v7 offset:256
    s_waitcnt lgkmcnt(8)
    v_mfma_f32_16x16x32_bf16 v[24:27], v[176:179], v[40:43], v[24:27]
    ds_read_b128 v[40:43], v2 offset:57856
    ds_read_b128 v[88:91], v7 offset:512
    v_mfma_f32_16x16x32_bf16 v[28:31], v[176:179], v[44:47], v[28:31]
    ds_read_b128 v[44:47], v2 offset:58112
    ds_read_b128 v[92:95], v7 offset:768
    s_waitcnt lgkmcnt(10)
    v_mfma_f32_16x16x32_bf16 v[16:19], v[180:183], v[48:51], v[16:19]
    ds_read_b128 v[48:51], v2 offset:61440
    v_mfma_f32_16x16x32_bf16 v[20:23], v[180:183], v[52:55], v[20:23]
    ds_read_b128 v[52:55], v2 offset:61696
    s_waitcnt lgkmcnt(10)
    v_mfma_f32_16x16x32_bf16 v[24:27], v[180:183], v[56:59], v[24:27]
    ds_read_b128 v[56:59], v2 offset:61952
    v_mfma_f32_16x16x32_bf16 v[28:31], v[180:183], v[60:63], v[28:31]
    ds_read_b128 v[60:63], v2 offset:62208
    s_waitcnt lgkmcnt(9)
    v_mfma_f32_16x16x32_bf16 v[16:19], v[184:187], v[32:35], v[16:19]
    ds_read_b32 v100, v7 offset:1024
    v_mfma_f32_16x16x32_bf16 v[20:23], v[184:187], v[36:39], v[20:23]
    ds_read_b32 v101, v7 offset:1280
    s_waitcnt lgkmcnt(7)
    v_mfma_f32_16x16x32_bf16 v[24:27], v[184:187], v[40:43], v[24:27]
    ds_read_b32 v102, v7 offset:1536
    v_mfma_f32_16x16x32_bf16 v[28:31], v[184:187], v[44:47], v[28:31]
    ds_read_b32 v103, v7 offset:1792
    s_waitcnt lgkmcnt(6)
    v_mfma_f32_16x16x32_bf16 v[16:19], v[188:191], v[48:51], v[16:19]
    v_mfma_f32_16x16x32_bf16 v[20:23], v[188:191], v[52:55], v[20:23]
    s_waitcnt lgkmcnt(4)
    v_mfma_f32_16x16x32_bf16 v[24:27], v[188:191], v[56:59], v[24:27]
    v_mfma_f32_16x16x32_bf16 v[28:31], v[188:191], v[60:63], v[28:31]
    s_waitcnt lgkmcnt(0)
    s_nop 2
    v_pk_fma_f32 v[16:17], v[80:81], v[96:97], v[16:17] op_sel_hi:[0,1,1] neg_lo:[1,0,0] neg_hi:[1,0,0]
    s_nop 2
    v_pk_fma_f32 v[28:29], v[92:93], v[96:97], v[28:29] op_sel_hi:[0,1,1] neg_lo:[1,0,0] neg_hi:[1,0,0]
    v_pk_fma_f32 v[18:19], v[80:81], v[98:99], v[18:19] op_sel_hi:[0,1,1] neg_lo:[1,0,0] neg_hi:[1,0,0]
    v_pk_fma_f32 v[30:31], v[92:93], v[98:99], v[30:31] op_sel_hi:[0,1,1] neg_lo:[1,0,0] neg_hi:[1,0,0]
    v_pk_mul_f32 v[104:105], v[16:17], v[16:17]
    v_pk_mul_f32 v[108:109], v[28:29], v[28:29]
    v_pk_mul_f32 v[106:107], v[18:19], v[18:19]
    v_pk_mul_f32 v[110:111], v[30:31], v[30:31]
    v_pk_fma_f32 v[104:105], v[82:83], v[104:105], v[82:83] op_sel:[1,0,0] op_sel_hi:[1,1,0]
    v_pk_fma_f32 v[108:109], v[94:95], v[108:109], v[94:95] op_sel:[1,0,0] op_sel_hi:[1,1,0]
    v_pk_fma_f32 v[106:107], v[82:83], v[106:107], v[82:83] op_sel:[1,0,0] op_sel_hi:[1,1,0]
    v_pk_fma_f32 v[110:111], v[94:95], v[110:111], v[94:95] op_sel:[1,0,0] op_sel_hi:[1,1,0]
    v_pk_mul_f32 v[104:105], v[104:105], v[16:17]
    v_pk_mul_f32 v[108:109], v[108:109], v[28:29]
    v_pk_mul_f32 v[106:107], v[106:107], v[18:19]
    v_pk_mul_f32 v[110:111], v[110:111], v[30:31]
    v_exp_f32 v104, v104
    v_exp_f32 v108, v108
    v_exp_f32 v105, v105
    v_exp_f32 v109, v109
    v_exp_f32 v106, v106
    v_exp_f32 v110, v110
    v_exp_f32 v107, v107
    v_exp_f32 v111, v111
    v_pk_fma_f32 v[104:105], v[80:81], v[104:105], v[80:81] op_sel:[1,0,1] op_sel_hi:[1,1,1]
    v_pk_fma_f32 v[108:109], v[92:93], v[108:109], v[92:93] op_sel:[1,0,1] op_sel_hi:[1,1,1]
    v_pk_fma_f32 v[106:107], v[80:81], v[106:107], v[80:81] op_sel:[1,0,1] op_sel_hi:[1,1,1]
    v_pk_fma_f32 v[110:111], v[92:93], v[110:111], v[92:93] op_sel:[1,0,1] op_sel_hi:[1,1,1]
    v_rcp_f32 v104, v104
    v_rcp_f32 v108, v108
    v_rcp_f32 v105, v105
    v_rcp_f32 v109, v109
    v_rcp_f32 v106, v106
    v_rcp_f32 v110, v110
    v_rcp_f32 v107, v107
    v_rcp_f32 v111, v111
    v_pk_mul_f32 v[16:17], v[16:17], v[104:105]
    v_pk_mul_f32 v[28:29], v[28:29], v[108:109]
    v_pk_mul_f32 v[18:19], v[18:19], v[106:107]
    v_pk_mul_f32 v[30:31], v[30:31], v[110:111]
    v_cvt_pk_bf16_f32 v8, v16, v17
    v_cvt_pk_bf16_f32 v14, v28, v29
    v_cvt_pk_bf16_f32 v9, v18, v19
    v_cvt_pk_bf16_f32 v15, v30, v31
    s_cbranch_vccnz L_cs_46
    buffer_store_dwordx2 v[8:9], v3, s[4:7], s24 offen offset:0 nt
    buffer_store_dwordx2 v[14:15], v3, s[4:7], s24 offen offset:768 nt
L_ce_47:
    v_pk_fma_f32 v[20:21], v[84:85], v[96:97], v[20:21] op_sel_hi:[0,1,1] neg_lo:[1,0,0] neg_hi:[1,0,0]
    v_pk_fma_f32 v[24:25], v[88:89], v[96:97], v[24:25] op_sel_hi:[0,1,1] neg_lo:[1,0,0] neg_hi:[1,0,0]
    v_pk_fma_f32 v[22:23], v[84:85], v[98:99], v[22:23] op_sel_hi:[0,1,1] neg_lo:[1,0,0] neg_hi:[1,0,0]
    v_pk_fma_f32 v[26:27], v[88:89], v[98:99], v[26:27] op_sel_hi:[0,1,1] neg_lo:[1,0,0] neg_hi:[1,0,0]
    v_pk_mul_f32 v[104:105], v[20:21], v[20:21]
    v_pk_mul_f32 v[108:109], v[24:25], v[24:25]
    v_pk_mul_f32 v[106:107], v[22:23], v[22:23]
    v_pk_mul_f32 v[110:111], v[26:27], v[26:27]
    v_pk_fma_f32 v[104:105], v[86:87], v[104:105], v[86:87] op_sel:[1,0,0] op_sel_hi:[1,1,0]
    v_pk_fma_f32 v[108:109], v[90:91], v[108:109], v[90:91] op_sel:[1,0,0] op_sel_hi:[1,1,0]
    v_pk_fma_f32 v[106:107], v[86:87], v[106:107], v[86:87] op_sel:[1,0,0] op_sel_hi:[1,1,0]
    v_pk_fma_f32 v[110:111], v[90:91], v[110:111], v[90:91] op_sel:[1,0,0] op_sel_hi:[1,1,0]
    v_pk_mul_f32 v[104:105], v[104:105], v[20:21]
    v_pk_mul_f32 v[108:109], v[108:109], v[24:25]
    v_pk_mul_f32 v[106:107], v[106:107], v[22:23]
    v_pk_mul_f32 v[110:111], v[110:111], v[26:27]
    v_exp_f32 v104, v104
    v_exp_f32 v108, v108
    v_exp_f32 v105, v105
    v_exp_f32 v109, v109
    v_exp_f32 v106, v106
    v_exp_f32 v110, v110
    v_exp_f32 v107, v107
    v_exp_f32 v111, v111
    v_pk_fma_f32 v[104:105], v[84:85], v[104:105], v[84:85] op_sel:[1,0,1] op_sel_hi:[1,1,1]
    v_pk_fma_f32 v[108:109], v[88:89], v[108:109], v[88:89] op_sel:[1,0,1] op_sel_hi:[1,1,1]
    v_pk_fma_f32 v[106:107], v[84:85], v[106:107], v[84:85] op_sel:[1,0,1] op_sel_hi:[1,1,1]
    v_pk_fma_f32 v[110:111], v[88:89], v[110:111], v[88:89] op_sel:[1,0,1] op_sel_hi:[1,1,1]
    v_rcp_f32 v104, v104
    v_rcp_f32 v108, v108
    v_rcp_f32 v105, v105
    v_rcp_f32 v109, v109
    v_rcp_f32 v106, v106
    v_rcp_f32 v110, v110
    v_rcp_f32 v107, v107
    v_rcp_f32 v111, v111
    v_pk_mul_f32 v[20:21], v[20:21], v[104:105]
    v_pk_mul_f32 v[24:25], v[24:25], v[108:109]
    v_pk_mul_f32 v[22:23], v[22:23], v[106:107]
    v_pk_mul_f32 v[26:27], v[26:27], v[110:111]
    v_cvt_pk_bf16_f32 v10, v20, v21
    v_cvt_pk_bf16_f32 v12, v24, v25
    v_cvt_pk_bf16_f32 v11, v22, v23
    v_cvt_pk_bf16_f32 v13, v26, v27
    s_cbranch_vccnz L_cs_48
    buffer_store_dwordx2 v[10:11], v3, s[4:7], s24 offen offset:256 nt
    buffer_store_dwordx2 v[12:13], v3, s[4:7], s24 offen offset:512 nt
L_ce_49:
    s_add_u32 s20, s30, 16384
    v_mov_b32 v6, 1
    s_waitcnt vmcnt(0)
    s_mov_b64 exec, 1
    s_cbranch_vccnz L_cs_50
    buffer_store_dword v6, v4, s[4:7], s20 offen
L_ce_51:
    s_mov_b64 exec, -1
    s_bitcmp1_b32 s17, 1
    s_cbranch_scc1 L_side1_53
    s_cmp_eq_u32 s16, 31
    s_cbranch_scc1 L_nohalo_52
    s_add_u32 s23, s23, 0x98000
    s_mov_b32 exec_lo, 0xc000c000
    s_mov_b32 exec_hi, 0xc000c000
    buffer_store_dwordx2 v[14:15], v124, s[4:7], s23 offen sc1
    s_branch L_nohalo_52
L_side1_53:
    s_cmp_eq_u32 s16, 0
    s_cbranch_scc1 L_nohalo_52
    s_sub_u32 s23, s23, 0x8000
    s_mov_b32 exec_lo, 0x00030003
    s_mov_b32 exec_hi, 0x00030003
    buffer_store_dwordx2 v[8:9], v124, s[4:7], s23 offen sc1
L_nohalo_52:
    s_mov_b64 exec, -1
    s_barrier
    s_branch M_H_2
.p2align 12,,2224
M_H_2:
    s_lshl_b32 s21, s3, 14
    v_add_u32 v7, s21, v1
    ds_read_b128 v[128:131], v7 offset:0
    ds_read_b128 v[132:135], v7 offset:1024
    ds_read_b128 v[136:139], v7 offset:2048
    ds_read_b128 v[140:143], v7 offset:3072
    ds_read_b128 v[144:147], v7 offset:4096
    ds_read_b128 v[148:151], v7 offset:5120
    ds_read_b128 v[152:155], v7 offset:6144
    ds_read_b128 v[156:159], v7 offset:7168
    ds_read_b128 v[160:163], v7 offset:8192
    ds_read_b128 v[164:167], v7 offset:9216
    ds_read_b128 v[168:171], v7 offset:10240
    ds_read_b128 v[172:175], v7 offset:11264
    ds_read_b128 v[176:179], v7 offset:12288
    ds_read_b128 v[180:183], v7 offset:13312
    ds_read_b128 v[184:187], v7 offset:14336
    ds_read_b128 v[188:191], v7 offset:15360
    v_mul_f32 v6, v80, v100
    v_fma_f32 v16, v64, v100, -v6
    v_fma_f32 v17, v65, v100, -v6
    v_fma_f32 v18, v66, v100, -v6
    v_fma_f32 v19, v67, v100, -v6
    v_mul_f32 v6, v84, v101
    v_fma_f32 v20, v68, v101, -v6
    v_fma_f32 v21, v69, v101, -v6
    v_fma_f32 v22, v70, v101, -v6
    v_fma_f32 v23, v71, v101, -v6
    v_mul_f32 v6, v88, v102
    v_fma_f32 v24, v72, v102, -v6
    v_fma_f32 v25, v73, v102, -v6
    v_fma_f32 v26, v74, v102, -v6
    v_fma_f32 v27, v75, v102, -v6
    v_mul_f32 v6, v92, v103
    v_fma_f32 v28, v76, v103, -v6
    v_fma_f32 v29, v77, v103, -v6
    v_fma_f32 v30, v78, v103, -v6
    v_fma_f32 v31, v79, v103, -v6
    s_lshl_b32 s24, s38, 11
    s_add_u32 s24, s24, s31
    s_add_u32 s24, s24, 0x0
    s_waitcnt lgkmcnt(0)
    v_mov_b32 v120, 0x3f803f80
    v_mov_b32 v121, 0x3f803f80
    v_mov_b32 v122, 0x3f803f80
    v_mov_b32 v123, 0x3f803f80
    s_nop 1
    v_mfma_f32_16x16x32_bf16 v[112:115], v[128:131], v[120:123], 0
    v_mfma_f32_16x16x32_bf16 v[112:115], v[132:135], v[120:123], v[112:115]
    v_mfma_f32_16x16x32_bf16 v[112:115], v[136:139], v[120:123], v[112:115]
    v_mfma_f32_16x16x32_bf16 v[112:115], v[140:143], v[120:123], v[112:115]
    v_mfma_f32_16x16x32_bf16 v[112:115], v[144:147], v[120:123], v[112:115]
    v_mfma_f32_16x16x32_bf16 v[112:115], v[148:151], v[120:123], v[112:115]
    v_mfma_f32_16x16x32_bf16 v[112:115], v[152:155], v[120:123], v[112:115]
    v_mfma_f32_16x16x32_bf16 v[112:115], v[156:159], v[120:123], v[112:115]
    v_mfma_f32_16x16x32_bf16 v[112:115], v[160:163], v[120:123], v[112:115]
    v_mfma_f32_16x16x32_bf16 v[112:115], v[164:167], v[120:123], v[112:115]
    v_mfma_f32_16x16x32_bf16 v[112:115], v[168:171], v[120:123], v[112:115]
    v_mfma_f32_16x16x32_bf16 v[112:115], v[172:175], v[120:123], v[112:115]
    v_mfma_f32_16x16x32_bf16 v[112:115], v[176:179], v[120:123], v[112:115]
    v_mfma_f32_16x16x32_bf16 v[112:115], v[180:183], v[120:123], v[112:115]
    v_mfma_f32_16x16x32_bf16 v[112:115], v[184:187], v[120:123], v[112:115]
    v_mfma_f32_16x16x32_bf16 v[112:115], v[188:191], v[120:123], v[112:115]
    s_barrier
    ds_read_b128 v[32:35], v2 offset:256
    ds_read_b128 v[36:39], v2 offset:512
    ds_read_b128 v[40:43], v2 offset:768
    ds_read_b128 v[44:47], v2 offset:4352
    ds_read_b128 v[48:51], v2 offset:4608
    ds_read_b128 v[52:55], v2 offset:4864
    s_barrier
    s_waitcnt lgkmcnt(4)
    v_mfma_f32_16x16x32_bf16 v[20:23], v[192:195], v[32:35], v[20:23]
    ds_read_b128 v[32:35], v2 offset:8448
    v_mfma_f32_16x16x32_bf16 v[24:27], v[192:195], v[36:39], v[24:27]
    ds_read_b128 v[36:39], v2 offset:8704
    s_waitcnt lgkmcnt(4)
    v_mfma_f32_16x16x32_bf16 v[28:31], v[192:195], v[40:43], v[28:31]
    ds_read_b128 v[40:43], v2 offset:8960
    v_mfma_f32_16x16x32_bf16 v[20:23], v[196:199], v[44:47], v[20:23]
    ds_read_b128 v[44:47], v2 offset:12544
    s_waitcnt lgkmcnt(4)
    v_mfma_f32_16x16x32_bf16 v[24:27], v[196:199], v[48:51], v[24:27]
    ds_read_b128 v[48:51], v2 offset:12800
    v_mfma_f32_16x16x32_bf16 v[28:31], v[196:199], v[52:55], v[28:31]
    ds_read_b128 v[52:55], v2 offset:13056
    s_barrier
    s_waitcnt lgkmcnt(4)
    v_mfma_f32_16x16x32_bf16 v[20:23], v[200:203], v[32:35], v[20:23]
    ds_read_b128 v[32:35], v2 offset:16384
    v_mfma_f32_16x16x32_bf16 v[24:27], v[200:203], v[36:39], v[24:27]
    ds_read_b128 v[36:39], v2 offset:16640
    s_waitcnt lgkmcnt(4)
    v_mfma_f32_16x16x32_bf16 v[28:31], v[200:203], v[40:43], v[28:31]
    ds_read_b128 v[40:43], v2 offset:16896
    v_mfma_f32_16x16x32_bf16 v[20:23], v[204:207], v[44:47], v[20:23]
    ds_read_b128 v[44:47], v2 offset:20480
    s_waitcnt lgkmcnt(4)
    v_mfma_f32_16x16x32_bf16 v[24:27], v[204:207], v[48:51], v[24:27]
    ds_read_b128 v[48:51], v2 offset:20736
    v_mfma_f32_16x16x32_bf16 v[28:31], v[204:207], v[52:55], v[28:31]
    ds_read_b128 v[52:55], v2 offset:20992
    s_barrier
    s_waitcnt lgkmcnt(4)
    v_mfma_f32_16x16x32_bf16 v[16:19], v[208:211], v[32:35], v[16:19]
    ds_read_b128 v[32:35], v2 offset:24576
    v_mfma_f32_16x16x32_bf16 v[20:23], v[208:211], v[36:39], v[20:23]
    ds_read_b128 v[36:39], v2 offset:24832
    s_waitcnt lgkmcnt(4)
    v_mfma_f32_16x16x32_bf16 v[24:27], v[208:211], v[40:43], v[24:27]
    ds_read_b128 v[40:43], v2 offset:25088
    v_mfma_f32_16x16x32_bf16 v[16:19], v[212:215], v[44:47], v[16:19]
    ds_read_b128 v[44:47], v2 offset:28672
    s_waitcnt lgkmcnt(4)
    v_mfma_f32_16x16x32_bf16 v[20:23], v[212:215], v[48:51], v[20:23]
    ds_read_b128 v[48:51], v2 offset:28928
    v_mfma_f32_16x16x32_bf16 v[24:27], v[212:215], v[52:55], v[24:27]
    ds_read_b128 v[52:55], v2 offset:29184
    s_barrier
    s_waitcnt lgkmcnt(4)
    v_mfma_f32_16x16x32_bf16 v[16:19], v[216:219], v[32:35], v[16:19]
    ds_read_b128 v[32:35], v2 offset:33024
    v_mfma_f32_16x16x32_bf16 v[20:23], v[216:219], v[36:39], v[20:23]
    ds_read_b128 v[36:39], v2 offset:33280
    s_waitcnt lgkmcnt(4)
    v_mfma_f32_16x16x32_bf16 v[24:27], v[216:219], v[40:43], v[24:27]
    ds_read_b128 v[40:43], v2 offset:33536
    v_mfma_f32_16x16x32_bf16 v[16:19], v[220:223], v[44:47], v[16:19]
    ds_read_b128 v[44:47], v2 offset:37120
    s_waitcnt lgkmcnt(4)
    v_mfma_f32_16x16x32_bf16 v[20:23], v[220:223], v[48:51], v[20:23]
    ds_read_b128 v[48:51], v2 offset:37376
    v_mfma_f32_16x16x32_bf16 v[24:27], v[220:223], v[52:55], v[24:27]
    ds_read_b128 v[52:55], v2 offset:37632
    s_barrier
    s_waitcnt lgkmcnt(4)
    v_mfma_f32_16x16x32_bf16 v[20:23], v[224:227], v[32:35], v[20:23]
    ds_read_b128 v[32:35], v2 offset:41216
    v_mfma_f32_16x16x32_bf16 v[24:27], v[224:227], v[36:39], v[24:27]
    ds_read_b128 v[36:39], v2 offset:41472
    s_waitcnt lgkmcnt(4)
    v_mfma_f32_16x16x32_bf16 v[28:31], v[224:227], v[40:43], v[28:31]
    ds_read_b128 v[40:43], v2 offset:41728
    v_mfma_f32_16x16x32_bf16 v[20:23], v[228:231], v[44:47], v[20:23]
    ds_read_b128 v[44:47], v2 offset:45312
    s_waitcnt lgkmcnt(4)
    v_mfma_f32_16x16x32_bf16 v[24:27], v[228:231], v[48:51], v[24:27]
    ds_read_b128 v[48:51], v2 offset:45568
    v_mfma_f32_16x16x32_bf16 v[28:31], v[228:231], v[52:55], v[28:31]
    ds_read_b128 v[52:55], v2 offset:45824
    s_barrier
    s_waitcnt lgkmcnt(4)
    v_mfma_f32_16x16x32_bf16 v[20:23], v[232:235], v[32:35], v[20:23]
    ds_read_b128 v[32:35], v2 offset:49152
    v_mfma_f32_16x16x32_bf16 v[24:27], v[232:235], v[36:39], v[24:27]
    ds_read_b128 v[36:39], v2 offset:49408
    s_waitcnt lgkmcnt(4)
    v_mfma_f32_16x16x32_bf16 v[28:31], v[232:235], v[40:43], v[28:31]
    ds_read_b128 v[40:43], v2 offset:49664
    v_mfma_f32_16x16x32_bf16 v[20:23], v[236:239], v[44:47], v[20:23]
    ds_read_b128 v[44:47], v2 offset:53248
    s_waitcnt lgkmcnt(4)
    v_mfma_f32_16x16x32_bf16 v[24:27], v[236:239], v[48:51], v[24:27]
    ds_read_b128 v[48:51], v2 offset:53504
    v_mfma_f32_16x16x32_bf16 v[28:31], v[236:239], v[52:55], v[28:31]
    ds_read_b128 v[52:55], v2 offset:53760
    s_barrier
    s_waitcnt lgkmcnt(4)
    v_mfma_f32_16x16x32_bf16 v[16:19], v[240:243], v[32:35], v[16:19]
    ds_read_b128 v[32:35], v2 offset:57344
    v_mfma_f32_16x16x32_bf16 v[20:23], v[240:243], v[36:39], v[20:23]
    ds_read_b128 v[36:39], v2 offset:57600
    s_waitcnt lgkmcnt(4)
    v_mfma_f32_16x16x32_bf16 v[24:27], v[240:243], v[40:43], v[24:27]
    ds_read_b128 v[40:43], v2 offset:57856
    v_mfma_f32_16x16x32_bf16 v[16:19], v[244:247], v[44:47], v[16:19]
    ds_read_b128 v[44:47], v2 offset:61440
    s_waitcnt lgkmcnt(4)
    v_mfma_f32_16x16x32_bf16 v[20:23], v[244:247], v[48:51], v[20:23]
    ds_read_b128 v[48:51], v2 offset:61696
    v_mfma_f32_16x16x32_bf16 v[24:27], v[244:247], v[52:55], v[24:27]
    ds_read_b128 v[52:55], v2 offset:61952
    s_barrier
    ds_read_b128 v[56:59], v2 offset:25344
    ds_read_b128 v[60:63], v2 offset:29440
    s_waitcnt lgkmcnt(6)
    v_mfma_f32_16x16x32_bf16 v[16:19], v[248:251], v[32:35], v[16:19]
    ds_read_b128 v[32:35], v2 offset:0
    v_mfma_f32_16x16x32_bf16 v[20:23], v[248:251], v[36:39], v[20:23]
    ds_read_b128 v[36:39], v2 offset:4096
    s_waitcnt lgkmcnt(6)
    v_mfma_f32_16x16x32_bf16 v[24:27], v[248:251], v[40:43], v[24:27]
    ds_read_b128 v[40:43], v2 offset:8192
    v_mfma_f32_16x16x32_bf16 v[16:19], v[252:255], v[44:47], v[16:19]
    ds_read_b128 v[44:47], v2 offset:12288
    s_waitcnt lgkmcnt(6)
    v_mfma_f32_16x16x32_bf16 v[20:23], v[252:255], v[48:51], v[20:23]
    ds_read_b128 v[48:51], v2 offset:17152
    v_mfma_f32_16x16x32_bf16 v[24:27], v[252:255], v[52:55], v[24:27]
    ds_read_b128 v[52:55], v2 offset:21248
    s_waitcnt lgkmcnt(4)
    v_mfma_f32_16x16x32_bf16 v[16:19], v[192:195], v[32:35], v[16:19]
    ds_read_b128 v[32:35], v2 offset:32768
    v_mfma_f32_16x16x32_bf16 v[16:19], v[196:199], v[36:39], v[16:19]
    ds_read_b128 v[36:39], v2 offset:36864
    s_waitcnt lgkmcnt(4)
    v_mfma_f32_16x16x32_bf16 v[16:19], v[200:203], v[40:43], v[16:19]
    ds_read_b128 v[40:43], v2 offset:40960
    v_mfma_f32_16x16x32_bf16 v[16:19], v[204:207], v[44:47], v[16:19]
    ds_read_b128 v[44:47], v2 offset:45056
    s_waitcnt lgkmcnt(4)
    v_mfma_f32_16x16x32_bf16 v[28:31], v[208:211], v[48:51], v[28:31]
    ds_read_b128 v[48:51], v2 offset:49920
    v_mfma_f32_16x16x32_bf16 v[28:31], v[212:215], v[52:55], v[28:31]
    ds_read_b128 v[52:55], v2 offset:54016
    s_waitcnt lgkmcnt(12)
    v_mfma_f32_16x16x32_bf16 v[28:31], v[216:219], v[56:59], v[28:31]
    ds_read_b128 v[56:59], v2 offset:58112
    v_mfma_f32_16x16x32_bf16 v[28:31], v[220:223], v[60:63], v[28:31]
    ds_read_b128 v[60:63], v2 offset:62208
    s_waitcnt lgkmcnt(6)
    v_mfma_f32_16x16x32_bf16 v[16:19], v[224:227], v[32:35], v[16:19]
    v_mfma_f32_16x16x32_bf16 v[16:19], v[228:231], v[36:39], v[16:19]
    s_waitcnt lgkmcnt(4)
    v_mfma_f32_16x16x32_bf16 v[16:19], v[232:235], v[40:43], v[16:19]
    v_mfma_f32_16x16x32_bf16 v[16:19], v[236:239], v[44:47], v[16:19]
    s_waitcnt lgkmcnt(2)
    v_mfma_f32_16x16x32_bf16 v[28:31], v[240:243], v[48:51], v[28:31]
    v_mfma_f32_16x16x32_bf16 v[28:31], v[244:247], v[52:55], v[28:31]
    s_waitcnt lgkmcnt(0)
    v_mfma_f32_16x16x32_bf16 v[28:31], v[248:251], v[56:59], v[28:31]
    v_mfma_f32_16x16x32_bf16 v[28:31], v[252:255], v[60:63], v[28:31]
    s_nop 1
    v_cvt_pk_bf16_f32 v8, v16, v17
    v_cvt_pk_bf16_f32 v9, v18, v19
    v_cvt_pk_bf16_f32 v10, v20, v21
    v_cvt_pk_bf16_f32 v11, v22, v23
    v_cvt_pk_bf16_f32 v12, v24, v25
    v_cvt_pk_bf16_f32 v13, v26, v27
    v_cvt_pk_bf16_f32 v14, v28, v29
    v_cvt_pk_bf16_f32 v15, v30, v31
    s_cbranch_vccnz L_cs_59
    buffer_store_dwordx2 v[8:9], v3, s[4:7], s24 offen offset:0 nt
    buffer_store_dwordx2 v[10:11], v3, s[4:7], s24 offen offset:256 nt
    buffer_store_dwordx2 v[12:13], v3, s[4:7], s24 offen offset:512 nt
    buffer_store_dwordx2 v[14:15], v3, s[4:7], s24 offen offset:768 nt
L_ce_60:
    v_pk_add_f32 v[32:33], v[16:17], v[18:19]
    v_pk_add_f32 v[34:35], v[20:21], v[22:23]
    v_pk_add_f32 v[36:37], v[24:25], v[26:27]
    v_pk_add_f32 v[38:39], v[28:29], v[30:31]
    v_pk_mul_f32 v[40:41], v[16:17], v[16:17]
    v_pk_mul_f32 v[42:43], v[20:21], v[20:21]
    v_pk_mul_f32 v[44:45], v[24:25], v[24:25]
    v_pk_mul_f32 v[46:47], v[28:29], v[28:29]
    v_pk_fma_f32 v[40:41], v[18:19], v[18:19], v[40:41]
    v_pk_fma_f32 v[42:43], v[22:23], v[22:23], v[42:43]
    v_pk_fma_f32 v[44:45], v[26:27], v[26:27], v[44:45]
    v_pk_fma_f32 v[46:47], v[30:31], v[30:31], v[46:47]
    v_add_f32 v104, v32, v33
    v_add_f32 v105, v34, v35
    v_add_f32 v106, v36, v37
    v_add_f32 v107, v38, v39
    v_add_f32 v108, v40, v41
    v_add_f32 v109, v42, v43
    v_add_f32 v110, v44, v45
    v_add_f32 v111, v46, v47
    s_lshl_b32 s25, s3, 10
    s_add_u32 s25, s25, 106752
    v_permlane32_swap_b32 v104, v106
    v_permlane32_swap_b32 v105, v107
    v_permlane32_swap_b32 v108, v110
    v_permlane32_swap_b32 v109, v111
    v_pk_add_f32 v[104:105], v[104:105], v[106:107]
    v_pk_add_f32 v[108:109], v[108:109], v[110:111]
    v_lshl_add_u32 v32, v0, 3, s25
    v_permlane16_swap_b32 v104, v105
    v_permlane16_swap_b32 v108, v109
    v_add_f32 v104, v104, v105
    v_add_f32 v105, v108, v109
    ds_write_b64 v32, v[104:105]
    v_lshlrev_b32 v16, 16, v8
    v_and_b32 v17, 0xffff0000, v8
    v_lshlrev_b32 v18, 16, v9
    v_and_b32 v19, 0xffff0000, v9
    v_lshlrev_b32 v20, 16, v10
    v_and_b32 v21, 0xffff0000, v10
    v_lshlrev_b32 v22, 16, v11
    v_and_b32 v23, 0xffff0000, v11
    v_lshlrev_b32 v24, 16, v12
    v_and_b32 v25, 0xffff0000, v12
    v_lshlrev_b32 v26, 16, v13
    v_and_b32 v27, 0xffff0000, v13
    v_lshlrev_b32 v28, 16, v14
    v_and_b32 v29, 0xffff0000, v14
    v_lshlrev_b32 v30, 16, v15
    v_and_b32 v31, 0xffff0000, v15
    s_add_u32 s20, s30, 24576
    v_mov_b32 v6, 1
    s_waitcnt vmcnt(0)
    s_mov_b64 exec, 1
    s_cbranch_vccnz L_cs_61
    buffer_store_dword v6, v4, s[4:7], s20 offen
L_ce_62:
    s_mov_b64 exec, -1
    s_waitcnt lgkmcnt(0)
    s_barrier
    v_pk_add_f32 v[64:65], v[64:65], v[16:17]
    v_pk_add_f32 v[66:67], v[66:67], v[18:19]
    v_pk_add_f32 v[68:69], v[68:69], v[20:21]
    v_pk_add_f32 v[70:71], v[70:71], v[22:23]
    v_pk_add_f32 v[72:73], v[72:73], v[24:25]
    v_pk_add_f32 v[74:75], v[74:75], v[26:27]
    v_pk_add_f32 v[76:77], v[76:77], v[28:29]
    v_pk_add_f32 v[78:79], v[78:79], v[30:31]
    s_branch M_H_3
.p2align 12,,3384
M_H_3:
    s_and_b32 s21, s3, 2
    s_lshl_b32 s21, s21, 13
    s_add_u32 s21, s21, 131072
    v_add_u32 v7, s21, v1
    ds_read_b128 v[192:195], v7 offset:0
    ds_read_b128 v[196:199], v7 offset:1024
    ds_read_b128 v[200:203], v7 offset:2048
    ds_read_b128 v[204:207], v7 offset:3072
    ds_read_b128 v[208:211], v7 offset:4096
    ds_read_b128 v[212:215], v7 offset:5120
    ds_read_b128 v[216:219], v7 offset:6144
    ds_read_b128 v[220:223], v7 offset:7168
    ds_read_b128 v[224:227], v7 offset:8192
    ds_read_b128 v[228:231], v7 offset:9216
    ds_read_b128 v[232:235], v7 offset:10240
    ds_read_b128 v[236:239], v7 offset:11264
    ds_read_b128 v[240:243], v7 offset:12288
    ds_read_b128 v[244:247], v7 offset:13312
    ds_read_b128 v[248:251], v7 offset:14336
    ds_read_b128 v[252:255], v7 offset:15360
    v_xor_b32 v96, s39, v2
    v_xor_b32 v97, 256, v96
    v_xor_b32 v98, s39, v3
    v_xor_b32 v99, 256, v98
    v_and_b32 v100, 0xff, v1
    v_add_u32 v100, 131072, v100
    v_xor_b32 v100, s39, v100
    v_xor_b32 v101, 256, v100
    s_mul_i32 s32, s17, 28672
    s_add_u32 s32, s32, s31
    s_add_u32 s32, s32, 0x10000
    s_lshr_b32 s33, s3, 1
    s_add_u32 s33, s33, 12
    s_lshl_b32 s33, s33, 11
    s_add_u32 s33, s33, s32
    s_mul_i32 s23, s3, 6144
    s_add_u32 s32, s32, s23
    s_lshl_b32 s43, s17, 3
    s_add_u32 s43, s43, s44
    s_lshl_b32 s23, s43, 2
    v_mov_b32 v4, s23
    s_mul_i32 s43, s43, 28672
    s_add_u32 s43, s43, 0x17c0000
    s_add_u32 s32, s32, 4096
    s_waitcnt lgkmcnt(0)
    v_mov_b32 v120, 0x3f803f80
    v_mov_b32 v121, 0x3f803f80
    v_mov_b32 v122, 0x3f803f80
    v_mov_b32 v123, 0x3f803f80
    s_nop 1
    v_mfma_f32_16x16x32_bf16 v[116:119], v[192:195], v[120:123], 0
    v_mfma_f32_16x16x32_bf16 v[116:119], v[196:199], v[120:123], v[116:119]
    v_mfma_f32_16x16x32_bf16 v[116:119], v[200:203], v[120:123], v[116:119]
    v_mfma_f32_16x16x32_bf16 v[116:119], v[204:207], v[120:123], v[116:119]
    v_mfma_f32_16x16x32_bf16 v[116:119], v[208:211], v[120:123], v[116:119]
    v_mfma_f32_16x16x32_bf16 v[116:119], v[212:215], v[120:123], v[116:119]
    v_mfma_f32_16x16x32_bf16 v[116:119], v[216:219], v[120:123], v[116:119]
    v_mfma_f32_16x16x32_bf16 v[116:119], v[220:223], v[120:123], v[116:119]
    v_mfma_f32_16x16x32_bf16 v[116:119], v[224:227], v[120:123], v[116:119]
    v_mfma_f32_16x16x32_bf16 v[116:119], v[228:231], v[120:123], v[116:119]
    v_mfma_f32_16x16x32_bf16 v[116:119], v[232:235], v[120:123], v[116:119]
    v_mfma_f32_16x16x32_bf16 v[116:119], v[236:239], v[120:123], v[116:119]
    v_mfma_f32_16x16x32_bf16 v[116:119], v[240:243], v[120:123], v[116:119]
    v_mfma_f32_16x16x32_bf16 v[116:119], v[244:247], v[120:123], v[116:119]
    v_mfma_f32_16x16x32_bf16 v[116:119], v[248:251], v[120:123], v[116:119]
    v_mfma_f32_16x16x32_bf16 v[116:119], v[252:255], v[120:123], v[116:119]
    s_setprio 0
    s_barrier
    ds_read_b128 v[32:35], v96 offset:0
    ds_read_b128 v[36:39], v97 offset:0
    ds_read_b128 v[40:43], v96 offset:512
    ds_read_b128 v[44:47], v97 offset:512
    s_waitcnt lgkmcnt(3)
    v_mfma_f32_16x16x32_bf16 v[16:19], v[128:131], v[32:35], 0
    ds_read_b128 v[48:51], v96 offset:4096
    v_mfma_f32_16x16x32_bf16 v[20:23], v[192:195], v[32:35], 0
    s_waitcnt lgkmcnt(3)
    v_mfma_f32_16x16x32_bf16 v[24:27], v[128:131], v[36:39], 0
    ds_read_b128 v[52:55], v97 offset:4096
    s_waitcnt lgkmcnt(3)
    v_mfma_f32_16x16x32_bf16 v[28:31], v[128:131], v[40:43], 0
    ds_read_b128 v[56:59], v96 offset:4608
    v_mfma_f32_16x16x32_bf16 v[120:123], v[192:195], v[40:43], 0
    s_waitcnt lgkmcnt(3)
    v_mfma_f32_16x16x32_bf16 v[124:127], v[128:131], v[44:47], 0
    ds_read_b128 v[60:63], v97 offset:4608
    s_barrier
    s_waitcnt lgkmcnt(3)
    v_mfma_f32_16x16x32_bf16 v[16:19], v[132:135], v[48:51], v[16:19]
    ds_read_b128 v[32:35], v96 offset:8192
    v_mfma_f32_16x16x32_bf16 v[20:23], v[196:199], v[48:51], v[20:23]
    s_waitcnt lgkmcnt(3)
    v_mfma_f32_16x16x32_bf16 v[24:27], v[132:135], v[52:55], v[24:27]
    ds_read_b128 v[36:39], v97 offset:8192
    s_waitcnt lgkmcnt(3)
    v_mfma_f32_16x16x32_bf16 v[28:31], v[132:135], v[56:59], v[28:31]
    ds_read_b128 v[40:43], v96 offset:8704
    v_mfma_f32_16x16x32_bf16 v[120:123], v[196:199], v[56:59], v[120:123]
    s_waitcnt lgkmcnt(3)
    v_mfma_f32_16x16x32_bf16 v[124:127], v[132:135], v[60:63], v[124:127]
    ds_read_b128 v[44:47], v97 offset:8704
    s_waitcnt lgkmcnt(3)
    v_mfma_f32_16x16x32_bf16 v[16:19], v[136:139], v[32:35], v[16:19]
    ds_read_b128 v[48:51], v96 offset:12288
    v_mfma_f32_16x16x32_bf16 v[20:23], v[200:203], v[32:35], v[20:23]
    s_waitcnt lgkmcnt(3)
    v_mfma_f32_16x16x32_bf16 v[24:27], v[136:139], v[36:39], v[24:27]
    ds_read_b128 v[52:55], v97 offset:12288
    s_waitcnt lgkmcnt(3)
    v_mfma_f32_16x16x32_bf16 v[28:31], v[136:139], v[40:43], v[28:31]
    ds_read_b128 v[56:59], v96 offset:12800
    v_mfma_f32_16x16x32_bf16 v[120:123], v[200:203], v[40:43], v[120:123]
    s_waitcnt lgkmcnt(3)
    v_mfma_f32_16x16x32_bf16 v[124:127], v[136:139], v[44:47], v[124:127]
    ds_read_b128 v[60:63], v97 offset:12800
    s_barrier
    s_waitcnt lgkmcnt(3)
    v_mfma_f32_16x16x32_bf16 v[16:19], v[140:143], v[48:51], v[16:19]
    ds_read_b128 v[32:35], v96 offset:16384
    v_mfma_f32_16x16x32_bf16 v[20:23], v[204:207], v[48:51], v[20:23]
    s_waitcnt lgkmcnt(3)
    v_mfma_f32_16x16x32_bf16 v[24:27], v[140:143], v[52:55], v[24:27]
    ds_read_b128 v[36:39], v97 offset:16384
    buffer_load_dwordx4 v[128:131], v1, s[4:7], s43 offen offset:0 sc1
    s_waitcnt lgkmcnt(3)
    v_mfma_f32_16x16x32_bf16 v[28:31], v[140:143], v[56:59], v[28:31]
    ds_read_b128 v[40:43], v96 offset:16896
    v_mfma_f32_16x16x32_bf16 v[120:123], v[204:207], v[56:59], v[120:123]
    s_waitcnt lgkmcnt(3)
    v_mfma_f32_16x16x32_bf16 v[124:127], v[140:143], v[60:63], v[124:127]
    ds_read_b128 v[44:47], v97 offset:16896
    buffer_load_dwordx4 v[192:195], v1, s[4:7], s43 offen offset:1024 sc1
    s_waitcnt lgkmcnt(3)
    v_mfma_f32_16x16x32_bf16 v[16:19], v[144:147], v[32:35], v[16:19]
    ds_read_b128 v[48:51], v96 offset:20480
    v_mfma_f32_16x16x32_bf16 v[20:23], v[208:211], v[32:35], v[20:23]
    s_waitcnt lgkmcnt(3)
    v_mfma_f32_16x16x32_bf16 v[24:27], v[144:147], v[36:39], v[24:27]
    ds_read_b128 v[52:55], v97 offset:20480
    buffer_load_dwordx4 v[132:135], v1, s[4:7], s43 offen offset:2048 sc1
    s_waitcnt lgkmcnt(3)
    v_mfma_f32_16x16x32_bf16 v[28:31], v[144:147], v[40:43], v[28:31]
    ds_read_b128 v[56:59], v96 offset:20992
    v_mfma_f32_16x16x32_bf16 v[120:123], v[208:211], v[40:43], v[120:123]
    s_waitcnt lgkmcnt(3)
    v_mfma_f32_16x16x32_bf16 v[124:127], v[144:147], v[44:47], v[124:127]
    ds_read_b128 v[60:63], v97 offset:20992
    buffer_load_dwordx4 v[196:199], v1, s[4:7], s43 offen offset:3072 sc1
    s_add_u32 s43, s43, 4096
    s_waitcnt lgkmcnt(3)
    v_mfma_f32_16x16x32_bf16 v[16:19], v[148:151], v[48:51], v[16:19]
    ds_read_b128 v[32:35], v96 offset:24576
    v_mfma_f32_16x16x32_bf16 v[20:23], v[212:215], v[48:51], v[20:23]
    s_waitcnt lgkmcnt(3)
    v_mfma_f32_16x16x32_bf16 v[24:27], v[148:151], v[52:55], v[24:27]
    ds_read_b128 v[36:39], v97 offset:24576
    buffer_load_dwordx4 v[136:139], v1, s[4:7], s43 offen offset:0 sc1
    s_waitcnt lgkmcnt(3)
    v_mfma_f32_16x16x32_bf16 v[28:31], v[148:151], v[56:59], v[28:31]
    ds_read_b128 v[40:43], v96 offset:25088
    v_mfma_f32_16x16x32_bf16 v[120:123], v[212:215], v[56:59], v[120:123]
    s_waitcnt lgkmcnt(3)
    v_mfma_f32_16x16x32_bf16 v[124:127], v[148:151], v[60:63], v[124:127]
    ds_read_b128 v[44:47], v97 offset:25088
    buffer_load_dwordx4 v[200:203], v1, s[4:7], s43 offen offset:1024 sc1
    s_waitcnt lgkmcnt(3)
    v_mfma_f32_16x16x32_bf16 v[16:19], v[152:155], v[32:35], v[16:19]
    ds_read_b128 v[48:51], v96 offset:28672
    v_mfma_f32_16x16x32_bf16 v[20:23], v[216:219], v[32:35], v[20:23]
    s_waitcnt lgkmcnt(3)
    v_mfma_f32_16x16x32_bf16 v[24:27], v[152:155], v[36:39], v[24:27]
    ds_read_b128 v[52:55], v97 offset:28672
    buffer_load_dwordx4 v[140:143], v1, s[4:7], s43 offen offset:2048 sc1
    s_waitcnt lgkmcnt(3)
    v_mfma_f32_16x16x32_bf16 v[28:31], v[152:155], v[40:43], v[28:31]
    ds_read_b128 v[56:59], v96 offset:29184
    v_mfma_f32_16x16x32_bf16 v[120:123], v[216:219], v[40:43], v[120:123]
    s_waitcnt lgkmcnt(3)
    v_mfma_f32_16x16x32_bf16 v[124:127], v[152:155], v[44:47], v[124:127]
    ds_read_b128 v[60:63], v97 offset:29184
    buffer_load_dwordx4 v[204:207], v1, s[4:7], s43 offen offset:3072 sc1
    s_add_u32 s43, s43, 4096
    s_barrier
    s_waitcnt lgkmcnt(3)
    v_mfma_f32_16x16x32_bf16 v[16:19], v[156:159], v[48:51], v[16:19]
    ds_read_b128 v[32:35], v96 offset:32768
    v_mfma_f32_16x16x32_bf16 v[20:23], v[220:223], v[48:51], v[20:23]
    s_waitcnt lgkmcnt(3)
    v_mfma_f32_16x16x32_bf16 v[24:27], v[156:159], v[52:55], v[24:27]
    ds_read_b128 v[36:39], v97 offset:32768
    buffer_load_dwordx4 v[144:147], v1, s[4:7], s43 offen offset:0 sc1
    s_waitcnt lgkmcnt(3)
    v_mfma_f32_16x16x32_bf16 v[28:31], v[156:159], v[56:59], v[28:31]
    ds_read_b128 v[40:43], v96 offset:33280
    v_mfma_f32_16x16x32_bf16 v[120:123], v[220:223], v[56:59], v[120:123]
    s_waitcnt lgkmcnt(3)
    v_mfma_f32_16x16x32_bf16 v[124:127], v[156:159], v[60:63], v[124:127]
    ds_read_b128 v[44:47], v97 offset:33280
    buffer_load_dwordx4 v[208:211], v1, s[4:7], s43 offen offset:1024 sc1
    s_waitcnt lgkmcnt(3)
    v_mfma_f32_16x16x32_bf16 v[16:19], v[160:163], v[32:35], v[16:19]
    ds_read_b128 v[48:51], v96 offset:36864
    buffer_load_dwordx4 v[148:151], v1, s[4:7], s43 offen offset:2048 sc1
    v_mfma_f32_16x16x32_bf16 v[20:23], v[224:227], v[32:35], v[20:23]
    ds_read_b128 v[80:83], v100 offset:0
    s_waitcnt lgkmcnt(4)
    v_mfma_f32_16x16x32_bf16 v[24:27], v[160:163], v[36:39], v[24:27]
    ds_read_b128 v[52:55], v97 offset:36864
    ds_read_b128 v[84:87], v101 offset:0
    s_waitcnt lgkmcnt(5)
    v_mfma_f32_16x16x32_bf16 v[28:31], v[160:163], v[40:43], v[28:31]
    ds_read_b128 v[56:59], v96 offset:37376
    buffer_load_dwordx4 v[212:215], v1, s[4:7], s43 offen offset:3072 sc1
    s_add_u32 s43, s43, 4096
    v_mfma_f32_16x16x32_bf16 v[120:123], v[224:227], v[40:43], v[120:123]
    ds_read_b128 v[88:91], v100 offset:512
    s_waitcnt lgkmcnt(6)
    v_mfma_f32_16x16x32_bf16 v[124:127], v[160:163], v[44:47], v[124:127]
    ds_read_b128 v[60:63], v97 offset:37376
    ds_read_b128 v[92:95], v101 offset:512
    s_waitcnt lgkmcnt(7)
    v_mfma_f32_16x16x32_bf16 v[16:19], v[164:167], v[48:51], v[16:19]
    ds_read_b128 v[32:35], v96 offset:40960
    v_mfma_f32_16x16x32_bf16 v[20:23], v[228:231], v[48:51], v[20:23]
    s_waitcnt lgkmcnt(6)
    v_mfma_f32_16x16x32_bf16 v[24:27], v[164:167], v[52:55], v[24:27]
    ds_read_b128 v[36:39], v97 offset:40960
    buffer_load_dwordx4 v[152:155], v1, s[4:7], s43 offen offset:0 sc1
    s_waitcnt lgkmcnt(5)
    v_mfma_f32_16x16x32_bf16 v[28:31], v[164:167], v[56:59], v[28:31]
    ds_read_b128 v[40:43], v96 offset:41472
    v_mfma_f32_16x16x32_bf16 v[120:123], v[228:231], v[56:59], v[120:123]
    s_waitcnt lgkmcnt(4)
    v_mfma_f32_16x16x32_bf16 v[124:127], v[164:167], v[60:63], v[124:127]
    ds_read_b128 v[44:47], v97 offset:41472
    buffer_load_dwordx4 v[216:219], v1, s[4:7], s43 offen offset:1024 sc1
    s_waitcnt lgkmcnt(3)
    v_mfma_f32_16x16x32_bf16 v[16:19], v[168:171], v[32:35], v[16:19]
    ds_read_b128 v[48:51], v96 offset:45056
    v_mfma_f32_16x16x32_bf16 v[20:23], v[232:235], v[32:35], v[20:23]
    s_waitcnt lgkmcnt(3)
    v_mfma_f32_16x16x32_bf16 v[24:27], v[168:171], v[36:39], v[24:27]
    ds_read_b128 v[52:55], v97 offset:45056
    buffer_load_dwordx4 v[156:159], v1, s[4:7], s43 offen offset:2048 sc1
    s_waitcnt lgkmcnt(3)
    v_mfma_f32_16x16x32_bf16 v[28:31], v[168:171], v[40:43], v[28:31]
    ds_read_b128 v[56:59], v96 offset:45568
    v_mfma_f32_16x16x32_bf16 v[120:123], v[232:235], v[40:43], v[120:123]
    s_waitcnt lgkmcnt(3)
    v_mfma_f32_16x16x32_bf16 v[124:127], v[168:171], v[44:47], v[124:127]
    ds_read_b128 v[60:63], v97 offset:45568
    buffer_load_dwordx4 v[220:223], v1, s[4:7], s43 offen offset:3072 sc1
    s_add_u32 s43, s43, 4096
    s_waitcnt lgkmcnt(3)
    v_mfma_f32_16x16x32_bf16 v[16:19], v[172:175], v[48:51], v[16:19]
    ds_read_b128 v[32:35], v96 offset:49152
    v_mfma_f32_16x16x32_bf16 v[20:23], v[236:239], v[48:51], v[20:23]
    s_waitcnt lgkmcnt(3)
    v_mfma_f32_16x16x32_bf16 v[24:27], v[172:175], v[52:55], v[24:27]
    ds_read_b128 v[36:39], v97 offset:49152
    buffer_load_dwordx4 v[160:163], v1, s[4:7], s43 offen offset:0 sc1
    s_waitcnt lgkmcnt(3)
    v_mfma_f32_16x16x32_bf16 v[28:31], v[172:175], v[56:59], v[28:31]
    ds_read_b128 v[40:43], v96 offset:49664
    v_mfma_f32_16x16x32_bf16 v[120:123], v[236:239], v[56:59], v[120:123]
    s_waitcnt lgkmcnt(3)
    v_mfma_f32_16x16x32_bf16 v[124:127], v[172:175], v[60:63], v[124:127]
    ds_read_b128 v[44:47], v97 offset:49664
    buffer_load_dwordx4 v[224:227], v1, s[4:7], s43 offen offset:1024 sc1
    s_waitcnt lgkmcnt(3)
    v_mfma_f32_16x16x32_bf16 v[16:19], v[176:179], v[32:35], v[16:19]
    ds_read_b128 v[48:51], v96 offset:53248
    v_mfma_f32_16x16x32_bf16 v[20:23], v[240:243], v[32:35], v[20:23]
    s_waitcnt lgkmcnt(3)
    v_mfma_f32_16x16x32_bf16 v[24:27], v[176:179], v[36:39], v[24:27]
    ds_read_b128 v[52:55], v97 offset:53248
    buffer_load_dwordx4 v[164:167], v1, s[4:7], s43 offen offset:2048 sc1
    s_waitcnt lgkmcnt(3)
    v_mfma_f32_16x16x32_bf16 v[28:31], v[176:179], v[40:43], v[28:31]
    ds_read_b128 v[56:59], v96 offset:53760
    v_mfma_f32_16x16x32_bf16 v[120:123], v[240:243], v[40:43], v[120:123]
    s_waitcnt lgkmcnt(3)
    v_mfma_f32_16x16x32_bf16 v[124:127], v[176:179], v[44:47], v[124:127]
    ds_read_b128 v[60:63], v97 offset:53760
    buffer_load_dwordx4 v[228:231], v1, s[4:7], s43 offen offset:3072 sc1
    s_add_u32 s43, s43, 4096
    s_waitcnt lgkmcnt(3)
    v_mfma_f32_16x16x32_bf16 v[16:19], v[180:183], v[48:51], v[16:19]
    ds_read_b128 v[32:35], v96 offset:57344
    v_mfma_f32_16x16x32_bf16 v[20:23], v[244:247], v[48:51], v[20:23]
    s_waitcnt lgkmcnt(3)
    v_mfma_f32_16x16x32_bf16 v[24:27], v[180:183], v[52:55], v[24:27]
    ds_read_b128 v[36:39], v97 offset:57344
    s_lshl_b32 s21, s44, 13
    s_waitcnt lgkmcnt(3)
    v_mfma_f32_16x16x32_bf16 v[28:31], v[180:183], v[56:59], v[28:31]
    ds_read_b128 v[40:43], v96 offset:57856
    v_mfma_f32_16x16x32_bf16 v[120:123], v[244:247], v[56:59], v[120:123]
    s_waitcnt lgkmcnt(3)
    v_mfma_f32_16x16x32_bf16 v[124:127], v[180:183], v[60:63], v[124:127]
    ds_read_b128 v[44:47], v97 offset:57856
    v_add_u32 v7, s21, v1
    s_waitcnt lgkmcnt(3)
    v_mfma_f32_16x16x32_bf16 v[16:19], v[184:187], v[32:35], v[16:19]
    ds_read_b128 v[48:51], v96 offset:61440
    v_mfma_f32_16x16x32_bf16 v[20:23], v[248:251], v[32:35], v[20:23]
    ds_read_b128 v[168:171], v7 offset:0
    s_waitcnt lgkmcnt(4)
    v_mfma_f32_16x16x32_bf16 v[24:27], v[184:187], v[36:39], v[24:27]
    ds_read_b128 v[52:55], v97 offset:61440
    ds_read_b128 v[232:235], v7 offset:1024
    s_waitcnt lgkmcnt(5)
    v_mfma_f32_16x16x32_bf16 v[28:31], v[184:187], v[40:43], v[28:31]
    ds_read_b128 v[56:59], v96 offset:61952
    v_mfma_f32_16x16x32_bf16 v[120:123], v[248:251], v[40:43], v[120:123]
    ds_read_b128 v[172:175], v7 offset:2048
    s_waitcnt lgkmcnt(6)
    v_mfma_f32_16x16x32_bf16 v[124:127], v[184:187], v[44:47], v[124:127]
    ds_read_b128 v[60:63], v97 offset:61952
    ds_read_b128 v[236:239], v7 offset:3072
    s_waitcnt lgkmcnt(7)
    v_mfma_f32_16x16x32_bf16 v[16:19], v[188:191], v[48:51], v[16:19]
    v_mfma_f32_16x16x32_bf16 v[20:23], v[252:255], v[48:51], v[20:23]
    ds_read_b128 v[176:179], v7 offset:4096
    s_waitcnt lgkmcnt(6)
    v_mfma_f32_16x16x32_bf16 v[24:27], v[188:191], v[52:55], v[24:27]
    ds_read_b128 v[240:243], v7 offset:5120
    s_waitcnt lgkmcnt(5)
    v_mfma_f32_16x16x32_bf16 v[28:31], v[188:191], v[56:59], v[28:31]
    v_mfma_f32_16x16x32_bf16 v[120:123], v[252:255], v[56:59], v[120:123]
    ds_read_b128 v[180:183], v7 offset:6144
    s_waitcnt lgkmcnt(4)
    v_mfma_f32_16x16x32_bf16 v[124:127], v[188:191], v[60:63], v[124:127]
    ds_read_b128 v[244:247], v7 offset:7168
    s_setprio 1
    s_mul_i32 s34, s44, 28672
    s_add_u32 s34, s34, s31
    s_add_u32 s34, s34, 0x0
    v_and_b32 v96, 7, v0
    v_lshlrev_b32 v96, 2, v96
    s_lshl_b32 s21, s44, 5
    v_add_u32 v96, s21, v96
    v_pk_fma_f32 v[16:17], v[80:81], v[112:113], v[16:17] op_sel_hi:[0,1,1] neg_lo:[1,0,0] neg_hi:[1,0,0]
    v_pk_fma_f32 v[20:21], v[80:81], v[116:117], v[20:21] op_sel_hi:[0,1,1] neg_lo:[1,0,0] neg_hi:[1,0,0]
    v_pk_fma_f32 v[18:19], v[80:81], v[114:115], v[18:19] op_sel_hi:[0,1,1] neg_lo:[1,0,0] neg_hi:[1,0,0]
    v_pk_fma_f32 v[22:23], v[80:81], v[118:119], v[22:23] op_sel_hi:[0,1,1] neg_lo:[1,0,0] neg_hi:[1,0,0]
    v_pk_mul_f32 v[104:105], v[16:17], v[16:17]
    v_pk_mul_f32 v[108:109], v[20:21], v[20:21]
    v_pk_mul_f32 v[106:107], v[18:19], v[18:19]
    v_pk_mul_f32 v[110:111], v[22:23], v[22:23]
    v_pk_fma_f32 v[104:105], v[82:83], v[104:105], v[82:83] op_sel:[1,0,0] op_sel_hi:[1,1,0]
    v_pk_fma_f32 v[108:109], v[82:83], v[108:109], v[82:83] op_sel:[1,0,0] op_sel_hi:[1,1,0]
    v_pk_fma_f32 v[106:107], v[82:83], v[106:107], v[82:83] op_sel:[1,0,0] op_sel_hi:[1,1,0]
    v_pk_fma_f32 v[110:111], v[82:83], v[110:111], v[82:83] op_sel:[1,0,0] op_sel_hi:[1,1,0]
    v_pk_mul_f32 v[104:105], v[104:105], v[16:17]
    v_pk_mul_f32 v[108:109], v[108:109], v[20:21]
    v_pk_mul_f32 v[106:107], v[106:107], v[18:19]
    v_pk_mul_f32 v[110:111], v[110:111], v[22:23]
    v_exp_f32 v104, v104
    v_exp_f32 v108, v108
    v_exp_f32 v105, v105
    v_exp_f32 v109, v109
    v_exp_f32 v106, v106
    v_exp_f32 v110, v110
    v_exp_f32 v107, v107
    v_exp_f32 v111, v111
    v_pk_fma_f32 v[104:105], v[80:81], v[104:105], v[80:81] op_sel:[1,0,1] op_sel_hi:[1,1,1]
    v_pk_fma_f32 v[108:109], v[80:81], v[108:109], v[80:81] op_sel:[1,0,1] op_sel_hi:[1,1,1]
    v_pk_fma_f32 v[106:107], v[80:81], v[106:107], v[80:81] op_sel:[1,0,1] op_sel_hi:[1,1,1]
    v_pk_fma_f32 v[110:111], v[80:81], v[110:111], v[80:81] op_sel:[1,0,1] op_sel_hi:[1,1,1]
    v_rcp_f32 v104, v104
    v_rcp_f32 v108, v108
    v_rcp_f32 v105, v105
    v_rcp_f32 v109, v109
    v_rcp_f32 v106, v106
    v_rcp_f32 v110, v110
    v_rcp_f32 v107, v107
    v_rcp_f32 v111, v111
    v_pk_mul_f32 v[16:17], v[16:17], v[104:105]
    v_pk_mul_f32 v[20:21], v[20:21], v[108:109]
    v_pk_mul_f32 v[18:19], v[18:19], v[106:107]
    v_pk_mul_f32 v[22:23], v[22:23], v[110:111]
    v_cvt_pk_bf16_f32 v8, v16, v17
    v_cvt_pk_bf16_f32 v10, v20, v21
    v_cvt_pk_bf16_f32 v9, v18, v19
    v_cvt_pk_bf16_f32 v11, v22, v23
    s_cbranch_vccnz L_cs_80
    buffer_store_dwordx2 v[8:9], v98, s[4:7], s32 offen offset:0 nt
    buffer_store_dwordx2 v[10:11], v98, s[4:7], s33 offen offset:0 nt
L_ce_81:
    v_pk_fma_f32 v[24:25], v[84:85], v[112:113], v[24:25] op_sel_hi:[0,1,1] neg_lo:[1,0,0] neg_hi:[1,0,0]
    v_pk_fma_f32 v[26:27], v[84:85], v[114:115], v[26:27] op_sel_hi:[0,1,1] neg_lo:[1,0,0] neg_hi:[1,0,0]
    v_pk_mul_f32 v[104:105], v[24:25], v[24:25]
    v_pk_mul_f32 v[106:107], v[26:27], v[26:27]
    v_pk_fma_f32 v[104:105], v[86:87], v[104:105], v[86:87] op_sel:[1,0,0] op_sel_hi:[1,1,0]
    v_pk_fma_f32 v[106:107], v[86:87], v[106:107], v[86:87] op_sel:[1,0,0] op_sel_hi:[1,1,0]
    v_pk_mul_f32 v[104:105], v[104:105], v[24:25]
    v_pk_mul_f32 v[106:107], v[106:107], v[26:27]
    v_exp_f32 v104, v104
    v_exp_f32 v105, v105
    v_exp_f32 v106, v106
    v_exp_f32 v107, v107
    v_pk_fma_f32 v[104:105], v[84:85], v[104:105], v[84:85] op_sel:[1,0,1] op_sel_hi:[1,1,1]
    v_pk_fma_f32 v[106:107], v[84:85], v[106:107], v[84:85] op_sel:[1,0,1] op_sel_hi:[1,1,1]
    v_rcp_f32 v104, v104
    v_rcp_f32 v105, v105
    v_rcp_f32 v106, v106
    v_rcp_f32 v107, v107
    v_pk_mul_f32 v[24:25], v[24:25], v[104:105]
    v_pk_mul_f32 v[26:27], v[26:27], v[106:107]
    v_cvt_pk_bf16_f32 v12, v24, v25
    v_cvt_pk_bf16_f32 v13, v26, v27
    s_cbranch_vccnz L_cs_82
    buffer_store_dwordx2 v[12:13], v99, s[4:7], s32 offen offset:0 nt
L_ce_83:
    s_setprio 0
    v_pk_fma_f32 v[28:29], v[88:89], v[112:113], v[28:29] op_sel_hi:[0,1,1] neg_lo:[1,0,0] neg_hi:[1,0,0]
    v_pk_fma_f32 v[120:121], v[88:89], v[116:117], v[120:121] op_sel_hi:[0,1,1] neg_lo:[1,0,0] neg_hi:[1,0,0]
    v_pk_fma_f32 v[30:31], v[88:89], v[114:115], v[30:31] op_sel_hi:[0,1,1] neg_lo:[1,0,0] neg_hi:[1,0,0]
    v_pk_fma_f32 v[122:123], v[88:89], v[118:119], v[122:123] op_sel_hi:[0,1,1] neg_lo:[1,0,0] neg_hi:[1,0,0]
    v_pk_mul_f32 v[104:105], v[28:29], v[28:29]
    v_pk_mul_f32 v[108:109], v[120:121], v[120:121]
    v_pk_mul_f32 v[106:107], v[30:31], v[30:31]
    v_pk_mul_f32 v[110:111], v[122:123], v[122:123]
    v_pk_fma_f32 v[104:105], v[90:91], v[104:105], v[90:91] op_sel:[1,0,0] op_sel_hi:[1,1,0]
    v_pk_fma_f32 v[108:109], v[90:91], v[108:109], v[90:91] op_sel:[1,0,0] op_sel_hi:[1,1,0]
    v_pk_fma_f32 v[106:107], v[90:91], v[106:107], v[90:91] op_sel:[1,0,0] op_sel_hi:[1,1,0]
    v_pk_fma_f32 v[110:111], v[90:91], v[110:111], v[90:91] op_sel:[1,0,0] op_sel_hi:[1,1,0]
    v_pk_mul_f32 v[104:105], v[104:105], v[28:29]
    v_pk_mul_f32 v[108:109], v[108:109], v[120:121]
    v_pk_mul_f32 v[106:107], v[106:107], v[30:31]
    v_pk_mul_f32 v[110:111], v[110:111], v[122:123]
    v_exp_f32 v104, v104
    v_exp_f32 v108, v108
    v_exp_f32 v105, v105
    v_exp_f32 v109, v109
    v_exp_f32 v106, v106
    v_exp_f32 v110, v110
    v_exp_f32 v107, v107
    v_exp_f32 v111, v111
    v_pk_fma_f32 v[104:105], v[88:89], v[104:105], v[88:89] op_sel:[1,0,1] op_sel_hi:[1,1,1]
    v_pk_fma_f32 v[108:109], v[88:89], v[108:109], v[88:89] op_sel:[1,0,1] op_sel_hi:[1,1,1]
    v_pk_fma_f32 v[106:107], v[88:89], v[106:107], v[88:89] op_sel:[1,0,1] op_sel_hi:[1,1,1]
    v_pk_fma_f32 v[110:111], v[88:89], v[110:111], v[88:89] op_sel:[1,0,1] op_sel_hi:[1,1,1]
    v_rcp_f32 v104, v104
    v_rcp_f32 v108, v108
    v_rcp_f32 v105, v105
    s_add_u32 s20, s30, 32768
    v_mov_b32 v6, 1
    s_waitcnt vmcnt(0)
    s_mov_b64 exec, 1
    s_cbranch_vccnz L_cs_84
    buffer_store_dword v6, v4, s[4:7], s20 offen
L_ce_85:
    s_mov_b64 exec, -1
    v_rcp_f32 v109, v109
    v_rcp_f32 v106, v106
    v_rcp_f32 v110, v110
    v_rcp_f32 v107, v107
    v_rcp_f32 v111, v111
    v_pk_mul_f32 v[28:29], v[28:29], v[104:105]
    v_pk_mul_f32 v[120:121], v[120:121], v[108:109]
    v_pk_mul_f32 v[30:31], v[30:31], v[106:107]
    v_pk_mul_f32 v[122:123], v[122:123], v[110:111]
    v_cvt_pk_bf16_f32 v8, v28, v29
    v_cvt_pk_bf16_f32 v10, v120, v121
    v_cvt_pk_bf16_f32 v9, v30, v31
    v_cvt_pk_bf16_f32 v11, v122, v123
    s_cbranch_vccnz L_cs_86
    buffer_store_dwordx2 v[8:9], v98, s[4:7], s32 offen offset:512 nt
    buffer_store_dwordx2 v[10:11], v98, s[4:7], s33 offen offset:512 nt
L_ce_87:
    v_pk_fma_f32 v[124:125], v[92:93], v[112:113], v[124:125] op_sel_hi:[0,1,1] neg_lo:[1,0,0] neg_hi:[1,0,0]
    v_pk_fma_f32 v[126:127], v[92:93], v[114:115], v[126:127] op_sel_hi:[0,1,1] neg_lo:[1,0,0] neg_hi:[1,0,0]
    v_pk_mul_f32 v[104:105], v[124:125], v[124:125]
    v_pk_mul_f32 v[106:107], v[126:127], v[126:127]
    v_pk_fma_f32 v[104:105], v[94:95], v[104:105], v[94:95] op_sel:[1,0,0] op_sel_hi:[1,1,0]
    v_pk_fma_f32 v[106:107], v[94:95], v[106:107], v[94:95] op_sel:[1,0,0] op_sel_hi:[1,1,0]
    v_pk_mul_f32 v[104:105], v[104:105], v[124:125]
    v_pk_mul_f32 v[106:107], v[106:107], v[126:127]
    v_exp_f32 v104, v104
    v_exp_f32 v105, v105
    v_exp_f32 v106, v106
    v_exp_f32 v107, v107
    v_pk_fma_f32 v[104:105], v[92:93], v[104:105], v[92:93] op_sel:[1,0,1] op_sel_hi:[1,1,1]
    v_pk_fma_f32 v[106:107], v[92:93], v[106:107], v[92:93] op_sel:[1,0,1] op_sel_hi:[1,1,1]
    v_rcp_f32 v104, v104
    v_rcp_f32 v105, v105
    v_rcp_f32 v106, v106
    v_rcp_f32 v107, v107
    v_pk_mul_f32 v[124:125], v[124:125], v[104:105]
    v_pk_mul_f32 v[126:127], v[126:127], v[106:107]
    v_cvt_pk_bf16_f32 v12, v124, v125
    v_cvt_pk_bf16_f32 v13, v126, v127
    s_cbranch_vccnz L_cs_88
    buffer_store_dwordx2 v[12:13], v99, s[4:7], s32 offen offset:512 nt
L_ce_89:
    s_branch M_H_4
.p2align 12,,2568
M_H_4:
    s_add_u32 s20, s30, 32768
    s_mov_b32 s29, 0
    buffer_load_dword v102, v96, s[4:7], s20 offen sc1
    v_and_b32 v80, 15, v0
    v_lshrrev_b32 v81, 4, v0
    v_xor_b32 v82, v80, v81
    s_add_u32 s21, s3, 0
    s_and_b32 s21, s21, 3
    s_lshl_b32 s22, s21, 2
    v_xor_b32 v124, s22, v82
    v_lshlrev_b32 v124, 4, v124
    v_lshl_add_u32 v124, v81, 8, v124
    s_lshl_b32 s21, s21, 10
    s_lshl_b32 s22, s44, 12
    s_add_u32 s21, s21, s22
    v_add_u32 v124, s21, v124
    s_add_u32 s21, s3, 1
    s_and_b32 s21, s21, 3
    s_lshl_b32 s22, s21, 2
    v_xor_b32 v125, s22, v82
    v_lshlrev_b32 v125, 4, v125
    v_lshl_add_u32 v125, v81, 8, v125
    s_lshl_b32 s21, s21, 10
    s_lshl_b32 s22, s44, 12
    s_add_u32 s21, s21, s22
    v_add_u32 v125, s21, v125
    s_add_u32 s21, s3, 2
    s_and_b32 s21, s21, 3
    s_lshl_b32 s22, s21, 2
    v_xor_b32 v126, s22, v82
    v_lshlrev_b32 v126, 4, v126
    v_lshl_add_u32 v126, v81, 8, v126
    s_lshl_b32 s21, s21, 10
    s_lshl_b32 s22, s44, 12
    s_add_u32 s21, s21, s22
    v_add_u32 v126, s21, v126
    s_add_u32 s21, s3, 3
    s_and_b32 s21, s21, 3
    s_lshl_b32 s22, s21, 2
    v_xor_b32 v127, s22, v82
    v_lshlrev_b32 v127, 4, v127
    v_lshl_add_u32 v127, v81, 8, v127
    s_lshl_b32 s21, s21, 10
    s_lshl_b32 s22, s44, 12
    s_add_u32 s21, s21, s22
    v_add_u32 v127, s21, v127
    s_lshl_b32 s21, s3, 2
    v_add_u32 v81, s21, v81
    v_xor_b32 v7, v81, v80
    v_lshlrev_b32 v7, 4, v7
    v_lshl_add_u32 v7, v80, 8, v7
    v_lshlrev_b32 v5, 10, v81
    v_lshl_add_u32 v5, v80, 3, v5
    s_lshl_b32 s24, s16, 16
    s_lshl_b32 s21, s17, 7
    s_add_u32 s24, s24, s21
    s_add_u32 s24, s24, 16384
    v_add_u32 v7, 32768, v7
    s_waitcnt lgkmcnt(0)
    buffer_load_dword v103, v96, s[4:7], s20 offen sc1
    s_waitcnt vmcnt(1)
    v_cmp_ne_u32 vcc, 1, v102
    s_nop 1
    s_cbranch_vccz L_pdone_97
L_poll_96:
    buffer_load_dword v102, v96, s[4:7], s20 offen sc1
    s_waitcnt vmcnt(1)
    v_cmp_ne_u32 vcc, 1, v103
    s_nop 1
    s_cbranch_vccz L_pdone_97
    buffer_load_dword v103, v96, s[4:7], s20 offen sc1
    s_add_u32 s29, s29, 1
    s_cmp_gt_u32 s29, 262144
    s_cbranch_scc1 main_exit
    s_waitcnt vmcnt(1)
    v_cmp_ne_u32 vcc, 1, v102
    s_nop 1
    s_cbranch_vccnz L_poll_96
L_pdone_97:
    s_mov_b64 vcc, s[18:19]
    s_add_u32 s20, s30, 49152
    v_mov_b32 v6, 1
    s_waitcnt vmcnt(2)
    s_mov_b64 exec, 1
    s_cbranch_vccnz L_cs_98
    buffer_store_dword v6, v4, s[4:7], s20 offen
L_ce_99:
    s_mov_b64 exec, -1
    buffer_load_dwordx4 v[32:35], v2, s[4:7], s34 offen offset:0 sc1
    s_add_u32 s34, s34, 4096
    buffer_load_dwordx4 v[36:39], v2, s[4:7], s34 offen offset:0 sc1
    s_add_u32 s34, s34, 4096
    buffer_load_dwordx4 v[40:43], v2, s[4:7], s34 offen offset:0 sc1
    s_add_u32 s34, s34, 4096
    buffer_load_dwordx4 v[44:47], v2, s[4:7], s34 offen offset:0 sc1
    s_add_u32 s34, s34, 4096
    s_waitcnt vmcnt(3)
    v_mfma_f32_16x16x32_bf16 v[184:187], v[128:131], v[32:35], v[64:67]
    buffer_load_dwordx4 v[48:51], v2, s[4:7], s34 offen offset:0 sc1
    s_add_u32 s34, s34, 4096
    v_mfma_f32_16x16x32_bf16 v[188:191], v[192:195], v[32:35], 0
    v_mfma_f32_16x16x32_bf16 v[248:251], v[132:135], v[32:35], 0
    v_mfma_f32_16x16x32_bf16 v[252:255], v[196:199], v[32:35], 0
    s_waitcnt vmcnt(3)
    v_mfma_f32_16x16x32_bf16 v[184:187], v[136:139], v[36:39], v[184:187]
    buffer_load_dwordx4 v[52:55], v2, s[4:7], s34 offen offset:0 sc1
    s_add_u32 s34, s34, 4096
    v_mfma_f32_16x16x32_bf16 v[188:191], v[200:203], v[36:39], v[188:191]
    v_mfma_f32_16x16x32_bf16 v[248:251], v[140:143], v[36:39], v[248:251]
    v_mfma_f32_16x16x32_bf16 v[252:255], v[204:207], v[36:39], v[252:255]
    s_waitcnt vmcnt(3)
    v_mfma_f32_16x16x32_bf16 v[184:187], v[144:147], v[40:43], v[184:187]
    buffer_load_dwordx4 v[56:59], v2, s[4:7], s34 offen offset:0 sc1
    s_sub_u32 s34, s34, 24576
    v_mfma_f32_16x16x32_bf16 v[188:191], v[208:211], v[40:43], v[188:191]
    v_mfma_f32_16x16x32_bf16 v[248:251], v[148:151], v[40:43], v[248:251]
    v_mfma_f32_16x16x32_bf16 v[252:255], v[212:215], v[40:43], v[252:255]
    s_waitcnt vmcnt(3)
    v_mfma_f32_16x16x32_bf16 v[184:187], v[152:155], v[44:47], v[184:187]
    buffer_load_dwordx4 v[60:63], v2, s[4:7], s34 offen offset:256 sc1
    s_add_u32 s34, s34, 4096
    v_mfma_f32_16x16x32_bf16 v[188:191], v[216:219], v[44:47], v[188:191]
    v_mfma_f32_16x16x32_bf16 v[248:251], v[156:159], v[44:47], v[248:251]
    v_mfma_f32_16x16x32_bf16 v[252:255], v[220:223], v[44:47], v[252:255]
    s_waitcnt vmcnt(3)
    v_mfma_f32_16x16x32_bf16 v[184:187], v[160:163], v[48:51], v[184:187]
    buffer_load_dwordx4 v[32:35], v2, s[4:7], s34 offen offset:256 sc1
    s_add_u32 s34, s34, 4096
    v_mfma_f32_16x16x32_bf16 v[188:191], v[224:227], v[48:51], v[188:191]
    v_mfma_f32_16x16x32_bf16 v[248:251], v[164:167], v[48:51], v[248:251]
    v_mfma_f32_16x16x32_bf16 v[252:255], v[228:231], v[48:51], v[252:255]
    s_waitcnt vmcnt(3)
    v_mfma_f32_16x16x32_bf16 v[184:187], v[168:171], v[52:55], v[184:187]
    buffer_load_dwordx4 v[36:39], v2, s[4:7], s34 offen offset:256 sc1
    s_add_u32 s34, s34, 4096
    v_mfma_f32_16x16x32_bf16 v[188:191], v[232:235], v[52:55], v[188:191]
    buffer_load_dword v102, v96, s[4:7], s20 offen sc1
    v_mfma_f32_16x16x32_bf16 v[248:251], v[172:175], v[52:55], v[248:251]
    v_mfma_f32_16x16x32_bf16 v[252:255], v[236:239], v[52:55], v[252:255]
    s_waitcnt vmcnt(4)
    v_mfma_f32_16x16x32_bf16 v[184:187], v[176:179], v[56:59], v[184:187]
    buffer_load_dwordx4 v[40:43], v2, s[4:7], s34 offen offset:256 sc1
    s_add_u32 s34, s34, 4096
    v_mfma_f32_16x16x32_bf16 v[188:191], v[240:243], v[56:59], v[188:191]
    s_waitcnt lgkmcnt(0)
    s_barrier
    v_mfma_f32_16x16x32_bf16 v[248:251], v[180:183], v[56:59], v[248:251]
    v_mfma_f32_16x16x32_bf16 v[252:255], v[244:247], v[56:59], v[252:255]
    s_waitcnt vmcnt(4)
    v_mfma_f32_16x16x32_bf16 v[16:19], v[128:131], v[60:63], v[68:71]
    buffer_load_dwordx4 v[44:47], v2, s[4:7], s34 offen offset:256 sc1
    s_add_u32 s34, s34, 4096
    v_mfma_f32_16x16x32_bf16 v[20:23], v[192:195], v[60:63], 0
    v_mfma_f32_16x16x32_bf16 v[24:27], v[132:135], v[60:63], 0
    v_mfma_f32_16x16x32_bf16 v[28:31], v[196:199], v[60:63], 0
    s_waitcnt vmcnt(4)
    v_mfma_f32_16x16x32_bf16 v[16:19], v[136:139], v[32:35], v[16:19]
    buffer_load_dwordx4 v[48:51], v2, s[4:7], s34 offen offset:256 sc1
    s_add_u32 s34, s34, 4096
    v_mfma_f32_16x16x32_bf16 v[20:23], v[200:203], v[32:35], v[20:23]
    ds_write_b128 v124, v[184:187] offset:0
    ds_write_b128 v125, v[188:191] offset:0
    v_mfma_f32_16x16x32_bf16 v[24:27], v[140:143], v[32:35], v[24:27]
    ds_write_b128 v126, v[248:251] offset:0
    ds_write_b128 v127, v[252:255] offset:0
    v_mfma_f32_16x16x32_bf16 v[28:31], v[204:207], v[32:35], v[28:31]
    s_waitcnt vmcnt(4)
    v_mfma_f32_16x16x32_bf16 v[16:19], v[144:147], v[36:39], v[16:19]
    buffer_load_dwordx4 v[52:55], v2, s[4:7], s34 offen offset:256 sc1
    s_sub_u32 s34, s34, 24576
    v_mfma_f32_16x16x32_bf16 v[20:23], v[208:211], v[36:39], v[20:23]
    s_waitcnt vmcnt(4)
L_bchk_100:
    v_cmp_ne_u32 vcc, 1, v102
    s_nop 1
    s_cbranch_vccnz L_bre_101
    v_mfma_f32_16x16x32_bf16 v[24:27], v[148:151], v[36:39], v[24:27]
    v_mfma_f32_16x16x32_bf16 v[28:31], v[212:215], v[36:39], v[28:31]
    s_waitcnt vmcnt(3)
    v_mfma_f32_16x16x32_bf16 v[16:19], v[152:155], v[40:43], v[16:19]
    buffer_load_dwordx4 v[56:59], v2, s[4:7], s34 offen offset:512 sc1
    s_add_u32 s34, s34, 4096
    v_mfma_f32_16x16x32_bf16 v[20:23], v[216:219], v[40:43], v[20:23]
    v_mfma_f32_16x16x32_bf16 v[24:27], v[156:159], v[40:43], v[24:27]
    v_mfma_f32_16x16x32_bf16 v[28:31], v[220:223], v[40:43], v[28:31]
    s_waitcnt vmcnt(3)
    v_mfma_f32_16x16x32_bf16 v[16:19], v[160:163], v[44:47], v[16:19]
    buffer_load_dwordx4 v[60:63], v2, s[4:7], s34 offen offset:512 sc1
    s_add_u32 s34, s34, 4096
    v_mfma_f32_16x16x32_bf16 v[20:23], v[224:227], v[44:47], v[20:23]
    v_mfma_f32_16x16x32_bf16 v[24:27], v[164:167], v[44:47], v[24:27]
    v_mfma_f32_16x16x32_bf16 v[28:31], v[228:231], v[44:47], v[28:31]
    s_waitcnt vmcnt(3)
    v_mfma_f32_16x16x32_bf16 v[16:19], v[168:171], v[48:51], v[16:19]
    buffer_load_dwordx4 v[32:35], v2, s[4:7], s34 offen offset:512 sc1
    s_add_u32 s34, s34, 4096
    v_mfma_f32_16x16x32_bf16 v[20:23], v[232:235], v[48:51], v[20:23]
    v_mfma_f32_16x16x32_bf16 v[24:27], v[172:175], v[48:51], v[24:27]
    v_mfma_f32_16x16x32_bf16 v[28:31], v[236:239], v[48:51], v[28:31]
    s_waitcnt vmcnt(3)
    v_mfma_f32_16x16x32_bf16 v[16:19], v[176:179], v[52:55], v[16:19]
    buffer_load_dwordx4 v[36:39], v2, s[4:7], s34 offen offset:512 sc1
    s_add_u32 s34, s34, 4096
    v_mfma_f32_16x16x32_bf16 v[20:23], v[240:243], v[52:55], v[20:23]
    v_mfma_f32_16x16x32_bf16 v[24:27], v[180:183], v[52:55], v[24:27]
    v_mfma_f32_16x16x32_bf16 v[28:31], v[244:247], v[52:55], v[28:31]
    s_waitcnt vmcnt(3)
    v_mfma_f32_16x16x32_bf16 v[184:187], v[128:131], v[56:59], v[72:75]
    buffer_load_dwordx4 v[40:43], v2, s[4:7], s34 offen offset:512 sc1
    s_add_u32 s34, s34, 4096
    v_mfma_f32_16x16x32_bf16 v[188:191], v[192:195], v[56:59], 0
    v_mfma_f32_16x16x32_bf16 v[248:251], v[132:135], v[56:59], 0
    v_mfma_f32_16x16x32_bf16 v[252:255], v[196:199], v[56:59], 0
    s_waitcnt vmcnt(3)
    v_mfma_f32_16x16x32_bf16 v[184:187], v[136:139], v[60:63], v[184:187]
    buffer_load_dwordx4 v[44:47], v2, s[4:7], s34 offen offset:512 sc1
    s_add_u32 s34, s34, 4096
    v_mfma_f32_16x16x32_bf16 v[188:191], v[200:203], v[60:63], v[188:191]
    ds_write_b128 v124, v[16:19] offset:32768
    ds_write_b128 v125, v[20:23] offset:32768
    v_mfma_f32_16x16x32_bf16 v[248:251], v[140:143], v[60:63], v[248:251]
    ds_write_b128 v126, v[24:27] offset:32768
    ds_write_b128 v127, v[28:31] offset:32768
    v_mfma_f32_16x16x32_bf16 v[252:255], v[204:207], v[60:63], v[252:255]
    s_waitcnt vmcnt(3)
    v_mfma_f32_16x16x32_bf16 v[184:187], v[144:147], v[32:35], v[184:187]
    buffer_load_dwordx4 v[48:51], v2, s[4:7], s34 offen offset:512 sc1
    s_sub_u32 s34, s34, 24576
    v_mfma_f32_16x16x32_bf16 v[188:191], v[208:211], v[32:35], v[188:191]
    s_waitcnt lgkmcnt(0)
    s_barrier
    v_mfma_f32_16x16x32_bf16 v[248:251], v[148:151], v[32:35], v[248:251]
    v_mfma_f32_16x16x32_bf16 v[252:255], v[212:215], v[32:35], v[252:255]
    s_waitcnt vmcnt(3)
    v_mfma_f32_16x16x32_bf16 v[184:187], v[152:155], v[36:39], v[184:187]
    buffer_load_dwordx4 v[52:55], v2, s[4:7], s34 offen offset:768 sc1
    s_add_u32 s34, s34, 4096
    v_mfma_f32_16x16x32_bf16 v[188:191], v[216:219], v[36:39], v[188:191]
    ds_read_b128 v[80:83], v7 offset:0
    ds_read_b128 v[84:87], v7 offset:4096
    ds_read_b128 v[88:91], v7 offset:8192
    v_mfma_f32_16x16x32_bf16 v[248:251], v[156:159], v[36:39], v[248:251]
    ds_read_b128 v[92:95], v7 offset:12288
    ds_read_b128 v[104:107], v7 offset:16384
    ds_read_b128 v[108:111], v7 offset:20480
    v_mfma_f32_16x16x32_bf16 v[252:255], v[220:223], v[36:39], v[252:255]
    ds_read_b128 v[112:115], v7 offset:24576
    ds_read_b128 v[116:119], v7 offset:28672
    s_waitcnt vmcnt(3)
    v_mfma_f32_16x16x32_bf16 v[184:187], v[160:163], v[40:43], v[184:187]
    buffer_load_dwordx4 v[56:59], v2, s[4:7], s34 offen offset:768 sc1
    s_add_u32 s34, s34, 4096
    v_mfma_f32_16x16x32_bf16 v[188:191], v[224:227], v[40:43], v[188:191]
    s_waitcnt lgkmcnt(0)
    v_add_f32 v80, v80, v84
    v_add_f32 v81, v81, v85
    v_add_f32 v82, v82, v86
    v_mfma_f32_16x16x32_bf16 v[248:251], v[164:167], v[40:43], v[248:251]
    v_add_f32 v83, v83, v87
    v_add_f32 v88, v88, v92
    v_add_f32 v89, v89, v93
    v_add_f32 v90, v90, v94
    v_mfma_f32_16x16x32_bf16 v[252:255], v[228:231], v[40:43], v[252:255]
    v_add_f32 v91, v91, v95
    v_add_f32 v104, v104, v108
    v_add_f32 v105, v105, v109
    s_waitcnt vmcnt(3)
    v_mfma_f32_16x16x32_bf16 v[184:187], v[168:171], v[44:47], v[184:187]
    buffer_load_dwordx4 v[60:63], v2, s[4:7], s34 offen offset:768 sc1
    s_add_u32 s34, s34, 4096
    v_mfma_f32_16x16x32_bf16 v[188:191], v[232:235], v[44:47], v[188:191]
    v_add_f32 v106, v106, v110
    v_add_f32 v107, v107, v111
    v_add_f32 v112, v112, v116
    v_add_f32 v113, v113, v117
    v_mfma_f32_16x16x32_bf16 v[248:251], v[172:175], v[44:47], v[248:251]
    v_add_f32 v114, v114, v118
    v_add_f32 v115, v115, v119
    v_add_f32 v80, v80, v88
    v_add_f32 v81, v81, v89
    v_mfma_f32_16x16x32_bf16 v[252:255], v[236:239], v[44:47], v[252:255]
    v_add_f32 v82, v82, v90
    v_add_f32 v83, v83, v91
    v_add_f32 v104, v104, v112
    s_waitcnt vmcnt(3)
    v_mfma_f32_16x16x32_bf16 v[184:187], v[176:179], v[48:51], v[184:187]
    buffer_load_dwordx4 v[32:35], v2, s[4:7], s34 offen offset:768 sc1
    s_add_u32 s34, s34, 4096
    v_mfma_f32_16x16x32_bf16 v[188:191], v[240:243], v[48:51], v[188:191]
    v_add_f32 v105, v105, v113
    v_add_f32 v106, v106, v114
    v_add_f32 v107, v107, v115
    v_add_f32 v80, v80, v104
    v_mfma_f32_16x16x32_bf16 v[248:251], v[180:183], v[48:51], v[248:251]
    v_add_f32 v81, v81, v105
    v_add_f32 v82, v82, v106
    v_add_f32 v83, v83, v107
    v_cvt_pk_bf16_f32 v84, v80, v81
    v_mfma_f32_16x16x32_bf16 v[252:255], v[244:247], v[48:51], v[252:255]
    v_cvt_pk_bf16_f32 v85, v82, v83
    buffer_store_dwordx2 v[84:85], v5, s[12:15], s24 offen nt
    s_add_u32 s24, s24, 32768
    s_waitcnt vmcnt(4)
    v_mfma_f32_16x16x32_bf16 v[16:19], v[128:131], v[52:55], v[76:79]
    buffer_load_dwordx4 v[36:39], v2, s[4:7], s34 offen offset:768 sc1
    s_add_u32 s34, s34, 4096
    v_mfma_f32_16x16x32_bf16 v[20:23], v[192:195], v[52:55], 0
    v_mfma_f32_16x16x32_bf16 v[24:27], v[132:135], v[52:55], 0
    v_mfma_f32_16x16x32_bf16 v[28:31], v[196:199], v[52:55], 0
    s_waitcnt vmcnt(4)
    v_mfma_f32_16x16x32_bf16 v[16:19], v[136:139], v[56:59], v[16:19]
    buffer_load_dwordx4 v[40:43], v2, s[4:7], s34 offen offset:768 sc1
    s_add_u32 s34, s34, 4096
    v_mfma_f32_16x16x32_bf16 v[20:23], v[200:203], v[56:59], v[20:23]
    v_add_u32 v124, 0x10000, v124
    ds_write_b128 v124, v[184:187] offset:0
    v_add_u32 v125, 0x10000, v125
    v_mfma_f32_16x16x32_bf16 v[24:27], v[140:143], v[56:59], v[24:27]
    ds_write_b128 v125, v[188:191] offset:0
    v_add_u32 v126, 0x10000, v126
    ds_write_b128 v126, v[248:251] offset:0
    v_mfma_f32_16x16x32_bf16 v[28:31], v[204:207], v[56:59], v[28:31]
    v_add_u32 v127, 0x10000, v127
    ds_write_b128 v127, v[252:255] offset:0
    s_waitcnt vmcnt(4)
    v_mfma_f32_16x16x32_bf16 v[16:19], v[144:147], v[60:63], v[16:19]
    buffer_load_dwordx4 v[44:47], v2, s[4:7], s34 offen offset:768 sc1
    s_sub_u32 s34, s34, 24576
    v_mfma_f32_16x16x32_bf16 v[20:23], v[208:211], v[60:63], v[20:23]
    v_mfma_f32_16x16x32_bf16 v[24:27], v[148:151], v[60:63], v[24:27]
    v_mfma_f32_16x16x32_bf16 v[28:31], v[212:215], v[60:63], v[28:31]
    s_waitcnt vmcnt(4)
    v_mfma_f32_16x16x32_bf16 v[16:19], v[152:155], v[32:35], v[16:19]
    v_mfma_f32_16x16x32_bf16 v[20:23], v[216:219], v[32:35], v[20:23]
    v_mfma_f32_16x16x32_bf16 v[24:27], v[156:159], v[32:35], v[24:27]
    v_mfma_f32_16x16x32_bf16 v[28:31], v[220:223], v[32:35], v[28:31]
    s_waitcnt vmcnt(2)
    v_mfma_f32_16x16x32_bf16 v[16:19], v[160:163], v[36:39], v[16:19]
    v_mfma_f32_16x16x32_bf16 v[20:23], v[224:227], v[36:39], v[20:23]
    v_mfma_f32_16x16x32_bf16 v[24:27], v[164:167], v[36:39], v[24:27]
    v_mfma_f32_16x16x32_bf16 v[28:31], v[228:231], v[36:39], v[28:31]
    s_waitcnt vmcnt(1)
    v_mfma_f32_16x16x32_bf16 v[16:19], v[168:171], v[40:43], v[16:19]
    v_mfma_f32_16x16x32_bf16 v[20:23], v[232:235], v[40:43], v[20:23]
    v_mfma_f32_16x16x32_bf16 v[24:27], v[172:175], v[40:43], v[24:27]
    v_mfma_f32_16x16x32_bf16 v[28:31], v[236:239], v[40:43], v[28:31]
    s_waitcnt vmcnt(0)
    v_mfma_f32_16x16x32_bf16 v[16:19], v[176:179], v[44:47], v[16:19]
    v_mfma_f32_16x16x32_bf16 v[20:23], v[240:243], v[44:47], v[20:23]
    v_mfma_f32_16x16x32_bf16 v[24:27], v[180:183], v[44:47], v[24:27]
    v_mfma_f32_16x16x32_bf16 v[28:31], v[244:247], v[44:47], v[28:31]
    s_nop 4
    ds_write_b128 v124, v[16:19] offset:32768
    ds_write_b128 v125, v[20:23] offset:32768
    ds_write_b128 v126, v[24:27] offset:32768
    ds_write_b128 v127, v[28:31] offset:32768
    s_waitcnt lgkmcnt(0)
    s_barrier
    v_add_u32 v7, 0x10000, v7
    ds_read_b128 v[80:83], v7 offset:0
    ds_read_b128 v[84:87], v7 offset:4096
    ds_read_b128 v[88:91], v7 offset:8192
    ds_read_b128 v[92:95], v7 offset:12288
    ds_read_b128 v[104:107], v7 offset:16384
    ds_read_b128 v[108:111], v7 offset:20480
    ds_read_b128 v[112:115], v7 offset:24576
    ds_read_b128 v[116:119], v7 offset:28672
    s_waitcnt lgkmcnt(0)
    v_pk_add_f32 v[80:81], v[80:81], v[84:85]
    v_pk_add_f32 v[82:83], v[82:83], v[86:87]
    v_pk_add_f32 v[88:89], v[88:89], v[92:93]
    v_pk_add_f32 v[90:91], v[90:91], v[94:95]
    v_pk_add_f32 v[104:105], v[104:105], v[108:109]
    v_pk_add_f32 v[106:107], v[106:107], v[110:111]
    v_pk_add_f32 v[112:113], v[112:113], v[116:117]
    v_pk_add_f32 v[114:115], v[114:115], v[118:119]
    v_pk_add_f32 v[80:81], v[80:81], v[88:89]
    v_pk_add_f32 v[82:83], v[82:83], v[90:91]
    v_pk_add_f32 v[104:105], v[104:105], v[112:113]
    v_pk_add_f32 v[106:107], v[106:107], v[114:115]
    v_pk_add_f32 v[80:81], v[80:81], v[104:105]
    v_pk_add_f32 v[82:83], v[82:83], v[106:107]
    v_cvt_pk_bf16_f32 v84, v80, v81
    v_cvt_pk_bf16_f32 v85, v82, v83
    buffer_store_dwordx2 v[84:85], v5, s[12:15], s24 offen nt
    s_add_u32 s24, s24, 32768
M_H_5:
    s_endpgm
L_cs_35:
    buffer_store_dwordx2 v[8:9], v3, s[4:7], s24 offen offset:0 sc1
    buffer_store_dwordx2 v[10:11], v3, s[4:7], s24 offen offset:256 sc1
    buffer_store_dwordx2 v[12:13], v3, s[4:7], s24 offen offset:512 sc1
    buffer_store_dwordx2 v[14:15], v3, s[4:7], s24 offen offset:768 sc1
    s_branch L_ce_36
L_cs_37:
    buffer_store_dword v6, v4, s[4:7], s20 offen sc1
    s_branch L_ce_38
L_cs_46:
    buffer_store_dwordx2 v[8:9], v3, s[4:7], s24 offen offset:0 sc1
    buffer_store_dwordx2 v[14:15], v3, s[4:7], s24 offen offset:768 sc1
    s_branch L_ce_47
L_cs_48:
    buffer_store_dwordx2 v[10:11], v3, s[4:7], s24 offen offset:256 sc1
    buffer_store_dwordx2 v[12:13], v3, s[4:7], s24 offen offset:512 sc1
    s_branch L_ce_49
L_cs_50:
    buffer_store_dword v6, v4, s[4:7], s20 offen sc1
    s_branch L_ce_51
L_cs_59:
    buffer_store_dwordx2 v[8:9], v3, s[4:7], s24 offen offset:0 sc1
    buffer_store_dwordx2 v[10:11], v3, s[4:7], s24 offen offset:256 sc1
    buffer_store_dwordx2 v[12:13], v3, s[4:7], s24 offen offset:512 sc1
    buffer_store_dwordx2 v[14:15], v3, s[4:7], s24 offen offset:768 sc1
    s_branch L_ce_60
L_cs_61:
    buffer_store_dword v6, v4, s[4:7], s20 offen sc1
    s_branch L_ce_62
L_cs_80:
    buffer_store_dwordx2 v[8:9], v98, s[4:7], s32 offen offset:0 sc1
    buffer_store_dwordx2 v[10:11], v98, s[4:7], s33 offen offset:0 sc1
    s_branch L_ce_81
L_cs_82:
    buffer_store_dwordx2 v[12:13], v99, s[4:7], s32 offen offset:0 sc1
    s_branch L_ce_83
L_cs_84:
    buffer_store_dword v6, v4, s[4:7], s20 offen sc1
    s_branch L_ce_85
L_cs_86:
    buffer_store_dwordx2 v[8:9], v98, s[4:7], s32 offen offset:512 sc1
    buffer_store_dwordx2 v[10:11], v98, s[4:7], s33 offen offset:512 sc1
    s_branch L_ce_87
L_cs_88:
    buffer_store_dwordx2 v[12:13], v99, s[4:7], s32 offen offset:512 sc1
    s_branch L_ce_89
L_cs_98:
    buffer_store_dword v6, v4, s[4:7], s20 offen sc1
    s_branch L_ce_99
L_bre_101:
    s_add_u32 s29, s29, 1
    s_cmp_gt_u32 s29, 262144
    s_cbranch_scc1 main_exit
    buffer_load_dword v102, v96, s[4:7], s20 offen sc1
    s_waitcnt vmcnt(0)
    s_branch L_bchk_100
.p2align 8
C_entry:
    s_and_b32 s5, s5, 0xffff
    s_and_b32 s13, s13, 0xffff
    v_lshrrev_b32 v161, 4, v0
    v_and_b32 v162, 0xff, v1
    v_lshl_add_u32 v156, v161, 14, v162
    v_lshrrev_b32 v159, 3, v0
    v_and_b32 v160, 0x7f, v1
    v_lshl_add_u32 v152, v159, 10, v160
    v_mul_u32_u24 v153, 3584, v159
    v_add_u32 v153, v153, v160
    s_mul_i32 s21, s2, 2341
    s_lshr_b32 s21, s21, 16
    s_mul_i32 s22, s21, 28
    s_sub_u32 s22, s2, s22
    s_lshl_b32 s23, s21, 2
    s_add_u32 s23, s23, s3
    s_mul_i32 s60, s23, 28672
    s_lshl_b32 s23, s22, 7
    s_add_u32 s60, s60, s23
    s_lshl_b32 s22, s22, 6
    s_add_u32 s22, s22, s21
    s_lshl_b32 s65, s22, 10
    s_lshl_b32 s23, s3, 8
    s_add_u32 s65, s65, s23
    s_add_u32 s65, s65, 0x1600000
    s_lshr_b32 s21, s2, 3
    s_and_b32 s22, s2, 7
    s_lshl_b32 s61, s21, 15
    s_lshl_b32 s23, s22, 7
    s_add_u32 s61, s61, s23
    s_lshl_b32 s23, s3, 13
    s_add_u32 s61, s61, s23
    s_mul_i32 s22, s22, 56
    s_add_u32 s22, s22, s21
    s_lshl_b32 s22, s22, 2
    s_mul_i32 s21, s21, 9363
    s_lshr_b32 s21, s21, 16
    v_subrev_u32 v157, s21, v161
    v_and_b32 v157, 3, v157
    v_lshl_add_u32 v157, v157, 10, v162
    s_lshl_b32 s66, s22, 10
    s_lshl_b32 s23, s3, 8
    s_add_u32 s66, s66, s23
    s_add_u32 s66, s66, 0x17c0000
    s_cmp_ge_u32 s2, 192
    s_cbranch_scc1 L_pwo_1
    s_add_u32 s20, s2, 256
    s_mul_i32 s21, s20, 2341
    s_lshr_b32 s21, s21, 16
    s_mul_i32 s22, s21, 28
    s_sub_u32 s22, s20, s22
    s_lshl_b32 s23, s21, 2
    s_add_u32 s23, s23, s3
    s_mul_i32 s62, s23, 28672
    s_lshl_b32 s23, s22, 7
    s_add_u32 s62, s62, s23
    s_lshl_b32 s22, s22, 6
    s_add_u32 s22, s22, s21
    s_lshl_b32 s67, s22, 10
    s_lshl_b32 s23, s3, 8
    s_add_u32 s67, s67, s23
    s_add_u32 s67, s67, 0x1600000
    s_lshr_b32 s21, s20, 3
    s_and_b32 s22, s20, 7
    s_lshl_b32 s63, s21, 15
    s_lshl_b32 s23, s22, 7
    s_add_u32 s63, s63, s23
    s_lshl_b32 s23, s3, 13
    s_add_u32 s63, s63, s23
    s_mul_i32 s22, s22, 56
    s_add_u32 s22, s22, s21
    s_lshl_b32 s22, s22, 2
    s_mul_i32 s21, s21, 9363
    s_lshr_b32 s21, s21, 16
    v_subrev_u32 v158, s21, v161
    v_and_b32 v158, 3, v158
    v_lshl_add_u32 v158, v158, 10, v162
    s_lshl_b32 s68, s22, 10
    s_lshl_b32 s23, s3, 8
    s_add_u32 s68, s68, s23
    s_add_u32 s68, s68, 0x17c0000
    v_mov_b32 v154, v153
    v_mov_b32 v155, v152
    s_branch L_pend_2
L_pwo_1:
    s_sub_u32 s20, s2, 192
    s_lshr_b32 s21, s20, 3
    s_and_b32 s22, s20, 7
    s_lshl_b32 s62, s21, 15
    s_lshl_b32 s23, s22, 7
    s_add_u32 s62, s62, s23
    s_lshl_b32 s22, s22, 6
    s_add_u32 s22, s22, s21
    s_lshl_b32 s67, s22, 10
    s_lshl_b32 s23, s3, 8
    s_add_u32 s67, s67, s23
    s_add_u32 s67, s67, 0x1480000
    s_sub_u32 s20, s2, 128
    s_lshr_b32 s21, s20, 3
    s_and_b32 s22, s20, 7
    s_lshl_b32 s63, s21, 15
    s_lshl_b32 s23, s22, 7
    s_add_u32 s63, s63, s23
    s_lshl_b32 s22, s22, 6
    s_add_u32 s22, s22, s21
    s_lshl_b32 s68, s22, 10
    s_lshl_b32 s23, s3, 8
    s_add_u32 s68, s68, s23
    s_add_u32 s68, s68, 0x1480000
    s_lshr_b32 s21, s3, 1
    s_lshl_b32 s21, s21, 4
    s_and_b32 s22, s3, 1
    s_lshl_b32 s22, s22, 2
    s_add_u32 s21, s21, s22
    v_and_b32 v154, 4, v159
    v_add3_u32 v154, v154, v159, s21
    v_lshl_add_u32 v154, v154, 10, v160
    v_mov_b32 v155, v154
    v_mov_b32 v158, v156
L_pend_2:
    s_and_b32 s20, s2, 127
    s_lshr_b32 s21, s20, 3
    s_and_b32 s22, s20, 7
    s_lshl_b32 s64, s21, 15
    s_lshl_b32 s23, s22, 7
    s_add_u32 s64, s64, s23
    s_lshl_b32 s23, s3, 13
    s_add_u32 s64, s64, s23
    s_lshl_b32 s22, s22, 6
    s_add_u32 s22, s22, s21
    s_lshl_b32 s69, s22, 10
    s_lshl_b32 s23, s3, 8
    s_add_u32 s69, s69, s23
    s_add_u32 s69, s69, 0x1500000
    s_lshr_b32 s20, s2, 7
    s_lshl_b32 s20, s20, 19
    s_add_u32 s69, s69, s20
    s_mul_i32 s20, s3, 5120
    s_add_u32 s20, s20, 20480
    v_add_u32 v159, s20, v1
    v_bfe_u32 v160, v0, 2, 2
    v_lshlrev_b32 v160, 7, v160
    v_lshl_add_u32 v160, v161, 5, v160
    v_and_b32 v161, 3, v0
    v_lshl_add_u32 v160, v161, 3, v160
    v_add_u32 v160, s20, v160
    s_mov_b64 s[56:57], s[52:53]
    s_mov_b32 s58, 0x1c0000
    s_and_b32 s57, s57, 0xffff
    buffer_load_dwordx4 v[164:167], v153, s[56:59], s60 offen
    s_mov_b64 s[56:57], s[54:55]
    s_mov_b32 s58, 0x1c0000
    s_and_b32 s57, s57, 0xffff
    buffer_load_dwordx4 v[168:171], v152, s[56:59], s61 offen
    s_mov_b32 s21, 0x80000
    s_cmp_ge_u32 s2, 192
    s_cselect_b64 s[56:57], s[46:47], s[52:53]
    s_cselect_b32 s58, s21, 0x1c0000
    s_and_b32 s57, s57, 0xffff
    buffer_load_dwordx4 v[172:175], v154, s[56:59], s62 offen
    s_mov_b32 s21, 0x80000
    s_cmp_ge_u32 s2, 192
    s_cselect_b64 s[56:57], s[46:47], s[54:55]
    s_cselect_b32 s58, s21, 0x1c0000
    s_and_b32 s57, s57, 0xffff
    buffer_load_dwordx4 v[176:179], v155, s[56:59], s63 offen
    s_cmp_ge_u32 s2, 128
    s_cselect_b64 s[56:57], s[50:51], s[48:49]
    s_mov_b32 s58, 0x80000
    s_and_b32 s57, s57, 0xffff
    buffer_load_dwordx4 v[180:183], v152, s[56:59], s64 offen
    s_mov_b32 s14, 0x200000
    s_mov_b32 s15, 0x20000
    s_getreg_b32 s45, hwreg(HW_REG_XCC_ID, 0, 3)
    v_and_b32 v6, 15, v0
    v_lshrrev_b32 v7, 4, v0
    v_lshlrev_b32 v2, 10, v7
    v_lshl_add_u32 v2, v6, 4, v2
    v_add_u32 v2, 65536, v2
    v_lshrrev_b32 v3, 1, v7
    v_lshlrev_b32 v3, 10, v3
    v_lshl_add_u32 v3, v6, 4, v3
    v_and_b32 v8, 1, v7
    v_lshl_add_u32 v3, v8, 3, v3
    s_lshl_b32 s20, s38, 2
    v_mov_b32 v4, s20
    s_lshl_b32 s30, s16, 8
    s_add_u32 s30, s30, 0x19a0000
    v_lshlrev_b32 v8, 10, v6
    v_lshl_add_u32 v5, v7, 3, v8
    s_and_b32 s39, s3, 1
    s_lshl_b32 s39, s39, 8
    v_lshrrev_b32 v7, 4, v0
    v_and_b32 v8, 7, v0
    v_xor_b32 v8, v8, v7
    v_lshlrev_b32 v8, 4, v8
    v_lshl_add_u32 v130, v6, 7, v8
    v_add_u32 v130, 32768, v130
    v_xor_b32 v131, 64, v130
    v_bfe_u32 v8, v0, 2, 2
    v_lshl_add_u32 v132, v7, 3, v8
    v_lshlrev_b32 v132, 7, v132
    v_and_b32 v7, 1, v7
    v_lshrrev_b32 v8, 1, v8
    v_lshl_add_u32 v7, v7, 1, v8
    v_xor_b32 v7, s3, v7
    v_lshl_add_u32 v132, v7, 5, v132
    v_and_b32 v8, 3, v0
    v_lshl_add_u32 v132, v8, 3, v132
    v_add_u32 v132, 98304, v132
    v_lshlrev_b32 v133, 3, v6
    v_mov_b32 v136, 0x3f803f80
    v_mov_b32 v137, 0x3f803f80
    v_mov_b32 v138, 0x3f803f80
    v_mov_b32 v139, 0x3f803f80
    s_mov_b32 s40, 0xffff
    s_mov_b32 s41, 0xffff
    v_mov_b32 v13, 0xdddddddd
    v_mov_b32 v14, v1
    v_lshrrev_b32 v8, 5, v0
    v_lshlrev_b32 v8, 8, v8
    v_and_b32 v9, 0xff, v1
    v_add_u32 v15, v9, v8
    v_mov_b32 v72, 0
    v_mov_b32 v73, 0
    v_mov_b32 v74, 0
    v_mov_b32 v75, 0
    v_mov_b32 v76, 0
    v_mov_b32 v77, 0
    v_mov_b32 v78, 0
    v_mov_b32 v79, 0
    v_mov_b32 v80, 0
    v_mov_b32 v81, 0
    v_mov_b32 v82, 0
    v_mov_b32 v83, 0
    v_mov_b32 v84, 0
    v_mov_b32 v85, 0
    v_mov_b32 v86, 0
    v_mov_b32 v87, 0
    v_mov_b32 v88, 0
    v_mov_b32 v89, 0
    v_mov_b32 v90, 0
    v_mov_b32 v91, 0
    v_mov_b32 v92, 0
    v_mov_b32 v93, 0
    v_mov_b32 v94, 0
    v_mov_b32 v95, 0
    v_mov_b32 v96, 0
    v_mov_b32 v97, 0
    v_mov_b32 v98, 0
    v_mov_b32 v99, 0
    v_mov_b32 v100, 0
    v_mov_b32 v101, 0
    v_mov_b32 v102, 0
    v_mov_b32 v103, 0
    v_and_b32 v8, 31, v0
    v_cmp_eq_u32 vcc, 16, v8
    v_mov_b32 v8, 0x3f803f80
    s_nop 0
    v_cndmask_b32 v108, 0, v8, vcc
    v_cndmask_b32 v109, 0, v8, vcc
    v_cndmask_b32 v110, 0, v8, vcc
    v_cndmask_b32 v111, 0, v8, vcc
    v_cndmask_b32 v112, 0, v8, vcc
    v_cndmask_b32 v113, 0, v8, vcc
    v_cndmask_b32 v114, 0, v8, vcc
    v_cndmask_b32 v115, 0, v8, vcc
    v_cndmask_b32 v120, 0, v8, vcc
    v_cndmask_b32 v121, 0, v8, vcc
    v_cndmask_b32 v122, 0, v8, vcc
    v_cndmask_b32 v123, 0, v8, vcc
    v_cndmask_b32 v124, 0, v8, vcc
    v_cndmask_b32 v125, 0, v8, vcc
    v_cndmask_b32 v126, 0, v8, vcc
    v_cndmask_b32 v127, 0, v8, vcc
    s_waitcnt vmcnt(5)
    s_barrier
    ds_read_b64_tr_b16 v[192:193], v132 offset:0
    ds_read_b64_tr_b16 v[194:195], v132 offset:512
    ds_read_b64_tr_b16 v[196:197], v132 offset:4096
    ds_read_b64_tr_b16 v[198:199], v132 offset:4608
    ds_read_b128 v[40:43], v130 offset:0
    ds_read_b128 v[44:47], v130 offset:2048
    ds_read_b128 v[48:51], v130 offset:4096
    ds_read_b128 v[52:55], v130 offset:6144
    ds_read_b128 v[56:59], v131 offset:0
    ds_read_b128 v[60:63], v131 offset:2048
    ds_read_b128 v[64:67], v131 offset:4096
    ds_read_b128 v[68:71], v131 offset:6144
    ds_read_b64_tr_b16 v[200:201], v132 offset:8192
    ds_read_b64_tr_b16 v[202:203], v132 offset:8704
    ds_read_b64_tr_b16 v[204:205], v132 offset:12288
    ds_read_b64_tr_b16 v[206:207], v132 offset:12800
    s_waitcnt lgkmcnt(10)
    v_mfma_f32_16x16x32_bf16 v[24:27], v[192:195], v[40:43], 0
    ds_read_b128 v[40:43], v130 offset:8192
    v_mfma_f32_16x16x32_bf16 v[140:143], v[192:195], v[136:139], 0
    v_mfma_f32_16x16x32_bf16 v[28:31], v[192:195], v[44:47], 0
    ds_read_b128 v[44:47], v130 offset:10240
    v_mfma_f32_16x16x32_bf16 v[140:143], v[196:199], v[136:139], v[140:143]
    s_waitcnt lgkmcnt(10)
    v_mfma_f32_16x16x32_bf16 v[32:35], v[192:195], v[48:51], 0
    ds_read_b128 v[48:51], v130 offset:12288
    v_mfma_f32_16x16x32_bf16 v[36:39], v[192:195], v[52:55], 0
    ds_read_b128 v[52:55], v130 offset:14336
    s_waitcnt lgkmcnt(10)
    v_mfma_f32_16x16x32_bf16 v[24:27], v[196:199], v[56:59], v[24:27]
    ds_read_b128 v[56:59], v131 offset:8192
    v_mfma_f32_16x16x32_bf16 v[28:31], v[196:199], v[60:63], v[28:31]
    ds_read_b128 v[60:63], v131 offset:10240
    s_waitcnt lgkmcnt(10)
    v_mfma_f32_16x16x32_bf16 v[32:35], v[196:199], v[64:67], v[32:35]
    ds_read_b128 v[64:67], v131 offset:12288
    v_mfma_f32_16x16x32_bf16 v[36:39], v[196:199], v[68:71], v[36:39]
    ds_read_b128 v[68:71], v131 offset:14336
    ds_read_b64_tr_b16 v[208:209], v132 offset:16384
    ds_read_b64_tr_b16 v[210:211], v132 offset:16896
    ds_read_b64_tr_b16 v[212:213], v132 offset:20480
    ds_read_b64_tr_b16 v[214:215], v132 offset:20992
    s_waitcnt lgkmcnt(10)
    v_mfma_f32_16x16x32_bf16 v[24:27], v[200:203], v[40:43], v[24:27]
    ds_read_b128 v[40:43], v130 offset:16384
    v_mfma_f32_16x16x32_bf16 v[140:143], v[200:203], v[136:139], v[140:143]
    v_mfma_f32_16x16x32_bf16 v[28:31], v[200:203], v[44:47], v[28:31]
    ds_read_b128 v[44:47], v130 offset:18432
    v_mfma_f32_16x16x32_bf16 v[140:143], v[204:207], v[136:139], v[140:143]
    s_waitcnt lgkmcnt(10)
    v_mfma_f32_16x16x32_bf16 v[32:35], v[200:203], v[48:51], v[32:35]
    ds_read_b128 v[48:51], v130 offset:20480
    v_mfma_f32_16x16x32_bf16 v[36:39], v[200:203], v[52:55], v[36:39]
    ds_read_b128 v[52:55], v130 offset:22528
    s_waitcnt lgkmcnt(10)
    v_mfma_f32_16x16x32_bf16 v[24:27], v[204:207], v[56:59], v[24:27]
    ds_read_b128 v[56:59], v131 offset:16384
    v_mfma_f32_16x16x32_bf16 v[28:31], v[204:207], v[60:63], v[28:31]
    ds_read_b128 v[60:63], v131 offset:18432
    s_waitcnt lgkmcnt(10)
    v_mfma_f32_16x16x32_bf16 v[32:35], v[204:207], v[64:67], v[32:35]
    ds_read_b128 v[64:67], v131 offset:20480
    v_mfma_f32_16x16x32_bf16 v[36:39], v[204:207], v[68:71], v[36:39]
    ds_read_b128 v[68:71], v131 offset:22528
    ds_read_b64_tr_b16 v[216:217], v132 offset:24576
    ds_read_b64_tr_b16 v[218:219], v132 offset:25088
    ds_read_b64_tr_b16 v[220:221], v132 offset:28672
    ds_read_b64_tr_b16 v[222:223], v132 offset:29184
    s_waitcnt lgkmcnt(10)
    v_mfma_f32_16x16x32_bf16 v[24:27], v[208:211], v[40:43], v[24:27]
    ds_read_b128 v[40:43], v130 offset:24576
    v_mfma_f32_16x16x32_bf16 v[140:143], v[208:211], v[136:139], v[140:143]
    v_mfma_f32_16x16x32_bf16 v[28:31], v[208:211], v[44:47], v[28:31]
    ds_read_b128 v[44:47], v130 offset:26624
    v_mfma_f32_16x16x32_bf16 v[140:143], v[212:215], v[136:139], v[140:143]
    s_waitcnt lgkmcnt(10)
    v_mfma_f32_16x16x32_bf16 v[32:35], v[208:211], v[48:51], v[32:35]
    ds_read_b128 v[48:51], v130 offset:28672
    v_mfma_f32_16x16x32_bf16 v[36:39], v[208:211], v[52:55], v[36:39]
    ds_read_b128 v[52:55], v130 offset:30720
    s_waitcnt lgkmcnt(10)
    v_mfma_f32_16x16x32_bf16 v[24:27], v[212:215], v[56:59], v[24:27]
    ds_read_b128 v[56:59], v131 offset:24576
    v_mfma_f32_16x16x32_bf16 v[28:31], v[212:215], v[60:63], v[28:31]
    ds_read_b128 v[60:63], v131 offset:26624
    s_waitcnt lgkmcnt(10)
    v_mfma_f32_16x16x32_bf16 v[32:35], v[212:215], v[64:67], v[32:35]
    ds_read_b128 v[64:67], v131 offset:28672
    v_mfma_f32_16x16x32_bf16 v[36:39], v[212:215], v[68:71], v[36:39]
    ds_read_b128 v[68:71], v131 offset:30720
    ds_read_b64_tr_b16 v[224:225], v132 offset:32768
    ds_read_b64_tr_b16 v[226:227], v132 offset:33280
    ds_read_b64_tr_b16 v[228:229], v132 offset:36864
    ds_read_b64_tr_b16 v[230:231], v132 offset:37376
    s_waitcnt lgkmcnt(10)
    v_mfma_f32_16x16x32_bf16 v[24:27], v[216:219], v[40:43], v[24:27]
    ds_read_b128 v[40:43], v130 offset:32768
    v_mfma_f32_16x16x32_bf16 v[140:143], v[216:219], v[136:139], v[140:143]
    v_mfma_f32_16x16x32_bf16 v[28:31], v[216:219], v[44:47], v[28:31]
    ds_read_b128 v[44:47], v130 offset:34816
    v_mfma_f32_16x16x32_bf16 v[140:143], v[220:223], v[136:139], v[140:143]
    s_waitcnt lgkmcnt(10)
    v_mfma_f32_16x16x32_bf16 v[32:35], v[216:219], v[48:51], v[32:35]
    ds_read_b128 v[48:51], v130 offset:36864
    v_mfma_f32_16x16x32_bf16 v[36:39], v[216:219], v[52:55], v[36:39]
    ds_read_b128 v[52:55], v130 offset:38912
    s_waitcnt lgkmcnt(10)
    v_mfma_f32_16x16x32_bf16 v[24:27], v[220:223], v[56:59], v[24:27]
    ds_read_b128 v[56:59], v131 offset:32768
    v_mfma_f32_16x16x32_bf16 v[28:31], v[220:223], v[60:63], v[28:31]
    ds_read_b128 v[60:63], v131 offset:34816
    s_waitcnt lgkmcnt(10)
    v_mfma_f32_16x16x32_bf16 v[32:35], v[220:223], v[64:67], v[32:35]
    ds_read_b128 v[64:67], v131 offset:36864
    v_mfma_f32_16x16x32_bf16 v[36:39], v[220:223], v[68:71], v[36:39]
    ds_read_b128 v[68:71], v131 offset:38912
    ds_read_b64_tr_b16 v[232:233], v132 offset:40960
    ds_read_b64_tr_b16 v[234:235], v132 offset:41472
    ds_read_b64_tr_b16 v[236:237], v132 offset:45056
    ds_read_b64_tr_b16 v[238:239], v132 offset:45568
    s_waitcnt lgkmcnt(10)
    v_mfma_f32_16x16x32_bf16 v[24:27], v[224:227], v[40:43], v[24:27]
    ds_read_b128 v[40:43], v130 offset:40960
    v_mfma_f32_16x16x32_bf16 v[140:143], v[224:227], v[136:139], v[140:143]
    v_mfma_f32_16x16x32_bf16 v[28:31], v[224:227], v[44:47], v[28:31]
    ds_read_b128 v[44:47], v130 offset:43008
    v_mfma_f32_16x16x32_bf16 v[140:143], v[228:231], v[136:139], v[140:143]
    s_waitcnt lgkmcnt(10)
    v_mfma_f32_16x16x32_bf16 v[32:35], v[224:227], v[48:51], v[32:35]
    ds_read_b128 v[48:51], v130 offset:45056
    v_mfma_f32_16x16x32_bf16 v[36:39], v[224:227], v[52:55], v[36:39]
    ds_read_b128 v[52:55], v130 offset:47104
    s_waitcnt lgkmcnt(10)
    v_mfma_f32_16x16x32_bf16 v[24:27], v[228:231], v[56:59], v[24:27]
    ds_read_b128 v[56:59], v131 offset:40960
    v_mfma_f32_16x16x32_bf16 v[28:31], v[228:231], v[60:63], v[28:31]
    ds_read_b128 v[60:63], v131 offset:43008
    s_waitcnt lgkmcnt(10)
    v_mfma_f32_16x16x32_bf16 v[32:35], v[228:231], v[64:67], v[32:35]
    ds_read_b128 v[64:67], v131 offset:45056
    v_mfma_f32_16x16x32_bf16 v[36:39], v[228:231], v[68:71], v[36:39]
    ds_read_b128 v[68:71], v131 offset:47104
    ds_read_b64_tr_b16 v[240:241], v132 offset:49152
    ds_read_b64_tr_b16 v[242:243], v132 offset:49664
    ds_read_b64_tr_b16 v[244:245], v132 offset:53248
    ds_read_b64_tr_b16 v[246:247], v132 offset:53760
    s_waitcnt lgkmcnt(10)
    v_mfma_f32_16x16x32_bf16 v[24:27], v[232:235], v[40:43], v[24:27]
    ds_read_b128 v[40:43], v130 offset:49152
    v_mfma_f32_16x16x32_bf16 v[140:143], v[232:235], v[136:139], v[140:143]
    v_mfma_f32_16x16x32_bf16 v[28:31], v[232:235], v[44:47], v[28:31]
    ds_read_b128 v[44:47], v130 offset:51200
    v_mfma_f32_16x16x32_bf16 v[140:143], v[236:239], v[136:139], v[140:143]
    s_waitcnt lgkmcnt(10)
    v_mfma_f32_16x16x32_bf16 v[32:35], v[232:235], v[48:51], v[32:35]
    ds_read_b128 v[48:51], v130 offset:53248
    ds_read_b64 v[144:145], v133 offset:16384
    v_mfma_f32_16x16x32_bf16 v[36:39], v[232:235], v[52:55], v[36:39]
    ds_read_b128 v[52:55], v130 offset:55296
    ds_read_b64 v[146:147], v133 offset:16512
    s_waitcnt lgkmcnt(12)
    v_mfma_f32_16x16x32_bf16 v[24:27], v[236:239], v[56:59], v[24:27]
    ds_read_b128 v[56:59], v131 offset:49152
    ds_read_b64 v[148:149], v133 offset:16640
    v_mfma_f32_16x16x32_bf16 v[28:31], v[236:239], v[60:63], v[28:31]
    ds_read_b128 v[60:63], v131 offset:51200
    ds_read_b64 v[150:151], v133 offset:16768
    s_waitcnt lgkmcnt(14)
    v_mfma_f32_16x16x32_bf16 v[32:35], v[236:239], v[64:67], v[32:35]
    ds_read_b128 v[64:67], v131 offset:53248
    v_mfma_f32_16x16x32_bf16 v[36:39], v[236:239], v[68:71], v[36:39]
    ds_read_b128 v[68:71], v131 offset:55296
    ds_read_b64_tr_b16 v[248:249], v132 offset:57344
    ds_read_b64_tr_b16 v[250:251], v132 offset:57856
    ds_read_b64_tr_b16 v[252:253], v132 offset:61440
    ds_read_b64_tr_b16 v[254:255], v132 offset:61952
    s_waitcnt lgkmcnt(14)
    v_mfma_f32_16x16x32_bf16 v[24:27], v[240:243], v[40:43], v[24:27]
    ds_read_b128 v[40:43], v130 offset:57344
    v_mfma_f32_16x16x32_bf16 v[140:143], v[240:243], v[136:139], v[140:143]
    v_mfma_f32_16x16x32_bf16 v[28:31], v[240:243], v[44:47], v[28:31]
    ds_read_b128 v[44:47], v130 offset:59392
    v_mfma_f32_16x16x32_bf16 v[140:143], v[244:247], v[136:139], v[140:143]
    s_waitcnt lgkmcnt(13)
    v_mfma_f32_16x16x32_bf16 v[32:35], v[240:243], v[48:51], v[32:35]
    ds_read_b128 v[48:51], v130 offset:61440
    v_mfma_f32_16x16x32_bf16 v[36:39], v[240:243], v[52:55], v[36:39]
    ds_read_b128 v[52:55], v130 offset:63488
    s_waitcnt lgkmcnt(11)
    v_mfma_f32_16x16x32_bf16 v[24:27], v[244:247], v[56:59], v[24:27]
    ds_read_b128 v[56:59], v131 offset:57344
    v_mfma_f32_16x16x32_bf16 v[28:31], v[244:247], v[60:63], v[28:31]
    ds_read_b128 v[60:63], v131 offset:59392
    s_waitcnt lgkmcnt(10)
    v_mfma_f32_16x16x32_bf16 v[32:35], v[244:247], v[64:67], v[32:35]
    ds_read_b128 v[64:67], v131 offset:61440
    v_mfma_f32_16x16x32_bf16 v[36:39], v[244:247], v[68:71], v[36:39]
    ds_read_b128 v[68:71], v131 offset:63488
    s_waitcnt lgkmcnt(6)
    v_mfma_f32_16x16x32_bf16 v[24:27], v[248:251], v[40:43], v[24:27]
    v_mfma_f32_16x16x32_bf16 v[140:143], v[248:251], v[136:139], v[140:143]
    v_mfma_f32_16x16x32_bf16 v[28:31], v[248:251], v[44:47], v[28:31]
    v_mfma_f32_16x16x32_bf16 v[140:143], v[252:255], v[136:139], v[140:143]
    s_waitcnt lgkmcnt(4)
    v_mfma_f32_16x16x32_bf16 v[32:35], v[248:251], v[48:51], v[32:35]
    v_mfma_f32_16x16x32_bf16 v[36:39], v[248:251], v[52:55], v[36:39]
    s_waitcnt lgkmcnt(2)
    v_mfma_f32_16x16x32_bf16 v[24:27], v[252:255], v[56:59], v[24:27]
    v_mfma_f32_16x16x32_bf16 v[28:31], v[252:255], v[60:63], v[28:31]
    s_waitcnt lgkmcnt(0)
    v_mfma_f32_16x16x32_bf16 v[32:35], v[252:255], v[64:67], v[32:35]
    v_mfma_f32_16x16x32_bf16 v[36:39], v[252:255], v[68:71], v[36:39]
    v_mul_f32 v145, 0x3eb8aa3b, v145
    v_mul_f32 v147, 0x3eb8aa3b, v147
    v_mul_f32 v149, 0x3eb8aa3b, v149
    v_mul_f32 v151, 0x3eb8aa3b, v151
    v_pk_fma_f32 v[24:25], v[144:145], v[140:141], v[24:25] op_sel_hi:[0,1,1] neg_lo:[1,0,0] neg_hi:[1,0,0]
    v_pk_fma_f32 v[26:27], v[144:145], v[142:143], v[26:27] op_sel_hi:[0,1,1] neg_lo:[1,0,0] neg_hi:[1,0,0]
    v_pk_fma_f32 v[28:29], v[146:147], v[140:141], v[28:29] op_sel_hi:[0,1,1] neg_lo:[1,0,0] neg_hi:[1,0,0]
    v_pk_fma_f32 v[30:31], v[146:147], v[142:143], v[30:31] op_sel_hi:[0,1,1] neg_lo:[1,0,0] neg_hi:[1,0,0]
    v_pk_fma_f32 v[32:33], v[148:149], v[140:141], v[32:33] op_sel_hi:[0,1,1] neg_lo:[1,0,0] neg_hi:[1,0,0]
    v_pk_fma_f32 v[34:35], v[148:149], v[142:143], v[34:35] op_sel_hi:[0,1,1] neg_lo:[1,0,0] neg_hi:[1,0,0]
    v_pk_fma_f32 v[36:37], v[150:151], v[140:141], v[36:37] op_sel_hi:[0,1,1] neg_lo:[1,0,0] neg_hi:[1,0,0]
    v_pk_fma_f32 v[38:39], v[150:151], v[142:143], v[38:39] op_sel_hi:[0,1,1] neg_lo:[1,0,0] neg_hi:[1,0,0]
    v_pk_mul_f32 v[24:25], v[144:145], v[24:25] op_sel:[1,0] op_sel_hi:[1,1]
    v_pk_mul_f32 v[26:27], v[144:145], v[26:27] op_sel:[1,0] op_sel_hi:[1,1]
    v_pk_mul_f32 v[28:29], v[146:147], v[28:29] op_sel:[1,0] op_sel_hi:[1,1]
    v_pk_mul_f32 v[30:31], v[146:147], v[30:31] op_sel:[1,0] op_sel_hi:[1,1]
    v_pk_mul_f32 v[32:33], v[148:149], v[32:33] op_sel:[1,0] op_sel_hi:[1,1]
    v_pk_mul_f32 v[34:35], v[148:149], v[34:35] op_sel:[1,0] op_sel_hi:[1,1]
    v_pk_mul_f32 v[36:37], v[150:151], v[36:37] op_sel:[1,0] op_sel_hi:[1,1]
    v_pk_mul_f32 v[38:39], v[150:151], v[38:39] op_sel:[1,0] op_sel_hi:[1,1]
    v_cvt_pk_bf16_f32 v16, v24, v25
    v_cvt_pk_bf16_f32 v17, v26, v27
    v_cvt_pk_bf16_f32 v18, v28, v29
    v_cvt_pk_bf16_f32 v19, v30, v31
    v_cvt_pk_bf16_f32 v20, v32, v33
    v_cvt_pk_bf16_f32 v21, v34, v35
    v_cvt_pk_bf16_f32 v22, v36, v37
    v_cvt_pk_bf16_f32 v23, v38, v39
    v_mov_b32 v6, 0
    v_mov_b32 v7, 0
    v_permlane16_swap_b32 v16, v18
    v_permlane16_swap_b32 v17, v19
    v_permlane16_swap_b32 v20, v22
    v_permlane16_swap_b32 v21, v23
    v_dot2_f32_bf16 v6, v16, v16, v6
    v_dot2_f32_bf16 v7, v20, v20, v7
    v_dot2_f32_bf16 v6, v17, v17, v6
    v_dot2_f32_bf16 v7, v21, v21, v7
    v_dot2_f32_bf16 v6, v18, v18, v6
    v_dot2_f32_bf16 v7, v22, v22, v7
    v_dot2_f32_bf16 v6, v19, v19, v6
    v_dot2_f32_bf16 v7, v23, v23, v7
    s_nop 2
    v_permlane32_swap_b32 v6, v7
    v_add_f32 v6, v6, v7
    v_mov_b32 v7, v6
    s_nop 1
    v_permlane32_swap_b32 v6, v7
    v_max_f32 v6, v6, v7
    v_sqrt_f32 v6, v6
    v_mov_b32 v133, 16896
    s_mul_i32 s20, s3, 5120
    s_add_u32 s20, s20, 131072
    v_add_u32 v134, s20, v1
    s_waitcnt vmcnt(0)
    s_barrier
    ds_read_b64 v[128:129], v133
    ds_write_b128 v134, v[164:167] offset:0
    ds_write_b128 v134, v[168:171] offset:1024
    ds_write_b128 v134, v[172:175] offset:2048
    ds_write_b128 v134, v[176:179] offset:3072
    ds_write_b128 v134, v[180:183] offset:4096
    s_waitcnt lgkmcnt(5)
    v_mul_f32 v56, v6, v128
    v_readfirstlane_b32 s18, v129
    v_mov_b32 v57, v56
    v_mov_b32 v58, v56
    v_mov_b32 v59, v56
    v_mov_b32 v60, v56
    v_mov_b32 v61, v56
    v_mov_b32 v62, v56
    v_mov_b32 v63, v56
    v_mov_b32 v64, v56
    v_mov_b32 v65, v56
    v_mov_b32 v66, v56
    v_mov_b32 v67, v56
    v_mov_b32 v68, v56
    v_mov_b32 v69, v56
    v_mov_b32 v70, v56
    v_mov_b32 v71, v56
    s_mov_b32 s19, s18
    s_waitcnt lgkmcnt(0)
    s_barrier
    s_setprio 1
    s_lshl_b32 s20, s3, 13
    s_add_u32 s20, s20, 131072
    v_add_u32 v6, s20, v1
    s_lshl_b32 s20, s3, 14
    v_add_u32 v7, s20, v1
    ds_read_b128 v[104:107], v14 offset:0
    s_mov_b64 exec, s[40:41]
    ds_read_b128 v[108:111], v15 offset:1024
    ds_read_b128 v[112:115], v15 offset:1536
    s_mov_b64 exec, -1
    ds_read_b128 v[116:119], v14 offset:2048
    s_waitcnt lgkmcnt(3)
    v_mfma_f32_32x32x16_bf16 v[24:39], v[104:107], v[16:19], v[56:71]
    s_nop 11
    v_exp_f32 v24, v24
    v_exp_f32 v25, v25
    v_exp_f32 v26, v26
    v_exp_f32 v27, v27
    v_exp_f32 v28, v28
    v_mfma_f32_32x32x16_bf16 v[40:55], v[104:107], v[20:23], v[56:71]
    s_mov_b64 exec, s[40:41]
    ds_read_b128 v[120:123], v15 offset:3072
    ds_read_b128 v[124:127], v15 offset:3584
    s_mov_b64 exec, -1
    ds_read_b128 v[104:107], v14 offset:4096
    v_exp_f32 v29, v29
    v_exp_f32 v30, v30
    v_exp_f32 v31, v31
    v_exp_f32 v32, v32
    v_exp_f32 v33, v33
    s_waitcnt lgkmcnt(3)
    v_smfmac_f32_32x32x32_bf16 v[72:87], v[108:111], v[24:31], v13
    v_exp_f32 v34, v34
    v_exp_f32 v35, v35
    v_exp_f32 v36, v36
    v_exp_f32 v37, v37
    v_exp_f32 v38, v38
    v_exp_f32 v39, v39
    v_exp_f32 v40, v40
    v_exp_f32 v41, v41
    v_smfmac_f32_32x32x32_bf16 v[72:87], v[112:115], v[32:39], v13
    v_exp_f32 v42, v42
    v_exp_f32 v43, v43
    v_exp_f32 v44, v44
    v_mfma_f32_32x32x16_bf16 v[24:39], v[116:119], v[16:19], v[56:71]
    v_exp_f32 v45, v45
    v_exp_f32 v46, v46
    v_exp_f32 v47, v47
    v_exp_f32 v48, v48
    v_exp_f32 v49, v49
    v_smfmac_f32_32x32x32_bf16 v[88:103], v[108:111], v[40:47], v13
    v_exp_f32 v50, v50
    v_exp_f32 v51, v51
    v_exp_f32 v52, v52
    v_exp_f32 v53, v53
    v_exp_f32 v54, v54
    v_exp_f32 v55, v55
    v_exp_f32 v24, v24
    v_exp_f32 v25, v25
    v_smfmac_f32_32x32x32_bf16 v[88:103], v[112:115], v[48:55], v13
    v_exp_f32 v26, v26
    v_exp_f32 v27, v27
    v_exp_f32 v28, v28
    v_mfma_f32_32x32x16_bf16 v[40:55], v[116:119], v[20:23], v[56:71]
    s_mov_b64 exec, s[40:41]
    ds_read_b128 v[108:111], v15 offset:5120
    ds_read_b128 v[112:115], v15 offset:5632
    s_mov_b64 exec, -1
    ds_read_b128 v[116:119], v14 offset:6144
    v_exp_f32 v29, v29
    v_exp_f32 v30, v30
    v_exp_f32 v31, v31
    v_exp_f32 v32, v32
    v_exp_f32 v33, v33
    s_waitcnt lgkmcnt(3)
    v_smfmac_f32_32x32x32_bf16 v[72:87], v[120:123], v[24:31], v13
    v_exp_f32 v34, v34
    v_exp_f32 v35, v35
    v_exp_f32 v36, v36
    v_exp_f32 v37, v37
    v_exp_f32 v38, v38
    v_exp_f32 v39, v39
    v_exp_f32 v40, v40
    v_exp_f32 v41, v41
    v_smfmac_f32_32x32x32_bf16 v[72:87], v[124:127], v[32:39], v13
    v_exp_f32 v42, v42
    v_exp_f32 v43, v43
    v_exp_f32 v44, v44
    v_mfma_f32_32x32x16_bf16 v[24:39], v[104:107], v[16:19], v[56:71]
    v_exp_f32 v45, v45
    v_exp_f32 v46, v46
    v_exp_f32 v47, v47
    v_exp_f32 v48, v48
    v_exp_f32 v49, v49
    v_smfmac_f32_32x32x32_bf16 v[88:103], v[120:123], v[40:47], v13
    v_exp_f32 v50, v50
    v_exp_f32 v51, v51
    v_exp_f32 v52, v52
    v_exp_f32 v53, v53
    v_exp_f32 v54, v54
    v_exp_f32 v55, v55
    v_exp_f32 v24, v24
    v_exp_f32 v25, v25
    v_smfmac_f32_32x32x32_bf16 v[88:103], v[124:127], v[48:55], v13
    v_exp_f32 v26, v26
    v_exp_f32 v27, v27
    v_exp_f32 v28, v28
    v_mfma_f32_32x32x16_bf16 v[40:55], v[104:107], v[20:23], v[56:71]
    s_mov_b64 exec, s[40:41]
    ds_read_b128 v[120:123], v15 offset:7168
    ds_read_b128 v[124:127], v15 offset:7680
    s_mov_b64 exec, -1
    ds_read_b128 v[104:107], v14 offset:8192
    v_exp_f32 v29, v29
    v_exp_f32 v30, v30
    v_exp_f32 v31, v31
    v_exp_f32 v32, v32
    v_exp_f32 v33, v33
    s_waitcnt lgkmcnt(3)
    v_smfmac_f32_32x32x32_bf16 v[72:87], v[108:111], v[24:31], v13
    v_exp_f32 v34, v34
    v_exp_f32 v35, v35
    v_exp_f32 v36, v36
    v_exp_f32 v37, v37
    v_exp_f32 v38, v38
    v_exp_f32 v39, v39
    v_exp_f32 v40, v40
    v_exp_f32 v41, v41
    v_smfmac_f32_32x32x32_bf16 v[72:87], v[112:115], v[32:39], v13
    v_exp_f32 v42, v42
    v_exp_f32 v43, v43
    v_exp_f32 v44, v44
    v_mfma_f32_32x32x16_bf16 v[24:39], v[116:119], v[16:19], v[56:71]
    v_exp_f32 v45, v45
    v_exp_f32 v46, v46
    v_exp_f32 v47, v47
    v_exp_f32 v48, v48
    v_exp_f32 v49, v49
    v_smfmac_f32_32x32x32_bf16 v[88:103], v[108:111], v[40:47], v13
    v_exp_f32 v50, v50
    v_exp_f32 v51, v51
    v_exp_f32 v52, v52
    v_exp_f32 v53, v53
    v_exp_f32 v54, v54
    v_exp_f32 v55, v55
    v_exp_f32 v24, v24
    v_exp_f32 v25, v25
    v_smfmac_f32_32x32x32_bf16 v[88:103], v[112:115], v[48:55], v13
    v_exp_f32 v26, v26
    v_exp_f32 v27, v27
    v_exp_f32 v28, v28
    v_mfma_f32_32x32x16_bf16 v[40:55], v[116:119], v[20:23], v[56:71]
    s_mov_b64 exec, s[40:41]
    ds_read_b128 v[108:111], v15 offset:9216
    ds_read_b128 v[112:115], v15 offset:9728
    s_mov_b64 exec, -1
    ds_read_b128 v[116:119], v14 offset:10240
    v_exp_f32 v29, v29
    v_exp_f32 v30, v30
    v_exp_f32 v31, v31
    v_exp_f32 v32, v32
    v_exp_f32 v33, v33
    s_waitcnt lgkmcnt(3)
    v_smfmac_f32_32x32x32_bf16 v[72:87], v[120:123], v[24:31], v13
    v_exp_f32 v34, v34
    v_exp_f32 v35, v35
    v_exp_f32 v36, v36
    v_exp_f32 v37, v37
    v_exp_f32 v38, v38
    v_exp_f32 v39, v39
    v_exp_f32 v40, v40
    v_exp_f32 v41, v41
    v_smfmac_f32_32x32x32_bf16 v[72:87], v[124:127], v[32:39], v13
    v_exp_f32 v42, v42
    v_exp_f32 v43, v43
    v_exp_f32 v44, v44
    v_mfma_f32_32x32x16_bf16 v[24:39], v[104:107], v[16:19], v[56:71]
    v_exp_f32 v45, v45
    v_exp_f32 v46, v46
    v_exp_f32 v47, v47
    v_exp_f32 v48, v48
    v_exp_f32 v49, v49
    v_smfmac_f32_32x32x32_bf16 v[88:103], v[120:123], v[40:47], v13
    v_exp_f32 v50, v50
    v_exp_f32 v51, v51
    v_exp_f32 v52, v52
    v_exp_f32 v53, v53
    v_exp_f32 v54, v54
    v_exp_f32 v55, v55
    v_exp_f32 v24, v24
    v_exp_f32 v25, v25
    v_smfmac_f32_32x32x32_bf16 v[88:103], v[124:127], v[48:55], v13
    v_exp_f32 v26, v26
    v_exp_f32 v27, v27
    v_exp_f32 v28, v28
    v_mfma_f32_32x32x16_bf16 v[40:55], v[104:107], v[20:23], v[56:71]
    s_mov_b64 exec, s[40:41]
    ds_read_b128 v[120:123], v15 offset:11264
    ds_read_b128 v[124:127], v15 offset:11776
    s_mov_b64 exec, -1
    ds_read_b128 v[104:107], v14 offset:12288
    v_exp_f32 v29, v29
    v_exp_f32 v30, v30
    v_exp_f32 v31, v31
    v_exp_f32 v32, v32
    v_exp_f32 v33, v33
    s_waitcnt lgkmcnt(3)
    v_smfmac_f32_32x32x32_bf16 v[72:87], v[108:111], v[24:31], v13
    v_exp_f32 v34, v34
    v_exp_f32 v35, v35
    v_exp_f32 v36, v36
    v_exp_f32 v37, v37
    v_exp_f32 v38, v38
    v_exp_f32 v39, v39
    v_exp_f32 v40, v40
    v_exp_f32 v41, v41
    v_smfmac_f32_32x32x32_bf16 v[72:87], v[112:115], v[32:39], v13
    v_exp_f32 v42, v42
    v_exp_f32 v43, v43
    v_exp_f32 v44, v44
    v_mfma_f32_32x32x16_bf16 v[24:39], v[116:119], v[16:19], v[56:71]
    v_exp_f32 v45, v45
    v_exp_f32 v46, v46
    v_exp_f32 v47, v47
    v_exp_f32 v48, v48
    v_exp_f32 v49, v49
    v_smfmac_f32_32x32x32_bf16 v[88:103], v[108:111], v[40:47], v13
    v_exp_f32 v50, v50
    v_exp_f32 v51, v51
    v_exp_f32 v52, v52
    v_exp_f32 v53, v53
    v_exp_f32 v54, v54
    v_exp_f32 v55, v55
    v_exp_f32 v24, v24
    v_exp_f32 v25, v25
    v_smfmac_f32_32x32x32_bf16 v[88:103], v[112:115], v[48:55], v13
    v_exp_f32 v26, v26
    v_exp_f32 v27, v27
    v_exp_f32 v28, v28
    v_mfma_f32_32x32x16_bf16 v[40:55], v[116:119], v[20:23], v[56:71]
    s_mov_b64 exec, s[40:41]
    ds_read_b128 v[108:111], v15 offset:13312
    ds_read_b128 v[112:115], v15 offset:13824
    s_mov_b64 exec, -1
    ds_read_b128 v[116:119], v14 offset:14336
    v_exp_f32 v29, v29
    v_exp_f32 v30, v30
    v_exp_f32 v31, v31
    v_exp_f32 v32, v32
    v_exp_f32 v33, v33
    s_waitcnt lgkmcnt(3)
    v_smfmac_f32_32x32x32_bf16 v[72:87], v[120:123], v[24:31], v13
    v_exp_f32 v34, v34
    v_exp_f32 v35, v35
    v_exp_f32 v36, v36
    v_exp_f32 v37, v37
    v_exp_f32 v38, v38
    v_exp_f32 v39, v39
    v_exp_f32 v40, v40
    v_exp_f32 v41, v41
    v_smfmac_f32_32x32x32_bf16 v[72:87], v[124:127], v[32:39], v13
    v_exp_f32 v42, v42
    v_exp_f32 v43, v43
    v_exp_f32 v44, v44
    v_mfma_f32_32x32x16_bf16 v[24:39], v[104:107], v[16:19], v[56:71]
    v_exp_f32 v45, v45
    v_exp_f32 v46, v46
    v_exp_f32 v47, v47
    v_exp_f32 v48, v48
    v_exp_f32 v49, v49
    v_smfmac_f32_32x32x32_bf16 v[88:103], v[120:123], v[40:47], v13
    v_exp_f32 v50, v50
    v_exp_f32 v51, v51
    v_exp_f32 v52, v52
    v_exp_f32 v53, v53
    v_exp_f32 v54, v54
    v_exp_f32 v55, v55
    v_exp_f32 v24, v24
    v_exp_f32 v25, v25
    v_smfmac_f32_32x32x32_bf16 v[88:103], v[124:127], v[48:55], v13
    v_exp_f32 v26, v26
    v_exp_f32 v27, v27
    v_exp_f32 v28, v28
    v_mfma_f32_32x32x16_bf16 v[40:55], v[104:107], v[20:23], v[56:71]
    s_barrier
    s_mov_b64 exec, s[40:41]
    ds_read_b128 v[120:123], v15 offset:15360
    ds_read_b128 v[124:127], v15 offset:15872
    s_mov_b64 exec, -1
    ds_read_b128 v[104:107], v14 offset:16384
    v_exp_f32 v29, v29
    v_exp_f32 v30, v30
    v_exp_f32 v31, v31
    v_exp_f32 v32, v32
    v_exp_f32 v33, v33
    s_waitcnt lgkmcnt(3)
    v_smfmac_f32_32x32x32_bf16 v[72:87], v[108:111], v[24:31], v13
    v_exp_f32 v34, v34
    v_exp_f32 v35, v35
    v_exp_f32 v36, v36
    v_exp_f32 v37, v37
    v_exp_f32 v38, v38
    v_exp_f32 v39, v39
    v_exp_f32 v40, v40
    v_exp_f32 v41, v41
    v_smfmac_f32_32x32x32_bf16 v[72:87], v[112:115], v[32:39], v13
    v_exp_f32 v42, v42
    v_exp_f32 v43, v43
    v_exp_f32 v44, v44
    v_mfma_f32_32x32x16_bf16 v[24:39], v[116:119], v[16:19], v[56:71]
    v_exp_f32 v45, v45
    v_exp_f32 v46, v46
    v_exp_f32 v47, v47
    v_exp_f32 v48, v48
    v_exp_f32 v49, v49
    v_smfmac_f32_32x32x32_bf16 v[88:103], v[108:111], v[40:47], v13
    v_exp_f32 v50, v50
    v_exp_f32 v51, v51
    v_exp_f32 v52, v52
    v_exp_f32 v53, v53
    v_exp_f32 v54, v54
    v_exp_f32 v55, v55
    v_exp_f32 v24, v24
    v_exp_f32 v25, v25
    v_smfmac_f32_32x32x32_bf16 v[88:103], v[112:115], v[48:55], v13
    v_exp_f32 v26, v26
    v_exp_f32 v27, v27
    v_exp_f32 v28, v28
    v_mfma_f32_32x32x16_bf16 v[40:55], v[116:119], v[20:23], v[56:71]
    s_mov_b64 exec, s[40:41]
    ds_read_b128 v[108:111], v15 offset:17408
    ds_read_b128 v[112:115], v15 offset:17920
    s_mov_b64 exec, -1
    ds_read_b128 v[116:119], v14 offset:18432
    v_exp_f32 v29, v29
    v_exp_f32 v30, v30
    v_exp_f32 v31, v31
    v_exp_f32 v32, v32
    v_exp_f32 v33, v33
    s_waitcnt lgkmcnt(3)
    v_smfmac_f32_32x32x32_bf16 v[72:87], v[120:123], v[24:31], v13
    v_exp_f32 v34, v34
    v_exp_f32 v35, v35
    v_exp_f32 v36, v36
    v_exp_f32 v37, v37
    v_exp_f32 v38, v38
    v_exp_f32 v39, v39
    v_exp_f32 v40, v40
    v_exp_f32 v41, v41
    v_smfmac_f32_32x32x32_bf16 v[72:87], v[124:127], v[32:39], v13
    v_exp_f32 v42, v42
    v_exp_f32 v43, v43
    v_exp_f32 v44, v44
    v_mfma_f32_32x32x16_bf16 v[24:39], v[104:107], v[16:19], v[56:71]
    v_exp_f32 v45, v45
    v_exp_f32 v46, v46
    v_exp_f32 v47, v47
    v_exp_f32 v48, v48
    v_exp_f32 v49, v49
    v_smfmac_f32_32x32x32_bf16 v[88:103], v[120:123], v[40:47], v13
    v_exp_f32 v50, v50
    v_exp_f32 v51, v51
    v_exp_f32 v52, v52
    v_exp_f32 v53, v53
    v_exp_f32 v54, v54
    v_exp_f32 v55, v55
    v_exp_f32 v24, v24
    v_exp_f32 v25, v25
    v_smfmac_f32_32x32x32_bf16 v[88:103], v[124:127], v[48:55], v13
    v_exp_f32 v26, v26
    v_exp_f32 v27, v27
    v_exp_f32 v28, v28
    v_mfma_f32_32x32x16_bf16 v[40:55], v[104:107], v[20:23], v[56:71]
    s_mov_b64 exec, s[40:41]
    ds_read_b128 v[120:123], v15 offset:19456
    ds_read_b128 v[124:127], v15 offset:19968
    s_mov_b64 exec, -1
    ds_read_b128 v[104:107], v14 offset:20480
    v_exp_f32 v29, v29
    v_exp_f32 v30, v30
    v_exp_f32 v31, v31
    v_exp_f32 v32, v32
    v_exp_f32 v33, v33
    s_waitcnt lgkmcnt(3)
    v_smfmac_f32_32x32x32_bf16 v[72:87], v[108:111], v[24:31], v13
    v_exp_f32 v34, v34
    v_exp_f32 v35, v35
    v_exp_f32 v36, v36
    v_exp_f32 v37, v37
    v_exp_f32 v38, v38
    v_exp_f32 v39, v39
    v_exp_f32 v40, v40
    v_exp_f32 v41, v41
    v_smfmac_f32_32x32x32_bf16 v[72:87], v[112:115], v[32:39], v13
    v_exp_f32 v42, v42
    v_exp_f32 v43, v43
    v_exp_f32 v44, v44
    v_mfma_f32_32x32x16_bf16 v[24:39], v[116:119], v[16:19], v[56:71]
    v_exp_f32 v45, v45
    v_exp_f32 v46, v46
    v_exp_f32 v47, v47
    v_exp_f32 v48, v48
    v_exp_f32 v49, v49
    v_smfmac_f32_32x32x32_bf16 v[88:103], v[108:111], v[40:47], v13
    v_exp_f32 v50, v50
    v_exp_f32 v51, v51
    v_exp_f32 v52, v52
    v_exp_f32 v53, v53
    v_exp_f32 v54, v54
    v_exp_f32 v55, v55
    v_exp_f32 v24, v24
    v_exp_f32 v25, v25
    v_smfmac_f32_32x32x32_bf16 v[88:103], v[112:115], v[48:55], v13
    v_exp_f32 v26, v26
    v_exp_f32 v27, v27
    v_exp_f32 v28, v28
    v_mfma_f32_32x32x16_bf16 v[40:55], v[116:119], v[20:23], v[56:71]
    s_mov_b64 exec, s[40:41]
    ds_read_b128 v[108:111], v15 offset:21504
    ds_read_b128 v[112:115], v15 offset:22016
    s_mov_b64 exec, -1
    ds_read_b128 v[116:119], v14 offset:22528
    v_exp_f32 v29, v29
    v_exp_f32 v30, v30
    v_exp_f32 v31, v31
    v_exp_f32 v32, v32
    v_exp_f32 v33, v33
    s_waitcnt lgkmcnt(3)
    v_smfmac_f32_32x32x32_bf16 v[72:87], v[120:123], v[24:31], v13
    v_exp_f32 v34, v34
    v_exp_f32 v35, v35
    v_exp_f32 v36, v36
    v_exp_f32 v37, v37
    v_exp_f32 v38, v38
    v_exp_f32 v39, v39
    v_exp_f32 v40, v40
    v_exp_f32 v41, v41
    v_smfmac_f32_32x32x32_bf16 v[72:87], v[124:127], v[32:39], v13
    v_exp_f32 v42, v42
    v_exp_f32 v43, v43
    v_exp_f32 v44, v44
    v_mfma_f32_32x32x16_bf16 v[24:39], v[104:107], v[16:19], v[56:71]
    v_exp_f32 v45, v45
    v_exp_f32 v46, v46
    v_exp_f32 v47, v47
    v_exp_f32 v48, v48
    v_exp_f32 v49, v49
    v_smfmac_f32_32x32x32_bf16 v[88:103], v[120:123], v[40:47], v13
    v_exp_f32 v50, v50
    v_exp_f32 v51, v51
    v_exp_f32 v52, v52
    v_exp_f32 v53, v53
    v_exp_f32 v54, v54
    v_exp_f32 v55, v55
    v_exp_f32 v24, v24
    v_exp_f32 v25, v25
    v_smfmac_f32_32x32x32_bf16 v[88:103], v[124:127], v[48:55], v13
    v_exp_f32 v26, v26
    v_exp_f32 v27, v27
    v_exp_f32 v28, v28
    v_mfma_f32_32x32x16_bf16 v[40:55], v[104:107], v[20:23], v[56:71]
    s_mov_b64 exec, s[40:41]
    ds_read_b128 v[120:123], v15 offset:23552
    ds_read_b128 v[124:127], v15 offset:24064
    s_mov_b64 exec, -1
    ds_read_b128 v[104:107], v14 offset:24576
    v_exp_f32 v29, v29
    v_exp_f32 v30, v30
    v_exp_f32 v31, v31
    v_exp_f32 v32, v32
    v_exp_f32 v33, v33
    s_waitcnt lgkmcnt(3)
    v_smfmac_f32_32x32x32_bf16 v[72:87], v[108:111], v[24:31], v13
    v_exp_f32 v34, v34
    v_exp_f32 v35, v35
    v_exp_f32 v36, v36
    v_exp_f32 v37, v37
    v_exp_f32 v38, v38
    v_exp_f32 v39, v39
    v_exp_f32 v40, v40
    v_exp_f32 v41, v41
    v_smfmac_f32_32x32x32_bf16 v[72:87], v[112:115], v[32:39], v13
    v_exp_f32 v42, v42
    v_exp_f32 v43, v43
    v_exp_f32 v44, v44
    v_mfma_f32_32x32x16_bf16 v[24:39], v[116:119], v[16:19], v[56:71]
    v_exp_f32 v45, v45
    v_exp_f32 v46, v46
    v_exp_f32 v47, v47
    v_exp_f32 v48, v48
    v_exp_f32 v49, v49
    v_smfmac_f32_32x32x32_bf16 v[88:103], v[108:111], v[40:47], v13
    v_exp_f32 v50, v50
    v_exp_f32 v51, v51
    v_exp_f32 v52, v52
    v_exp_f32 v53, v53
    v_exp_f32 v54, v54
    v_exp_f32 v55, v55
    v_exp_f32 v24, v24
    v_exp_f32 v25, v25
    v_smfmac_f32_32x32x32_bf16 v[88:103], v[112:115], v[48:55], v13
    v_exp_f32 v26, v26
    v_exp_f32 v27, v27
    v_exp_f32 v28, v28
    v_mfma_f32_32x32x16_bf16 v[40:55], v[116:119], v[20:23], v[56:71]
    s_mov_b64 exec, s[40:41]
    ds_read_b128 v[108:111], v15 offset:25600
    ds_read_b128 v[112:115], v15 offset:26112
    s_mov_b64 exec, -1
    ds_read_b128 v[116:119], v14 offset:26624
    v_exp_f32 v29, v29
    v_exp_f32 v30, v30
    v_exp_f32 v31, v31
    v_exp_f32 v32, v32
    v_exp_f32 v33, v33
    s_waitcnt lgkmcnt(3)
    v_smfmac_f32_32x32x32_bf16 v[72:87], v[120:123], v[24:31], v13
    v_exp_f32 v34, v34
    v_exp_f32 v35, v35
    v_exp_f32 v36, v36
    v_exp_f32 v37, v37
    v_exp_f32 v38, v38
    v_exp_f32 v39, v39
    v_exp_f32 v40, v40
    v_exp_f32 v41, v41
    v_smfmac_f32_32x32x32_bf16 v[72:87], v[124:127], v[32:39], v13
    v_exp_f32 v42, v42
    v_exp_f32 v43, v43
    v_exp_f32 v44, v44
    v_mfma_f32_32x32x16_bf16 v[24:39], v[104:107], v[16:19], v[56:71]
    v_exp_f32 v45, v45
    v_exp_f32 v46, v46
    v_exp_f32 v47, v47
    v_exp_f32 v48, v48
    v_exp_f32 v49, v49
    v_smfmac_f32_32x32x32_bf16 v[88:103], v[120:123], v[40:47], v13
    v_exp_f32 v50, v50
    v_exp_f32 v51, v51
    v_exp_f32 v52, v52
    v_exp_f32 v53, v53
    v_exp_f32 v54, v54
    v_exp_f32 v55, v55
    v_exp_f32 v24, v24
    v_exp_f32 v25, v25
    v_smfmac_f32_32x32x32_bf16 v[88:103], v[124:127], v[48:55], v13
    v_exp_f32 v26, v26
    v_exp_f32 v27, v27
    v_exp_f32 v28, v28
    v_mfma_f32_32x32x16_bf16 v[40:55], v[104:107], v[20:23], v[56:71]
    s_mov_b64 exec, s[40:41]
    ds_read_b128 v[120:123], v15 offset:27648
    ds_read_b128 v[124:127], v15 offset:28160
    s_mov_b64 exec, -1
    ds_read_b128 v[104:107], v14 offset:28672
    v_exp_f32 v29, v29
    v_exp_f32 v30, v30
    v_exp_f32 v31, v31
    v_exp_f32 v32, v32
    v_exp_f32 v33, v33
    s_waitcnt lgkmcnt(3)
    v_smfmac_f32_32x32x32_bf16 v[72:87], v[108:111], v[24:31], v13
    v_exp_f32 v34, v34
    v_exp_f32 v35, v35
    v_exp_f32 v36, v36
    v_exp_f32 v37, v37
    v_exp_f32 v38, v38
    v_exp_f32 v39, v39
    v_exp_f32 v40, v40
    v_exp_f32 v41, v41
    v_smfmac_f32_32x32x32_bf16 v[72:87], v[112:115], v[32:39], v13
    v_exp_f32 v42, v42
    v_exp_f32 v43, v43
    v_exp_f32 v44, v44
    v_mfma_f32_32x32x16_bf16 v[24:39], v[116:119], v[16:19], v[56:71]
    v_exp_f32 v45, v45
    v_exp_f32 v46, v46
    v_exp_f32 v47, v47
    v_exp_f32 v48, v48
    v_exp_f32 v49, v49
    v_smfmac_f32_32x32x32_bf16 v[88:103], v[108:111], v[40:47], v13
    v_exp_f32 v50, v50
    v_exp_f32 v51, v51
    v_exp_f32 v52, v52
    v_exp_f32 v53, v53
    v_exp_f32 v54, v54
    v_exp_f32 v55, v55
    v_exp_f32 v24, v24
    v_exp_f32 v25, v25
    v_smfmac_f32_32x32x32_bf16 v[88:103], v[112:115], v[48:55], v13
    v_exp_f32 v26, v26
    v_exp_f32 v27, v27
    v_exp_f32 v28, v28
    v_mfma_f32_32x32x16_bf16 v[40:55], v[116:119], v[20:23], v[56:71]
    s_mov_b64 exec, s[40:41]
    ds_read_b128 v[108:111], v15 offset:29696
    ds_read_b128 v[112:115], v15 offset:30208
    s_mov_b64 exec, -1
    ds_read_b128 v[116:119], v14 offset:30720
    v_exp_f32 v29, v29
    v_exp_f32 v30, v30
    v_exp_f32 v31, v31
    v_exp_f32 v32, v32
    v_exp_f32 v33, v33
    s_waitcnt lgkmcnt(3)
    v_smfmac_f32_32x32x32_bf16 v[72:87], v[120:123], v[24:31], v13
    v_exp_f32 v34, v34
    v_exp_f32 v35, v35
    v_exp_f32 v36, v36
    v_exp_f32 v37, v37
    v_exp_f32 v38, v38
    v_exp_f32 v39, v39
    v_exp_f32 v40, v40
    v_exp_f32 v41, v41
    v_smfmac_f32_32x32x32_bf16 v[72:87], v[124:127], v[32:39], v13
    v_exp_f32 v42, v42
    v_exp_f32 v43, v43
    v_exp_f32 v44, v44
    v_mfma_f32_32x32x16_bf16 v[24:39], v[104:107], v[16:19], v[56:71]
    v_exp_f32 v45, v45
    v_exp_f32 v46, v46
    v_exp_f32 v47, v47
    v_exp_f32 v48, v48
    v_exp_f32 v49, v49
    v_smfmac_f32_32x32x32_bf16 v[88:103], v[120:123], v[40:47], v13
    v_exp_f32 v50, v50
    v_exp_f32 v51, v51
    v_exp_f32 v52, v52
    v_exp_f32 v53, v53
    v_exp_f32 v54, v54
    v_exp_f32 v55, v55
    v_exp_f32 v24, v24
    v_exp_f32 v25, v25
    v_smfmac_f32_32x32x32_bf16 v[88:103], v[124:127], v[48:55], v13
    v_exp_f32 v26, v26
    v_exp_f32 v27, v27
    v_exp_f32 v28, v28
    v_mfma_f32_32x32x16_bf16 v[40:55], v[104:107], v[20:23], v[56:71]
    s_barrier
    s_mov_b64 exec, s[40:41]
    ds_read_b128 v[120:123], v15 offset:31744
    ds_read_b128 v[124:127], v15 offset:32256
    s_mov_b64 exec, -1
    ds_read_b128 v[104:107], v14 offset:32768
    v_exp_f32 v29, v29
    v_exp_f32 v30, v30
    v_exp_f32 v31, v31
    v_exp_f32 v32, v32
    v_exp_f32 v33, v33
    s_waitcnt lgkmcnt(3)
    v_smfmac_f32_32x32x32_bf16 v[72:87], v[108:111], v[24:31], v13
    v_exp_f32 v34, v34
    v_exp_f32 v35, v35
    v_exp_f32 v36, v36
    v_exp_f32 v37, v37
    v_exp_f32 v38, v38
    v_exp_f32 v39, v39
    v_exp_f32 v40, v40
    v_exp_f32 v41, v41
    v_smfmac_f32_32x32x32_bf16 v[72:87], v[112:115], v[32:39], v13
    v_exp_f32 v42, v42
    v_exp_f32 v43, v43
    v_exp_f32 v44, v44
    v_mfma_f32_32x32x16_bf16 v[24:39], v[116:119], v[16:19], v[56:71]
    v_exp_f32 v45, v45
    v_exp_f32 v46, v46
    v_exp_f32 v47, v47
    v_exp_f32 v48, v48
    v_exp_f32 v49, v49
    v_smfmac_f32_32x32x32_bf16 v[88:103], v[108:111], v[40:47], v13
    v_exp_f32 v50, v50
    v_exp_f32 v51, v51
    v_exp_f32 v52, v52
    v_exp_f32 v53, v53
    v_exp_f32 v54, v54
    v_exp_f32 v55, v55
    v_exp_f32 v24, v24
    v_exp_f32 v25, v25
    v_smfmac_f32_32x32x32_bf16 v[88:103], v[112:115], v[48:55], v13
    v_exp_f32 v26, v26
    v_exp_f32 v27, v27
    v_exp_f32 v28, v28
    v_mfma_f32_32x32x16_bf16 v[40:55], v[116:119], v[20:23], v[56:71]
    s_mov_b64 exec, s[40:41]
    ds_read_b128 v[108:111], v15 offset:33792
    ds_read_b128 v[112:115], v15 offset:34304
    s_mov_b64 exec, -1
    ds_read_b128 v[116:119], v14 offset:34816
    v_exp_f32 v29, v29
    v_exp_f32 v30, v30
    v_exp_f32 v31, v31
    v_exp_f32 v32, v32
    v_exp_f32 v33, v33
    s_waitcnt lgkmcnt(3)
    v_smfmac_f32_32x32x32_bf16 v[72:87], v[120:123], v[24:31], v13
    v_exp_f32 v34, v34
    v_exp_f32 v35, v35
    v_exp_f32 v36, v36
    v_exp_f32 v37, v37
    v_exp_f32 v38, v38
    v_exp_f32 v39, v39
    v_exp_f32 v40, v40
    v_exp_f32 v41, v41
    v_smfmac_f32_32x32x32_bf16 v[72:87], v[124:127], v[32:39], v13
    v_exp_f32 v42, v42
    v_exp_f32 v43, v43
    v_exp_f32 v44, v44
    v_mfma_f32_32x32x16_bf16 v[24:39], v[104:107], v[16:19], v[56:71]
    v_exp_f32 v45, v45
    v_exp_f32 v46, v46
    v_exp_f32 v47, v47
    v_exp_f32 v48, v48
    v_exp_f32 v49, v49
    v_smfmac_f32_32x32x32_bf16 v[88:103], v[120:123], v[40:47], v13
    v_exp_f32 v50, v50
    v_exp_f32 v51, v51
    v_exp_f32 v52, v52
    v_exp_f32 v53, v53
    v_exp_f32 v54, v54
    v_exp_f32 v55, v55
    v_exp_f32 v24, v24
    v_exp_f32 v25, v25
    v_smfmac_f32_32x32x32_bf16 v[88:103], v[124:127], v[48:55], v13
    v_exp_f32 v26, v26
    v_exp_f32 v27, v27
    v_exp_f32 v28, v28
    v_mfma_f32_32x32x16_bf16 v[40:55], v[104:107], v[20:23], v[56:71]
    s_mov_b64 exec, s[40:41]
    ds_read_b128 v[120:123], v15 offset:35840
    ds_read_b128 v[124:127], v15 offset:36352
    s_mov_b64 exec, -1
    ds_read_b128 v[104:107], v14 offset:36864
    v_exp_f32 v29, v29
    v_exp_f32 v30, v30
    v_exp_f32 v31, v31
    v_exp_f32 v32, v32
    v_exp_f32 v33, v33
    s_waitcnt lgkmcnt(3)
    v_smfmac_f32_32x32x32_bf16 v[72:87], v[108:111], v[24:31], v13
    v_exp_f32 v34, v34
    v_exp_f32 v35, v35
    v_exp_f32 v36, v36
    v_exp_f32 v37, v37
    v_exp_f32 v38, v38
    v_exp_f32 v39, v39
    v_exp_f32 v40, v40
    v_exp_f32 v41, v41
    v_smfmac_f32_32x32x32_bf16 v[72:87], v[112:115], v[32:39], v13
    v_exp_f32 v42, v42
    v_exp_f32 v43, v43
    v_exp_f32 v44, v44
    v_mfma_f32_32x32x16_bf16 v[24:39], v[116:119], v[16:19], v[56:71]
    v_exp_f32 v45, v45
    v_exp_f32 v46, v46
    v_exp_f32 v47, v47
    v_exp_f32 v48, v48
    v_exp_f32 v49, v49
    v_smfmac_f32_32x32x32_bf16 v[88:103], v[108:111], v[40:47], v13
    v_exp_f32 v50, v50
    v_exp_f32 v51, v51
    v_exp_f32 v52, v52
    v_exp_f32 v53, v53
    v_exp_f32 v54, v54
    v_exp_f32 v55, v55
    v_exp_f32 v24, v24
    v_exp_f32 v25, v25
    v_smfmac_f32_32x32x32_bf16 v[88:103], v[112:115], v[48:55], v13
    v_exp_f32 v26, v26
    v_exp_f32 v27, v27
    v_exp_f32 v28, v28
    v_mfma_f32_32x32x16_bf16 v[40:55], v[116:119], v[20:23], v[56:71]
    s_mov_b64 exec, s[40:41]
    ds_read_b128 v[108:111], v15 offset:37888
    ds_read_b128 v[112:115], v15 offset:38400
    s_mov_b64 exec, -1
    ds_read_b128 v[116:119], v14 offset:38912
    v_exp_f32 v29, v29
    v_exp_f32 v30, v30
    v_exp_f32 v31, v31
    v_exp_f32 v32, v32
    v_exp_f32 v33, v33
    s_waitcnt lgkmcnt(3)
    v_smfmac_f32_32x32x32_bf16 v[72:87], v[120:123], v[24:31], v13
    v_exp_f32 v34, v34
    v_exp_f32 v35, v35
    v_exp_f32 v36, v36
    v_exp_f32 v37, v37
    v_exp_f32 v38, v38
    v_exp_f32 v39, v39
    v_exp_f32 v40, v40
    v_exp_f32 v41, v41
    v_smfmac_f32_32x32x32_bf16 v[72:87], v[124:127], v[32:39], v13
    v_exp_f32 v42, v42
    v_exp_f32 v43, v43
    v_exp_f32 v44, v44
    v_mfma_f32_32x32x16_bf16 v[24:39], v[104:107], v[16:19], v[56:71]
    v_exp_f32 v45, v45
    v_exp_f32 v46, v46
    v_exp_f32 v47, v47
    v_exp_f32 v48, v48
    v_exp_f32 v49, v49
    v_smfmac_f32_32x32x32_bf16 v[88:103], v[120:123], v[40:47], v13
    v_exp_f32 v50, v50
    v_exp_f32 v51, v51
    v_exp_f32 v52, v52
    v_exp_f32 v53, v53
    v_exp_f32 v54, v54
    v_exp_f32 v55, v55
    v_exp_f32 v24, v24
    v_exp_f32 v25, v25
    v_smfmac_f32_32x32x32_bf16 v[88:103], v[124:127], v[48:55], v13
    v_exp_f32 v26, v26
    v_exp_f32 v27, v27
    v_exp_f32 v28, v28
    v_mfma_f32_32x32x16_bf16 v[40:55], v[104:107], v[20:23], v[56:71]
    s_mov_b64 exec, s[40:41]
    ds_read_b128 v[120:123], v15 offset:39936
    ds_read_b128 v[124:127], v15 offset:40448
    s_mov_b64 exec, -1
    ds_read_b128 v[104:107], v14 offset:40960
    v_exp_f32 v29, v29
    v_exp_f32 v30, v30
    v_exp_f32 v31, v31
    v_exp_f32 v32, v32
    v_exp_f32 v33, v33
    s_waitcnt lgkmcnt(3)
    v_smfmac_f32_32x32x32_bf16 v[72:87], v[108:111], v[24:31], v13
    v_exp_f32 v34, v34
    v_exp_f32 v35, v35
    v_exp_f32 v36, v36
    v_exp_f32 v37, v37
    v_exp_f32 v38, v38
    v_exp_f32 v39, v39
    v_exp_f32 v40, v40
    v_exp_f32 v41, v41
    v_smfmac_f32_32x32x32_bf16 v[72:87], v[112:115], v[32:39], v13
    v_exp_f32 v42, v42
    v_exp_f32 v43, v43
    v_exp_f32 v44, v44
    v_mfma_f32_32x32x16_bf16 v[24:39], v[116:119], v[16:19], v[56:71]
    v_exp_f32 v45, v45
    v_exp_f32 v46, v46
    v_exp_f32 v47, v47
    v_exp_f32 v48, v48
    v_exp_f32 v49, v49
    v_smfmac_f32_32x32x32_bf16 v[88:103], v[108:111], v[40:47], v13
    v_exp_f32 v50, v50
    v_exp_f32 v51, v51
    v_exp_f32 v52, v52
    v_exp_f32 v53, v53
    v_exp_f32 v54, v54
    v_exp_f32 v55, v55
    v_exp_f32 v24, v24
    v_exp_f32 v25, v25
    v_smfmac_f32_32x32x32_bf16 v[88:103], v[112:115], v[48:55], v13
    v_exp_f32 v26, v26
    v_exp_f32 v27, v27
    v_exp_f32 v28, v28
    v_mfma_f32_32x32x16_bf16 v[40:55], v[116:119], v[20:23], v[56:71]
    s_mov_b64 exec, s[40:41]
    ds_read_b128 v[108:111], v15 offset:41984
    ds_read_b128 v[112:115], v15 offset:42496
    s_mov_b64 exec, -1
    ds_read_b128 v[116:119], v14 offset:43008
    v_exp_f32 v29, v29
    v_exp_f32 v30, v30
    v_exp_f32 v31, v31
    v_exp_f32 v32, v32
    v_exp_f32 v33, v33
    s_waitcnt lgkmcnt(3)
    v_smfmac_f32_32x32x32_bf16 v[72:87], v[120:123], v[24:31], v13
    v_exp_f32 v34, v34
    v_exp_f32 v35, v35
    v_exp_f32 v36, v36
    v_exp_f32 v37, v37
    v_exp_f32 v38, v38
    v_exp_f32 v39, v39
    v_exp_f32 v40, v40
    v_exp_f32 v41, v41
    v_smfmac_f32_32x32x32_bf16 v[72:87], v[124:127], v[32:39], v13
    v_exp_f32 v42, v42
    v_exp_f32 v43, v43
    v_exp_f32 v44, v44
    v_mfma_f32_32x32x16_bf16 v[24:39], v[104:107], v[16:19], v[56:71]
    v_exp_f32 v45, v45
    v_exp_f32 v46, v46
    v_exp_f32 v47, v47
    v_exp_f32 v48, v48
    v_exp_f32 v49, v49
    v_smfmac_f32_32x32x32_bf16 v[88:103], v[120:123], v[40:47], v13
    v_exp_f32 v50, v50
    v_exp_f32 v51, v51
    v_exp_f32 v52, v52
    v_exp_f32 v53, v53
    v_exp_f32 v54, v54
    v_exp_f32 v55, v55
    v_exp_f32 v24, v24
    v_exp_f32 v25, v25
    v_smfmac_f32_32x32x32_bf16 v[88:103], v[124:127], v[48:55], v13
    v_exp_f32 v26, v26
    v_exp_f32 v27, v27
    v_exp_f32 v28, v28
    v_mfma_f32_32x32x16_bf16 v[40:55], v[104:107], v[20:23], v[56:71]
    s_mov_b64 exec, s[40:41]
    ds_read_b128 v[120:123], v15 offset:44032
    ds_read_b128 v[124:127], v15 offset:44544
    s_mov_b64 exec, -1
    ds_read_b128 v[104:107], v14 offset:45056
    v_exp_f32 v29, v29
    v_exp_f32 v30, v30
    v_exp_f32 v31, v31
    v_exp_f32 v32, v32
    v_exp_f32 v33, v33
    s_waitcnt lgkmcnt(3)
    v_smfmac_f32_32x32x32_bf16 v[72:87], v[108:111], v[24:31], v13
    v_exp_f32 v34, v34
    v_exp_f32 v35, v35
    v_exp_f32 v36, v36
    v_exp_f32 v37, v37
    v_exp_f32 v38, v38
    v_exp_f32 v39, v39
    v_exp_f32 v40, v40
    v_exp_f32 v41, v41
    v_smfmac_f32_32x32x32_bf16 v[72:87], v[112:115], v[32:39], v13
    v_exp_f32 v42, v42
    v_exp_f32 v43, v43
    v_exp_f32 v44, v44
    v_mfma_f32_32x32x16_bf16 v[24:39], v[116:119], v[16:19], v[56:71]
    v_exp_f32 v45, v45
    v_exp_f32 v46, v46
    v_exp_f32 v47, v47
    v_exp_f32 v48, v48
    v_exp_f32 v49, v49
    v_smfmac_f32_32x32x32_bf16 v[88:103], v[108:111], v[40:47], v13
    v_exp_f32 v50, v50
    v_exp_f32 v51, v51
    v_exp_f32 v52, v52
    v_exp_f32 v53, v53
    v_exp_f32 v54, v54
    v_exp_f32 v55, v55
    v_exp_f32 v24, v24
    v_exp_f32 v25, v25
    v_smfmac_f32_32x32x32_bf16 v[88:103], v[112:115], v[48:55], v13
    v_exp_f32 v26, v26
    v_exp_f32 v27, v27
    v_exp_f32 v28, v28
    v_mfma_f32_32x32x16_bf16 v[40:55], v[116:119], v[20:23], v[56:71]
    s_mov_b64 exec, s[40:41]
    ds_read_b128 v[108:111], v15 offset:46080
    ds_read_b128 v[112:115], v15 offset:46592
    s_mov_b64 exec, -1
    ds_read_b128 v[116:119], v14 offset:47104
    v_exp_f32 v29, v29
    v_exp_f32 v30, v30
    v_exp_f32 v31, v31
    v_exp_f32 v32, v32
    v_exp_f32 v33, v33
    s_waitcnt lgkmcnt(3)
    v_smfmac_f32_32x32x32_bf16 v[72:87], v[120:123], v[24:31], v13
    v_exp_f32 v34, v34
    v_exp_f32 v35, v35
    v_exp_f32 v36, v36
    v_exp_f32 v37, v37
    v_exp_f32 v38, v38
    v_exp_f32 v39, v39
    v_exp_f32 v40, v40
    v_exp_f32 v41, v41
    v_smfmac_f32_32x32x32_bf16 v[72:87], v[124:127], v[32:39], v13
    v_exp_f32 v42, v42
    v_exp_f32 v43, v43
    v_exp_f32 v44, v44
    v_mfma_f32_32x32x16_bf16 v[24:39], v[104:107], v[16:19], v[56:71]
    v_exp_f32 v45, v45
    v_exp_f32 v46, v46
    v_exp_f32 v47, v47
    v_exp_f32 v48, v48
    v_exp_f32 v49, v49
    v_smfmac_f32_32x32x32_bf16 v[88:103], v[120:123], v[40:47], v13
    v_exp_f32 v50, v50
    v_exp_f32 v51, v51
    v_exp_f32 v52, v52
    v_exp_f32 v53, v53
    v_exp_f32 v54, v54
    v_exp_f32 v55, v55
    v_exp_f32 v24, v24
    v_exp_f32 v25, v25
    v_smfmac_f32_32x32x32_bf16 v[88:103], v[124:127], v[48:55], v13
    v_exp_f32 v26, v26
    v_exp_f32 v27, v27
    v_exp_f32 v28, v28
    v_mfma_f32_32x32x16_bf16 v[40:55], v[104:107], v[20:23], v[56:71]
    s_mov_b64 exec, s[40:41]
    ds_read_b128 v[120:123], v15 offset:48128
    ds_read_b128 v[124:127], v15 offset:48640
    s_mov_b64 exec, -1
    ds_read_b128 v[104:107], v14 offset:49152
    v_exp_f32 v29, v29
    v_exp_f32 v30, v30
    v_exp_f32 v31, v31
    v_exp_f32 v32, v32
    v_exp_f32 v33, v33
    s_waitcnt lgkmcnt(3)
    v_smfmac_f32_32x32x32_bf16 v[72:87], v[108:111], v[24:31], v13
    v_exp_f32 v34, v34
    v_exp_f32 v35, v35
    v_exp_f32 v36, v36
    v_exp_f32 v37, v37
    v_exp_f32 v38, v38
    v_exp_f32 v39, v39
    v_exp_f32 v40, v40
    v_exp_f32 v41, v41
    v_smfmac_f32_32x32x32_bf16 v[72:87], v[112:115], v[32:39], v13
    v_exp_f32 v42, v42
    v_exp_f32 v43, v43
    v_exp_f32 v44, v44
    v_mfma_f32_32x32x16_bf16 v[24:39], v[116:119], v[16:19], v[56:71]
    v_exp_f32 v45, v45
    v_exp_f32 v46, v46
    v_exp_f32 v47, v47
    v_exp_f32 v48, v48
    v_exp_f32 v49, v49
    v_smfmac_f32_32x32x32_bf16 v[88:103], v[108:111], v[40:47], v13
    v_exp_f32 v50, v50
    v_exp_f32 v51, v51
    v_exp_f32 v52, v52
    v_exp_f32 v53, v53
    v_exp_f32 v54, v54
    v_exp_f32 v55, v55
    v_exp_f32 v24, v24
    v_exp_f32 v25, v25
    v_smfmac_f32_32x32x32_bf16 v[88:103], v[112:115], v[48:55], v13
    v_exp_f32 v26, v26
    v_exp_f32 v27, v27
    v_exp_f32 v28, v28
    v_mfma_f32_32x32x16_bf16 v[40:55], v[116:119], v[20:23], v[56:71]
    s_mov_b64 exec, s[40:41]
    ds_read_b128 v[108:111], v15 offset:50176
    ds_read_b128 v[112:115], v15 offset:50688
    s_mov_b64 exec, -1
    ds_read_b128 v[116:119], v14 offset:51200
    v_exp_f32 v29, v29
    v_exp_f32 v30, v30
    v_exp_f32 v31, v31
    v_exp_f32 v32, v32
    v_exp_f32 v33, v33
    s_waitcnt lgkmcnt(3)
    v_smfmac_f32_32x32x32_bf16 v[72:87], v[120:123], v[24:31], v13
    v_exp_f32 v34, v34
    v_exp_f32 v35, v35
    v_exp_f32 v36, v36
    v_exp_f32 v37, v37
    v_exp_f32 v38, v38
    v_exp_f32 v39, v39
    v_exp_f32 v40, v40
    v_exp_f32 v41, v41
    v_smfmac_f32_32x32x32_bf16 v[72:87], v[124:127], v[32:39], v13
    v_exp_f32 v42, v42
    v_exp_f32 v43, v43
    v_exp_f32 v44, v44
    v_mfma_f32_32x32x16_bf16 v[24:39], v[104:107], v[16:19], v[56:71]
    v_exp_f32 v45, v45
    v_exp_f32 v46, v46
    v_exp_f32 v47, v47
    v_exp_f32 v48, v48
    v_exp_f32 v49, v49
    v_smfmac_f32_32x32x32_bf16 v[88:103], v[120:123], v[40:47], v13
    v_exp_f32 v50, v50
    v_exp_f32 v51, v51
    v_exp_f32 v52, v52
    v_exp_f32 v53, v53
    v_exp_f32 v54, v54
    v_exp_f32 v55, v55
    v_exp_f32 v24, v24
    v_exp_f32 v25, v25
    v_smfmac_f32_32x32x32_bf16 v[88:103], v[124:127], v[48:55], v13
    v_exp_f32 v26, v26
    v_exp_f32 v27, v27
    v_exp_f32 v28, v28
    v_mfma_f32_32x32x16_bf16 v[40:55], v[104:107], v[20:23], v[56:71]
    s_mov_b64 exec, s[40:41]
    ds_read_b128 v[120:123], v15 offset:52224
    ds_read_b128 v[124:127], v15 offset:52736
    s_mov_b64 exec, -1
    ds_read_b128 v[104:107], v14 offset:53248
    v_exp_f32 v29, v29
    v_exp_f32 v30, v30
    v_exp_f32 v31, v31
    v_exp_f32 v32, v32
    v_exp_f32 v33, v33
    s_waitcnt lgkmcnt(3)
    v_smfmac_f32_32x32x32_bf16 v[72:87], v[108:111], v[24:31], v13
    v_exp_f32 v34, v34
    v_exp_f32 v35, v35
    v_exp_f32 v36, v36
    v_exp_f32 v37, v37
    v_exp_f32 v38, v38
    v_exp_f32 v39, v39
    v_exp_f32 v40, v40
    v_exp_f32 v41, v41
    v_smfmac_f32_32x32x32_bf16 v[72:87], v[112:115], v[32:39], v13
    v_exp_f32 v42, v42
    v_exp_f32 v43, v43
    v_exp_f32 v44, v44
    v_mfma_f32_32x32x16_bf16 v[24:39], v[116:119], v[16:19], v[56:71]
    v_exp_f32 v45, v45
    v_exp_f32 v46, v46
    v_exp_f32 v47, v47
    v_exp_f32 v48, v48
    v_exp_f32 v49, v49
    v_smfmac_f32_32x32x32_bf16 v[88:103], v[108:111], v[40:47], v13
    v_exp_f32 v50, v50
    v_exp_f32 v51, v51
    v_exp_f32 v52, v52
    v_exp_f32 v53, v53
    v_exp_f32 v54, v54
    v_exp_f32 v55, v55
    v_exp_f32 v24, v24
    v_exp_f32 v25, v25
    v_smfmac_f32_32x32x32_bf16 v[88:103], v[112:115], v[48:55], v13
    v_exp_f32 v26, v26
    v_exp_f32 v27, v27
    v_exp_f32 v28, v28
    v_mfma_f32_32x32x16_bf16 v[40:55], v[116:119], v[20:23], v[56:71]
    s_mov_b64 exec, s[40:41]
    ds_read_b128 v[108:111], v15 offset:54272
    ds_read_b128 v[112:115], v15 offset:54784
    s_mov_b64 exec, -1
    ds_read_b128 v[116:119], v14 offset:55296
    v_exp_f32 v29, v29
    v_exp_f32 v30, v30
    v_exp_f32 v31, v31
    v_exp_f32 v32, v32
    v_exp_f32 v33, v33
    s_waitcnt lgkmcnt(3)
    v_smfmac_f32_32x32x32_bf16 v[72:87], v[120:123], v[24:31], v13
    v_exp_f32 v34, v34
    v_exp_f32 v35, v35
    v_exp_f32 v36, v36
    v_exp_f32 v37, v37
    v_exp_f32 v38, v38
    v_exp_f32 v39, v39
    v_exp_f32 v40, v40
    v_exp_f32 v41, v41
    v_smfmac_f32_32x32x32_bf16 v[72:87], v[124:127], v[32:39], v13
    v_exp_f32 v42, v42
    v_exp_f32 v43, v43
    v_exp_f32 v44, v44
    v_mfma_f32_32x32x16_bf16 v[24:39], v[104:107], v[16:19], v[56:71]
    v_exp_f32 v45, v45
    v_exp_f32 v46, v46
    v_exp_f32 v47, v47
    v_exp_f32 v48, v48
    v_exp_f32 v49, v49
    v_smfmac_f32_32x32x32_bf16 v[88:103], v[120:123], v[40:47], v13
    v_exp_f32 v50, v50
    v_exp_f32 v51, v51
    v_exp_f32 v52, v52
    v_exp_f32 v53, v53
    v_exp_f32 v54, v54
    v_exp_f32 v55, v55
    v_exp_f32 v24, v24
    v_exp_f32 v25, v25
    v_smfmac_f32_32x32x32_bf16 v[88:103], v[124:127], v[48:55], v13
    v_exp_f32 v26, v26
    v_exp_f32 v27, v27
    v_exp_f32 v28, v28
    v_mfma_f32_32x32x16_bf16 v[40:55], v[104:107], v[20:23], v[56:71]
    s_mov_b64 exec, s[40:41]
    ds_read_b128 v[120:123], v15 offset:56320
    ds_read_b128 v[124:127], v15 offset:56832
    s_mov_b64 exec, -1
    ds_read_b128 v[104:107], v14 offset:57344
    v_exp_f32 v29, v29
    v_exp_f32 v30, v30
    v_exp_f32 v31, v31
    v_exp_f32 v32, v32
    v_exp_f32 v33, v33
    s_waitcnt lgkmcnt(3)
    v_smfmac_f32_32x32x32_bf16 v[72:87], v[108:111], v[24:31], v13
    v_exp_f32 v34, v34
    v_exp_f32 v35, v35
    v_exp_f32 v36, v36
    v_exp_f32 v37, v37
    v_exp_f32 v38, v38
    v_exp_f32 v39, v39
    v_exp_f32 v40, v40
    v_exp_f32 v41, v41
    v_smfmac_f32_32x32x32_bf16 v[72:87], v[112:115], v[32:39], v13
    v_exp_f32 v42, v42
    v_exp_f32 v43, v43
    v_exp_f32 v44, v44
    v_mfma_f32_32x32x16_bf16 v[24:39], v[116:119], v[16:19], v[56:71]
    v_exp_f32 v45, v45
    v_exp_f32 v46, v46
    v_exp_f32 v47, v47
    v_exp_f32 v48, v48
    v_exp_f32 v49, v49
    v_smfmac_f32_32x32x32_bf16 v[88:103], v[108:111], v[40:47], v13
    v_exp_f32 v50, v50
    v_exp_f32 v51, v51
    v_exp_f32 v52, v52
    v_exp_f32 v53, v53
    v_exp_f32 v54, v54
    v_exp_f32 v55, v55
    v_exp_f32 v24, v24
    v_exp_f32 v25, v25
    v_smfmac_f32_32x32x32_bf16 v[88:103], v[112:115], v[48:55], v13
    v_exp_f32 v26, v26
    v_exp_f32 v27, v27
    v_exp_f32 v28, v28
    v_mfma_f32_32x32x16_bf16 v[40:55], v[116:119], v[20:23], v[56:71]
    s_mov_b64 exec, s[40:41]
    ds_read_b128 v[108:111], v15 offset:58368
    ds_read_b128 v[112:115], v15 offset:58880
    s_mov_b64 exec, -1
    ds_read_b128 v[116:119], v14 offset:59392
    v_exp_f32 v29, v29
    v_exp_f32 v30, v30
    v_exp_f32 v31, v31
    v_exp_f32 v32, v32
    v_exp_f32 v33, v33
    s_waitcnt lgkmcnt(3)
    v_smfmac_f32_32x32x32_bf16 v[72:87], v[120:123], v[24:31], v13
    v_exp_f32 v34, v34
    v_exp_f32 v35, v35
    v_exp_f32 v36, v36
    v_exp_f32 v37, v37
    v_exp_f32 v38, v38
    v_exp_f32 v39, v39
    v_exp_f32 v40, v40
    v_exp_f32 v41, v41
    v_smfmac_f32_32x32x32_bf16 v[72:87], v[124:127], v[32:39], v13
    v_exp_f32 v42, v42
    v_exp_f32 v43, v43
    v_exp_f32 v44, v44
    v_mfma_f32_32x32x16_bf16 v[24:39], v[104:107], v[16:19], v[56:71]
    v_exp_f32 v45, v45
    v_exp_f32 v46, v46
    v_exp_f32 v47, v47
    v_exp_f32 v48, v48
    v_exp_f32 v49, v49
    v_smfmac_f32_32x32x32_bf16 v[88:103], v[120:123], v[40:47], v13
    v_exp_f32 v50, v50
    v_exp_f32 v51, v51
    v_exp_f32 v52, v52
    v_exp_f32 v53, v53
    v_exp_f32 v54, v54
    v_exp_f32 v55, v55
    v_exp_f32 v24, v24
    v_exp_f32 v25, v25
    v_smfmac_f32_32x32x32_bf16 v[88:103], v[124:127], v[48:55], v13
    v_exp_f32 v26, v26
    v_exp_f32 v27, v27
    v_exp_f32 v28, v28
    v_mfma_f32_32x32x16_bf16 v[40:55], v[104:107], v[20:23], v[56:71]
    s_mov_b64 exec, s[40:41]
    ds_read_b128 v[120:123], v15 offset:60416
    ds_read_b128 v[124:127], v15 offset:60928
    s_mov_b64 exec, -1
    ds_read_b128 v[104:107], v14 offset:61440
    v_exp_f32 v29, v29
    v_exp_f32 v30, v30
    v_exp_f32 v31, v31
    v_exp_f32 v32, v32
    v_exp_f32 v33, v33
    s_waitcnt lgkmcnt(3)
    v_smfmac_f32_32x32x32_bf16 v[72:87], v[108:111], v[24:31], v13
    v_exp_f32 v34, v34
    v_exp_f32 v35, v35
    v_exp_f32 v36, v36
    v_exp_f32 v37, v37
    v_exp_f32 v38, v38
    v_exp_f32 v39, v39
    v_exp_f32 v40, v40
    v_exp_f32 v41, v41
    v_smfmac_f32_32x32x32_bf16 v[72:87], v[112:115], v[32:39], v13
    v_exp_f32 v42, v42
    v_exp_f32 v43, v43
    v_exp_f32 v44, v44
    v_mfma_f32_32x32x16_bf16 v[24:39], v[116:119], v[16:19], v[56:71]
    v_exp_f32 v45, v45
    v_exp_f32 v46, v46
    v_exp_f32 v47, v47
    v_exp_f32 v48, v48
    v_exp_f32 v49, v49
    v_smfmac_f32_32x32x32_bf16 v[88:103], v[108:111], v[40:47], v13
    v_exp_f32 v50, v50
    v_exp_f32 v51, v51
    v_exp_f32 v52, v52
    v_exp_f32 v53, v53
    v_exp_f32 v54, v54
    v_exp_f32 v55, v55
    v_exp_f32 v24, v24
    v_exp_f32 v25, v25
    v_smfmac_f32_32x32x32_bf16 v[88:103], v[112:115], v[48:55], v13
    v_exp_f32 v26, v26
    v_exp_f32 v27, v27
    v_exp_f32 v28, v28
    v_mfma_f32_32x32x16_bf16 v[40:55], v[116:119], v[20:23], v[56:71]
    s_mov_b64 exec, s[40:41]
    ds_read_b128 v[108:111], v15 offset:62464
    ds_read_b128 v[112:115], v15 offset:62976
    s_mov_b64 exec, -1
    ds_read_b128 v[116:119], v14 offset:63488
    v_exp_f32 v29, v29
    v_exp_f32 v30, v30
    v_exp_f32 v31, v31
    v_exp_f32 v32, v32
    v_exp_f32 v33, v33
    s_waitcnt lgkmcnt(3)
    v_smfmac_f32_32x32x32_bf16 v[72:87], v[120:123], v[24:31], v13
    v_exp_f32 v34, v34
    v_exp_f32 v35, v35
    v_exp_f32 v36, v36
    v_exp_f32 v37, v37
    v_exp_f32 v38, v38
    v_exp_f32 v39, v39
    v_exp_f32 v40, v40
    v_exp_f32 v41, v41
    v_smfmac_f32_32x32x32_bf16 v[72:87], v[124:127], v[32:39], v13
    v_exp_f32 v42, v42
    v_exp_f32 v43, v43
    v_exp_f32 v44, v44
    v_mfma_f32_32x32x16_bf16 v[24:39], v[104:107], v[16:19], v[56:71]
    v_exp_f32 v45, v45
    v_exp_f32 v46, v46
    v_exp_f32 v47, v47
    v_exp_f32 v48, v48
    v_exp_f32 v49, v49
    v_smfmac_f32_32x32x32_bf16 v[88:103], v[120:123], v[40:47], v13
    v_exp_f32 v50, v50
    v_exp_f32 v51, v51
    v_exp_f32 v52, v52
    v_exp_f32 v53, v53
    v_exp_f32 v54, v54
    v_exp_f32 v55, v55
    v_exp_f32 v24, v24
    v_exp_f32 v25, v25
    v_smfmac_f32_32x32x32_bf16 v[88:103], v[124:127], v[48:55], v13
    v_exp_f32 v26, v26
    v_exp_f32 v27, v27
    v_exp_f32 v28, v28
    v_mfma_f32_32x32x16_bf16 v[40:55], v[104:107], v[20:23], v[56:71]
    s_mov_b64 exec, s[40:41]
    ds_read_b128 v[120:123], v15 offset:64512
    ds_read_b128 v[124:127], v15 offset:65024
    s_mov_b64 exec, -1
    v_add_u32 v14, 0x10000, v14
    ds_read_b128 v[104:107], v14 offset:0
    v_exp_f32 v29, v29
    v_exp_f32 v30, v30
    v_exp_f32 v31, v31
    v_exp_f32 v32, v32
    v_exp_f32 v33, v33
    s_waitcnt lgkmcnt(3)
    v_smfmac_f32_32x32x32_bf16 v[72:87], v[108:111], v[24:31], v13
    v_exp_f32 v34, v34
    v_exp_f32 v35, v35
    v_exp_f32 v36, v36
    v_exp_f32 v37, v37
    v_exp_f32 v38, v38
    v_exp_f32 v39, v39
    v_exp_f32 v40, v40
    v_exp_f32 v41, v41
    v_smfmac_f32_32x32x32_bf16 v[72:87], v[112:115], v[32:39], v13
    v_exp_f32 v42, v42
    v_exp_f32 v43, v43
    v_exp_f32 v44, v44
    v_mfma_f32_32x32x16_bf16 v[24:39], v[116:119], v[16:19], v[56:71]
    v_exp_f32 v45, v45
    v_exp_f32 v46, v46
    v_exp_f32 v47, v47
    v_exp_f32 v48, v48
    v_exp_f32 v49, v49
    v_smfmac_f32_32x32x32_bf16 v[88:103], v[108:111], v[40:47], v13
    v_exp_f32 v50, v50
    v_exp_f32 v51, v51
    v_exp_f32 v52, v52
    v_exp_f32 v53, v53
    v_exp_f32 v54, v54
    v_exp_f32 v55, v55
    v_exp_f32 v24, v24
    v_exp_f32 v25, v25
    v_smfmac_f32_32x32x32_bf16 v[88:103], v[112:115], v[48:55], v13
    v_exp_f32 v26, v26
    v_exp_f32 v27, v27
    v_exp_f32 v28, v28
    v_mfma_f32_32x32x16_bf16 v[40:55], v[116:119], v[20:23], v[56:71]
    v_add_u32 v15, 0x10000, v15
    s_mov_b64 exec, s[40:41]
    ds_read_b128 v[108:111], v15 offset:1024
    ds_read_b128 v[112:115], v15 offset:1536
    s_mov_b64 exec, -1
    ds_read_b128 v[116:119], v14 offset:2048
    v_exp_f32 v29, v29
    v_exp_f32 v30, v30
    v_exp_f32 v31, v31
    v_exp_f32 v32, v32
    v_exp_f32 v33, v33
    s_waitcnt lgkmcnt(3)
    v_smfmac_f32_32x32x32_bf16 v[72:87], v[120:123], v[24:31], v13
    v_exp_f32 v34, v34
    v_exp_f32 v35, v35
    v_exp_f32 v36, v36
    v_exp_f32 v37, v37
    v_exp_f32 v38, v38
    v_exp_f32 v39, v39
    v_exp_f32 v40, v40
    v_exp_f32 v41, v41
    v_smfmac_f32_32x32x32_bf16 v[72:87], v[124:127], v[32:39], v13
    v_exp_f32 v42, v42
    v_exp_f32 v43, v43
    v_exp_f32 v44, v44
    v_mfma_f32_32x32x16_bf16 v[24:39], v[104:107], v[16:19], v[56:71]
    v_exp_f32 v45, v45
    v_exp_f32 v46, v46
    v_exp_f32 v47, v47
    v_exp_f32 v48, v48
    v_exp_f32 v49, v49
    v_smfmac_f32_32x32x32_bf16 v[88:103], v[120:123], v[40:47], v13
    v_exp_f32 v50, v50
    v_exp_f32 v51, v51
    v_exp_f32 v52, v52
    v_exp_f32 v53, v53
    v_exp_f32 v54, v54
    v_exp_f32 v55, v55
    v_exp_f32 v24, v24
    v_exp_f32 v25, v25
    v_smfmac_f32_32x32x32_bf16 v[88:103], v[124:127], v[48:55], v13
    v_exp_f32 v26, v26
    v_exp_f32 v27, v27
    v_exp_f32 v28, v28
    v_mfma_f32_32x32x16_bf16 v[40:55], v[104:107], v[20:23], v[56:71]
    s_mov_b64 exec, s[40:41]
    ds_read_b128 v[120:123], v15 offset:3072
    ds_read_b128 v[124:127], v15 offset:3584
    s_mov_b64 exec, -1
    ds_read_b128 v[104:107], v14 offset:4096
    v_exp_f32 v29, v29
    v_exp_f32 v30, v30
    v_exp_f32 v31, v31
    v_exp_f32 v32, v32
    v_exp_f32 v33, v33
    s_waitcnt lgkmcnt(3)
    v_smfmac_f32_32x32x32_bf16 v[72:87], v[108:111], v[24:31], v13
    v_exp_f32 v34, v34
    v_exp_f32 v35, v35
    v_exp_f32 v36, v36
    v_exp_f32 v37, v37
    v_exp_f32 v38, v38
    v_exp_f32 v39, v39
    v_exp_f32 v40, v40
    v_exp_f32 v41, v41
    v_smfmac_f32_32x32x32_bf16 v[72:87], v[112:115], v[32:39], v13
    v_exp_f32 v42, v42
    v_exp_f32 v43, v43
    v_exp_f32 v44, v44
    v_mfma_f32_32x32x16_bf16 v[24:39], v[116:119], v[16:19], v[56:71]
    v_exp_f32 v45, v45
    v_exp_f32 v46, v46
    v_exp_f32 v47, v47
    v_exp_f32 v48, v48
    v_exp_f32 v49, v49
    v_smfmac_f32_32x32x32_bf16 v[88:103], v[108:111], v[40:47], v13
    v_exp_f32 v50, v50
    v_exp_f32 v51, v51
    v_exp_f32 v52, v52
    v_exp_f32 v53, v53
    v_exp_f32 v54, v54
    v_exp_f32 v55, v55
    v_exp_f32 v24, v24
    v_exp_f32 v25, v25
    v_smfmac_f32_32x32x32_bf16 v[88:103], v[112:115], v[48:55], v13
    v_exp_f32 v26, v26
    v_exp_f32 v27, v27
    v_exp_f32 v28, v28
    v_mfma_f32_32x32x16_bf16 v[40:55], v[116:119], v[20:23], v[56:71]
    s_mov_b64 exec, s[40:41]
    ds_read_b128 v[108:111], v15 offset:5120
    ds_read_b128 v[112:115], v15 offset:5632
    s_mov_b64 exec, -1
    ds_read_b128 v[116:119], v14 offset:6144
    v_exp_f32 v29, v29
    v_exp_f32 v30, v30
    v_exp_f32 v31, v31
    v_exp_f32 v32, v32
    v_exp_f32 v33, v33
    s_waitcnt lgkmcnt(3)
    v_smfmac_f32_32x32x32_bf16 v[72:87], v[120:123], v[24:31], v13
    v_exp_f32 v34, v34
    v_exp_f32 v35, v35
    v_exp_f32 v36, v36
    v_exp_f32 v37, v37
    v_exp_f32 v38, v38
    v_exp_f32 v39, v39
    v_exp_f32 v40, v40
    v_exp_f32 v41, v41
    v_smfmac_f32_32x32x32_bf16 v[72:87], v[124:127], v[32:39], v13
    v_exp_f32 v42, v42
    v_exp_f32 v43, v43
    v_exp_f32 v44, v44
    v_mfma_f32_32x32x16_bf16 v[24:39], v[104:107], v[16:19], v[56:71]
    v_exp_f32 v45, v45
    v_exp_f32 v46, v46
    v_exp_f32 v47, v47
    v_exp_f32 v48, v48
    v_exp_f32 v49, v49
    v_smfmac_f32_32x32x32_bf16 v[88:103], v[120:123], v[40:47], v13
    v_exp_f32 v50, v50
    v_exp_f32 v51, v51
    v_exp_f32 v52, v52
    v_exp_f32 v53, v53
    v_exp_f32 v54, v54
    v_exp_f32 v55, v55
    v_exp_f32 v24, v24
    v_exp_f32 v25, v25
    v_smfmac_f32_32x32x32_bf16 v[88:103], v[124:127], v[48:55], v13
    v_exp_f32 v26, v26
    v_exp_f32 v27, v27
    v_exp_f32 v28, v28
    v_mfma_f32_32x32x16_bf16 v[40:55], v[104:107], v[20:23], v[56:71]
    s_mov_b64 exec, s[40:41]
    ds_read_b128 v[120:123], v15 offset:7168
    ds_read_b128 v[124:127], v15 offset:7680
    s_mov_b64 exec, -1
    ds_read_b128 v[104:107], v14 offset:8192
    v_exp_f32 v29, v29
    v_exp_f32 v30, v30
    v_exp_f32 v31, v31
    v_exp_f32 v32, v32
    v_exp_f32 v33, v33
    s_waitcnt lgkmcnt(3)
    v_smfmac_f32_32x32x32_bf16 v[72:87], v[108:111], v[24:31], v13
    v_exp_f32 v34, v34
    v_exp_f32 v35, v35
    v_exp_f32 v36, v36
    v_exp_f32 v37, v37
    v_exp_f32 v38, v38
    v_exp_f32 v39, v39
    v_exp_f32 v40, v40
    v_exp_f32 v41, v41
    v_smfmac_f32_32x32x32_bf16 v[72:87], v[112:115], v[32:39], v13
    v_exp_f32 v42, v42
    v_exp_f32 v43, v43
    v_exp_f32 v44, v44
    v_mfma_f32_32x32x16_bf16 v[24:39], v[116:119], v[16:19], v[56:71]
    v_exp_f32 v45, v45
    v_exp_f32 v46, v46
    v_exp_f32 v47, v47
    v_exp_f32 v48, v48
    v_exp_f32 v49, v49
    v_smfmac_f32_32x32x32_bf16 v[88:103], v[108:111], v[40:47], v13
    v_exp_f32 v50, v50
    v_exp_f32 v51, v51
    v_exp_f32 v52, v52
    v_exp_f32 v53, v53
    v_exp_f32 v54, v54
    v_exp_f32 v55, v55
    v_exp_f32 v24, v24
    v_exp_f32 v25, v25
    v_smfmac_f32_32x32x32_bf16 v[88:103], v[112:115], v[48:55], v13
    v_exp_f32 v26, v26
    v_exp_f32 v27, v27
    v_exp_f32 v28, v28
    v_mfma_f32_32x32x16_bf16 v[40:55], v[116:119], v[20:23], v[56:71]
    s_mov_b64 exec, s[40:41]
    ds_read_b128 v[108:111], v15 offset:9216
    ds_read_b128 v[112:115], v15 offset:9728
    s_mov_b64 exec, -1
    ds_read_b128 v[116:119], v14 offset:10240
    v_exp_f32 v29, v29
    v_exp_f32 v30, v30
    v_exp_f32 v31, v31
    v_exp_f32 v32, v32
    v_exp_f32 v33, v33
    s_waitcnt lgkmcnt(3)
    v_smfmac_f32_32x32x32_bf16 v[72:87], v[120:123], v[24:31], v13
    v_exp_f32 v34, v34
    v_exp_f32 v35, v35
    v_exp_f32 v36, v36
    v_exp_f32 v37, v37
    v_exp_f32 v38, v38
    v_exp_f32 v39, v39
    v_exp_f32 v40, v40
    v_exp_f32 v41, v41
    v_smfmac_f32_32x32x32_bf16 v[72:87], v[124:127], v[32:39], v13
    v_exp_f32 v42, v42
    v_exp_f32 v43, v43
    v_exp_f32 v44, v44
    v_mfma_f32_32x32x16_bf16 v[24:39], v[104:107], v[16:19], v[56:71]
    v_exp_f32 v45, v45
    v_exp_f32 v46, v46
    v_exp_f32 v47, v47
    v_exp_f32 v48, v48
    v_exp_f32 v49, v49
    v_smfmac_f32_32x32x32_bf16 v[88:103], v[120:123], v[40:47], v13
    v_exp_f32 v50, v50
    v_exp_f32 v51, v51
    v_exp_f32 v52, v52
    v_exp_f32 v53, v53
    v_exp_f32 v54, v54
    v_exp_f32 v55, v55
    v_exp_f32 v24, v24
    v_exp_f32 v25, v25
    v_smfmac_f32_32x32x32_bf16 v[88:103], v[124:127], v[48:55], v13
    v_exp_f32 v26, v26
    v_exp_f32 v27, v27
    v_exp_f32 v28, v28
    v_mfma_f32_32x32x16_bf16 v[40:55], v[104:107], v[20:23], v[56:71]
    s_barrier
    s_mov_b64 exec, s[40:41]
    ds_read_b128 v[120:123], v15 offset:11264
    ds_read_b128 v[124:127], v15 offset:11776
    s_mov_b64 exec, -1
    ds_read_b128 v[104:107], v14 offset:12288
    v_exp_f32 v29, v29
    v_exp_f32 v30, v30
    v_exp_f32 v31, v31
    v_exp_f32 v32, v32
    v_exp_f32 v33, v33
    s_waitcnt lgkmcnt(3)
    v_smfmac_f32_32x32x32_bf16 v[72:87], v[108:111], v[24:31], v13
    v_exp_f32 v34, v34
    v_exp_f32 v35, v35
    v_exp_f32 v36, v36
    v_exp_f32 v37, v37
    v_exp_f32 v38, v38
    v_exp_f32 v39, v39
    v_exp_f32 v40, v40
    v_exp_f32 v41, v41
    v_smfmac_f32_32x32x32_bf16 v[72:87], v[112:115], v[32:39], v13
    v_exp_f32 v42, v42
    v_exp_f32 v43, v43
    v_exp_f32 v44, v44
    v_mfma_f32_32x32x16_bf16 v[24:39], v[116:119], v[16:19], v[56:71]
    ds_read_b128 v[128:131], v6 offset:0
    ds_read_b128 v[132:135], v6 offset:1024
    ds_read_b128 v[136:139], v6 offset:2048
    ds_read_b128 v[140:143], v6 offset:3072
    v_exp_f32 v45, v45
    v_exp_f32 v46, v46
    v_exp_f32 v47, v47
    v_exp_f32 v48, v48
    v_exp_f32 v49, v49
    v_smfmac_f32_32x32x32_bf16 v[88:103], v[108:111], v[40:47], v13
    v_exp_f32 v50, v50
    v_exp_f32 v51, v51
    v_exp_f32 v52, v52
    v_exp_f32 v53, v53
    v_exp_f32 v54, v54
    v_exp_f32 v55, v55
    v_exp_f32 v24, v24
    v_exp_f32 v25, v25
    v_smfmac_f32_32x32x32_bf16 v[88:103], v[112:115], v[48:55], v13
    v_exp_f32 v26, v26
    v_exp_f32 v27, v27
    v_exp_f32 v28, v28
    v_mfma_f32_32x32x16_bf16 v[40:55], v[116:119], v[20:23], v[56:71]
    s_mov_b64 exec, s[40:41]
    ds_read_b128 v[108:111], v15 offset:13312
    ds_read_b128 v[112:115], v15 offset:13824
    s_mov_b64 exec, -1
    ds_read_b128 v[116:119], v14 offset:14336
    v_exp_f32 v29, v29
    v_exp_f32 v30, v30
    v_exp_f32 v31, v31
    v_exp_f32 v32, v32
    v_exp_f32 v33, v33
    s_waitcnt lgkmcnt(3)
    v_smfmac_f32_32x32x32_bf16 v[72:87], v[120:123], v[24:31], v13
    v_exp_f32 v34, v34
    v_exp_f32 v35, v35
    v_exp_f32 v36, v36
    v_exp_f32 v37, v37
    v_exp_f32 v38, v38
    v_exp_f32 v39, v39
    v_exp_f32 v40, v40
    v_exp_f32 v41, v41
    v_smfmac_f32_32x32x32_bf16 v[72:87], v[124:127], v[32:39], v13
    v_exp_f32 v42, v42
    v_exp_f32 v43, v43
    v_exp_f32 v44, v44
    v_mfma_f32_32x32x16_bf16 v[24:39], v[104:107], v[16:19], v[56:71]
    ds_read_b128 v[144:147], v6 offset:4096
    ds_read_b128 v[148:151], v6 offset:5120
    ds_read_b128 v[152:155], v6 offset:6144
    ds_read_b128 v[156:159], v6 offset:7168
    v_exp_f32 v45, v45
    v_exp_f32 v46, v46
    v_exp_f32 v47, v47
    v_exp_f32 v48, v48
    v_exp_f32 v49, v49
    v_smfmac_f32_32x32x32_bf16 v[88:103], v[120:123], v[40:47], v13
    v_exp_f32 v50, v50
    v_exp_f32 v51, v51
    v_exp_f32 v52, v52
    v_exp_f32 v53, v53
    v_exp_f32 v54, v54
    v_exp_f32 v55, v55
    v_exp_f32 v24, v24
    v_exp_f32 v25, v25
    v_smfmac_f32_32x32x32_bf16 v[88:103], v[124:127], v[48:55], v13
    v_exp_f32 v26, v26
    v_exp_f32 v27, v27
    v_exp_f32 v28, v28
    v_mfma_f32_32x32x16_bf16 v[40:55], v[104:107], v[20:23], v[56:71]
    s_mov_b64 exec, s[40:41]
    ds_read_b128 v[120:123], v15 offset:15360
    ds_read_b128 v[124:127], v15 offset:15872
    s_mov_b64 exec, -1
    ds_read_b128 v[104:107], v14 offset:16384
    v_exp_f32 v29, v29
    v_exp_f32 v30, v30
    v_exp_f32 v31, v31
    v_exp_f32 v32, v32
    v_exp_f32 v33, v33
    s_waitcnt lgkmcnt(3)
    v_smfmac_f32_32x32x32_bf16 v[72:87], v[108:111], v[24:31], v13
    v_exp_f32 v34, v34
    v_exp_f32 v35, v35
    v_exp_f32 v36, v36
    v_exp_f32 v37, v37
    v_exp_f32 v38, v38
    v_exp_f32 v39, v39
    v_exp_f32 v40, v40
    v_exp_f32 v41, v41
    v_smfmac_f32_32x32x32_bf16 v[72:87], v[112:115], v[32:39], v13
    v_exp_f32 v42, v42
    v_exp_f32 v43, v43
    v_exp_f32 v44, v44
    v_mfma_f32_32x32x16_bf16 v[24:39], v[116:119], v[16:19], v[56:71]
    v_exp_f32 v45, v45
    v_exp_f32 v46, v46
    v_exp_f32 v47, v47
    v_exp_f32 v48, v48
    v_exp_f32 v49, v49
    v_smfmac_f32_32x32x32_bf16 v[88:103], v[108:111], v[40:47], v13
    v_exp_f32 v50, v50
    v_exp_f32 v51, v51
    v_exp_f32 v52, v52
    v_exp_f32 v53, v53
    v_exp_f32 v54, v54
    v_exp_f32 v55, v55
    v_exp_f32 v24, v24
    v_exp_f32 v25, v25
    v_smfmac_f32_32x32x32_bf16 v[88:103], v[112:115], v[48:55], v13
    v_exp_f32 v26, v26
    v_exp_f32 v27, v27
    v_exp_f32 v28, v28
    v_mfma_f32_32x32x16_bf16 v[40:55], v[116:119], v[20:23], v[56:71]
    s_mov_b64 exec, s[40:41]
    ds_read_b128 v[108:111], v15 offset:17408
    ds_read_b128 v[112:115], v15 offset:17920
    s_mov_b64 exec, -1
    ds_read_b128 v[116:119], v14 offset:18432
    v_exp_f32 v29, v29
    v_exp_f32 v30, v30
    v_exp_f32 v31, v31
    v_exp_f32 v32, v32
    v_exp_f32 v33, v33
    s_waitcnt lgkmcnt(3)
    v_smfmac_f32_32x32x32_bf16 v[72:87], v[120:123], v[24:31], v13
    v_exp_f32 v34, v34
    v_exp_f32 v35, v35
    v_exp_f32 v36, v36
    v_exp_f32 v37, v37
    v_exp_f32 v38, v38
    v_exp_f32 v39, v39
    v_exp_f32 v40, v40
    v_exp_f32 v41, v41
    v_smfmac_f32_32x32x32_bf16 v[72:87], v[124:127], v[32:39], v13
    v_exp_f32 v42, v42
    v_exp_f32 v43, v43
    v_exp_f32 v44, v44
    v_mfma_f32_32x32x16_bf16 v[24:39], v[104:107], v[16:19], v[56:71]
    v_exp_f32 v45, v45
    v_exp_f32 v46, v46
    v_exp_f32 v47, v47
    v_exp_f32 v48, v48
    v_exp_f32 v49, v49
    v_smfmac_f32_32x32x32_bf16 v[88:103], v[120:123], v[40:47], v13
    v_exp_f32 v50, v50
    v_exp_f32 v51, v51
    v_exp_f32 v52, v52
    v_exp_f32 v53, v53
    v_exp_f32 v54, v54
    v_exp_f32 v55, v55
    v_exp_f32 v24, v24
    v_exp_f32 v25, v25
    v_smfmac_f32_32x32x32_bf16 v[88:103], v[124:127], v[48:55], v13
    v_exp_f32 v26, v26
    v_exp_f32 v27, v27
    v_exp_f32 v28, v28
    v_mfma_f32_32x32x16_bf16 v[40:55], v[104:107], v[20:23], v[56:71]
    s_mov_b64 exec, s[40:41]
    ds_read_b128 v[120:123], v15 offset:19456
    ds_read_b128 v[124:127], v15 offset:19968
    s_mov_b64 exec, -1
    ds_read_b128 v[104:107], v14 offset:20480
    v_exp_f32 v29, v29
    v_exp_f32 v30, v30
    v_exp_f32 v31, v31
    v_exp_f32 v32, v32
    v_exp_f32 v33, v33
    s_waitcnt lgkmcnt(3)
    v_smfmac_f32_32x32x32_bf16 v[72:87], v[108:111], v[24:31], v13
    v_exp_f32 v34, v34
    v_exp_f32 v35, v35
    v_exp_f32 v36, v36
    v_exp_f32 v37, v37
    v_exp_f32 v38, v38
    v_exp_f32 v39, v39
    v_exp_f32 v40, v40
    v_exp_f32 v41, v41
    v_smfmac_f32_32x32x32_bf16 v[72:87], v[112:115], v[32:39], v13
    v_exp_f32 v42, v42
    v_exp_f32 v43, v43
    v_exp_f32 v44, v44
    v_mfma_f32_32x32x16_bf16 v[24:39], v[116:119], v[16:19], v[56:71]
    v_exp_f32 v45, v45
    v_exp_f32 v46, v46
    v_exp_f32 v47, v47
    v_exp_f32 v48, v48
    v_exp_f32 v49, v49
    v_smfmac_f32_32x32x32_bf16 v[88:103], v[108:111], v[40:47], v13
    v_exp_f32 v50, v50
    v_exp_f32 v51, v51
    v_exp_f32 v52, v52
    v_exp_f32 v53, v53
    v_exp_f32 v54, v54
    v_exp_f32 v55, v55
    v_exp_f32 v24, v24
    v_exp_f32 v25, v25
    v_smfmac_f32_32x32x32_bf16 v[88:103], v[112:115], v[48:55], v13
    v_exp_f32 v26, v26
    v_exp_f32 v27, v27
    v_exp_f32 v28, v28
    v_mfma_f32_32x32x16_bf16 v[40:55], v[116:119], v[20:23], v[56:71]
    s_mov_b64 exec, s[40:41]
    ds_read_b128 v[108:111], v15 offset:21504
    ds_read_b128 v[112:115], v15 offset:22016
    s_mov_b64 exec, -1
    ds_read_b128 v[116:119], v14 offset:22528
    v_exp_f32 v29, v29
    v_exp_f32 v30, v30
    v_exp_f32 v31, v31
    v_exp_f32 v32, v32
    v_exp_f32 v33, v33
    s_waitcnt lgkmcnt(3)
    v_smfmac_f32_32x32x32_bf16 v[72:87], v[120:123], v[24:31], v13
    v_exp_f32 v34, v34
    v_exp_f32 v35, v35
    v_exp_f32 v36, v36
    v_exp_f32 v37, v37
    v_exp_f32 v38, v38
    v_exp_f32 v39, v39
    v_exp_f32 v40, v40
    v_exp_f32 v41, v41
    v_smfmac_f32_32x32x32_bf16 v[72:87], v[124:127], v[32:39], v13
    v_exp_f32 v42, v42
    v_exp_f32 v43, v43
    v_exp_f32 v44, v44
    v_mfma_f32_32x32x16_bf16 v[24:39], v[104:107], v[16:19], v[56:71]
    v_exp_f32 v45, v45
    v_exp_f32 v46, v46
    v_exp_f32 v47, v47
    v_exp_f32 v48, v48
    v_exp_f32 v49, v49
    v_smfmac_f32_32x32x32_bf16 v[88:103], v[120:123], v[40:47], v13
    v_exp_f32 v50, v50
    v_exp_f32 v51, v51
    v_exp_f32 v52, v52
    v_exp_f32 v53, v53
    v_exp_f32 v54, v54
    v_exp_f32 v55, v55
    v_exp_f32 v24, v24
    v_exp_f32 v25, v25
    v_smfmac_f32_32x32x32_bf16 v[88:103], v[124:127], v[48:55], v13
    v_exp_f32 v26, v26
    v_exp_f32 v27, v27
    v_exp_f32 v28, v28
    v_mfma_f32_32x32x16_bf16 v[40:55], v[104:107], v[20:23], v[56:71]
    s_mov_b64 exec, s[40:41]
    ds_read_b128 v[120:123], v15 offset:23552
    ds_read_b128 v[124:127], v15 offset:24064
    s_mov_b64 exec, -1
    ds_read_b128 v[104:107], v14 offset:24576
    v_exp_f32 v29, v29
    v_exp_f32 v30, v30
    v_exp_f32 v31, v31
    v_exp_f32 v32, v32
    v_exp_f32 v33, v33
    s_waitcnt lgkmcnt(3)
    v_smfmac_f32_32x32x32_bf16 v[72:87], v[108:111], v[24:31], v13
    v_exp_f32 v34, v34
    v_exp_f32 v35, v35
    v_exp_f32 v36, v36
    v_exp_f32 v37, v37
    v_exp_f32 v38, v38
    v_exp_f32 v39, v39
    v_exp_f32 v40, v40
    v_exp_f32 v41, v41
    v_smfmac_f32_32x32x32_bf16 v[72:87], v[112:115], v[32:39], v13
    v_exp_f32 v42, v42
    v_exp_f32 v43, v43
    v_exp_f32 v44, v44
    v_mfma_f32_32x32x16_bf16 v[24:39], v[116:119], v[16:19], v[56:71]
    v_exp_f32 v45, v45
    v_exp_f32 v46, v46
    v_exp_f32 v47, v47
    v_exp_f32 v48, v48
    v_exp_f32 v49, v49
    v_smfmac_f32_32x32x32_bf16 v[88:103], v[108:111], v[40:47], v13
    v_exp_f32 v50, v50
    v_exp_f32 v51, v51
    v_exp_f32 v52, v52
    v_exp_f32 v53, v53
    v_exp_f32 v54, v54
    v_exp_f32 v55, v55
    v_exp_f32 v24, v24
    v_exp_f32 v25, v25
    v_smfmac_f32_32x32x32_bf16 v[88:103], v[112:115], v[48:55], v13
    v_exp_f32 v26, v26
    v_exp_f32 v27, v27
    v_exp_f32 v28, v28
    v_mfma_f32_32x32x16_bf16 v[40:55], v[116:119], v[20:23], v[56:71]
    s_barrier
    s_mov_b64 exec, s[40:41]
    ds_read_b128 v[108:111], v15 offset:25600
    ds_read_b128 v[112:115], v15 offset:26112
    s_mov_b64 exec, -1
    ds_read_b128 v[116:119], v14 offset:26624
    v_exp_f32 v29, v29
    v_exp_f32 v30, v30
    v_exp_f32 v31, v31
    v_exp_f32 v32, v32
    v_exp_f32 v33, v33
    s_waitcnt lgkmcnt(3)
    v_smfmac_f32_32x32x32_bf16 v[72:87], v[120:123], v[24:31], v13
    v_exp_f32 v34, v34
    v_exp_f32 v35, v35
    v_exp_f32 v36, v36
    v_exp_f32 v37, v37
    v_exp_f32 v38, v38
    v_exp_f32 v39, v39
    v_exp_f32 v40, v40
    v_exp_f32 v41, v41
    v_smfmac_f32_32x32x32_bf16 v[72:87], v[124:127], v[32:39], v13
    v_exp_f32 v42, v42
    v_exp_f32 v43, v43
    v_exp_f32 v44, v44
    v_mfma_f32_32x32x16_bf16 v[24:39], v[104:107], v[16:19], v[56:71]
    ds_read_b128 v[160:163], v7 offset:0
    ds_read_b128 v[164:167], v7 offset:1024
    ds_read_b128 v[168:171], v7 offset:2048
    ds_read_b128 v[172:175], v7 offset:3072
    v_exp_f32 v45, v45
    v_exp_f32 v46, v46
    v_exp_f32 v47, v47
    v_exp_f32 v48, v48
    v_exp_f32 v49, v49
    v_smfmac_f32_32x32x32_bf16 v[88:103], v[120:123], v[40:47], v13
    v_exp_f32 v50, v50
    v_exp_f32 v51, v51
    v_exp_f32 v52, v52
    v_exp_f32 v53, v53
    v_exp_f32 v54, v54
    v_exp_f32 v55, v55
    v_exp_f32 v24, v24
    v_exp_f32 v25, v25
    v_smfmac_f32_32x32x32_bf16 v[88:103], v[124:127], v[48:55], v13
    v_exp_f32 v26, v26
    v_exp_f32 v27, v27
    v_exp_f32 v28, v28
    v_mfma_f32_32x32x16_bf16 v[40:55], v[104:107], v[20:23], v[56:71]
    s_mov_b64 exec, s[40:41]
    ds_read_b128 v[120:123], v15 offset:27648
    ds_read_b128 v[124:127], v15 offset:28160
    s_mov_b64 exec, -1
    ds_read_b128 v[104:107], v14 offset:28672
    v_exp_f32 v29, v29
    v_exp_f32 v30, v30
    v_exp_f32 v31, v31
    v_exp_f32 v32, v32
    v_exp_f32 v33, v33
    s_waitcnt lgkmcnt(3)
    v_smfmac_f32_32x32x32_bf16 v[72:87], v[108:111], v[24:31], v13
    v_exp_f32 v34, v34
    v_exp_f32 v35, v35
    v_exp_f32 v36, v36
    v_exp_f32 v37, v37
    v_exp_f32 v38, v38
    v_exp_f32 v39, v39
    v_exp_f32 v40, v40
    v_exp_f32 v41, v41
    v_smfmac_f32_32x32x32_bf16 v[72:87], v[112:115], v[32:39], v13
    v_exp_f32 v42, v42
    v_exp_f32 v43, v43
    v_exp_f32 v44, v44
    v_mfma_f32_32x32x16_bf16 v[24:39], v[116:119], v[16:19], v[56:71]
    ds_read_b128 v[176:179], v7 offset:4096
    ds_read_b128 v[180:183], v7 offset:5120
    ds_read_b128 v[184:187], v7 offset:6144
    ds_read_b128 v[188:191], v7 offset:7168
    v_exp_f32 v45, v45
    v_exp_f32 v46, v46
    v_exp_f32 v47, v47
    v_exp_f32 v48, v48
    v_exp_f32 v49, v49
    v_smfmac_f32_32x32x32_bf16 v[88:103], v[108:111], v[40:47], v13
    v_exp_f32 v50, v50
    v_exp_f32 v51, v51
    v_exp_f32 v52, v52
    v_exp_f32 v53, v53
    v_exp_f32 v54, v54
    v_exp_f32 v55, v55
    v_exp_f32 v24, v24
    v_exp_f32 v25, v25
    v_smfmac_f32_32x32x32_bf16 v[88:103], v[112:115], v[48:55], v13
    v_exp_f32 v26, v26
    v_exp_f32 v27, v27
    v_exp_f32 v28, v28
    v_mfma_f32_32x32x16_bf16 v[40:55], v[116:119], v[20:23], v[56:71]
    s_mov_b64 exec, s[40:41]
    ds_read_b128 v[108:111], v15 offset:29696
    ds_read_b128 v[112:115], v15 offset:30208
    s_mov_b64 exec, -1
    ds_read_b128 v[116:119], v14 offset:30720
    v_exp_f32 v29, v29
    v_exp_f32 v30, v30
    v_exp_f32 v31, v31
    v_exp_f32 v32, v32
    v_exp_f32 v33, v33
    s_waitcnt lgkmcnt(3)
    v_smfmac_f32_32x32x32_bf16 v[72:87], v[120:123], v[24:31], v13
    v_exp_f32 v34, v34
    v_exp_f32 v35, v35
    v_exp_f32 v36, v36
    v_exp_f32 v37, v37
    v_exp_f32 v38, v38
    v_exp_f32 v39, v39
    v_exp_f32 v40, v40
    v_exp_f32 v41, v41
    v_smfmac_f32_32x32x32_bf16 v[72:87], v[124:127], v[32:39], v13
    v_exp_f32 v42, v42
    v_exp_f32 v43, v43
    v_exp_f32 v44, v44
    v_mfma_f32_32x32x16_bf16 v[24:39], v[104:107], v[16:19], v[56:71]
    ds_read_b128 v[192:195], v7 offset:8192
    ds_read_b128 v[196:199], v7 offset:9216
    ds_read_b128 v[200:203], v7 offset:10240
    ds_read_b128 v[204:207], v7 offset:11264
    v_exp_f32 v45, v45
    v_exp_f32 v46, v46
    v_exp_f32 v47, v47
    v_exp_f32 v48, v48
    v_exp_f32 v49, v49
    v_smfmac_f32_32x32x32_bf16 v[88:103], v[120:123], v[40:47], v13
    v_exp_f32 v50, v50
    v_exp_f32 v51, v51
    v_exp_f32 v52, v52
    v_exp_f32 v53, v53
    v_exp_f32 v54, v54
    v_exp_f32 v55, v55
    v_exp_f32 v24, v24
    v_exp_f32 v25, v25
    v_smfmac_f32_32x32x32_bf16 v[88:103], v[124:127], v[48:55], v13
    v_exp_f32 v26, v26
    v_exp_f32 v27, v27
    v_exp_f32 v28, v28
    v_mfma_f32_32x32x16_bf16 v[40:55], v[104:107], v[20:23], v[56:71]
    s_mov_b64 exec, s[40:41]
    ds_read_b128 v[120:123], v15 offset:31744
    ds_read_b128 v[124:127], v15 offset:32256
    s_mov_b64 exec, -1
    ds_read_b128 v[104:107], v14 offset:32768
    v_exp_f32 v29, v29
    v_exp_f32 v30, v30
    v_exp_f32 v31, v31
    v_exp_f32 v32, v32
    v_exp_f32 v33, v33
    s_waitcnt lgkmcnt(3)
    v_smfmac_f32_32x32x32_bf16 v[72:87], v[108:111], v[24:31], v13
    v_exp_f32 v34, v34
    v_exp_f32 v35, v35
    v_exp_f32 v36, v36
    v_exp_f32 v37, v37
    v_exp_f32 v38, v38
    v_exp_f32 v39, v39
    v_exp_f32 v40, v40
    v_exp_f32 v41, v41
    v_smfmac_f32_32x32x32_bf16 v[72:87], v[112:115], v[32:39], v13
    v_exp_f32 v42, v42
    v_exp_f32 v43, v43
    v_exp_f32 v44, v44
    v_mfma_f32_32x32x16_bf16 v[24:39], v[116:119], v[16:19], v[56:71]
    ds_read_b128 v[208:211], v7 offset:12288
    ds_read_b128 v[212:215], v7 offset:13312
    ds_read_b128 v[216:219], v7 offset:14336
    ds_read_b128 v[220:223], v7 offset:15360
    v_exp_f32 v45, v45
    v_exp_f32 v46, v46
    v_exp_f32 v47, v47
    v_exp_f32 v48, v48
    v_exp_f32 v49, v49
    v_smfmac_f32_32x32x32_bf16 v[88:103], v[108:111], v[40:47], v13
    v_exp_f32 v50, v50
    v_exp_f32 v51, v51
    v_exp_f32 v52, v52
    v_exp_f32 v53, v53
    v_exp_f32 v54, v54
    v_exp_f32 v55, v55
    v_exp_f32 v24, v24
    v_exp_f32 v25, v25
    v_smfmac_f32_32x32x32_bf16 v[88:103], v[112:115], v[48:55], v13
    v_exp_f32 v26, v26
    v_exp_f32 v27, v27
    v_exp_f32 v28, v28
    v_mfma_f32_32x32x16_bf16 v[40:55], v[116:119], v[20:23], v[56:71]
    s_mov_b64 exec, s[40:41]
    ds_read_b128 v[108:111], v15 offset:33792
    ds_read_b128 v[112:115], v15 offset:34304
    s_mov_b64 exec, -1
    ds_read_b128 v[116:119], v14 offset:34816
    v_exp_f32 v29, v29
    v_exp_f32 v30, v30
    v_exp_f32 v31, v31
    v_exp_f32 v32, v32
    v_exp_f32 v33, v33
    s_waitcnt lgkmcnt(3)
    v_smfmac_f32_32x32x32_bf16 v[72:87], v[120:123], v[24:31], v13
    v_exp_f32 v34, v34
    v_exp_f32 v35, v35
    v_exp_f32 v36, v36
    v_exp_f32 v37, v37
    v_exp_f32 v38, v38
    v_exp_f32 v39, v39
    v_exp_f32 v40, v40
    v_exp_f32 v41, v41
    v_smfmac_f32_32x32x32_bf16 v[72:87], v[124:127], v[32:39], v13
    v_exp_f32 v42, v42
    v_exp_f32 v43, v43
    v_exp_f32 v44, v44
    v_mfma_f32_32x32x16_bf16 v[24:39], v[104:107], v[16:19], v[56:71]
    v_exp_f32 v45, v45
    v_exp_f32 v46, v46
    v_exp_f32 v47, v47
    v_exp_f32 v48, v48
    v_exp_f32 v49, v49
    v_smfmac_f32_32x32x32_bf16 v[88:103], v[120:123], v[40:47], v13
    v_exp_f32 v50, v50
    v_exp_f32 v51, v51
    v_exp_f32 v52, v52
    v_exp_f32 v53, v53
    v_exp_f32 v54, v54
    v_exp_f32 v55, v55
    v_exp_f32 v24, v24
    v_exp_f32 v25, v25
    v_smfmac_f32_32x32x32_bf16 v[88:103], v[124:127], v[48:55], v13
    v_exp_f32 v26, v26
    v_exp_f32 v27, v27
    v_exp_f32 v28, v28
    v_mfma_f32_32x32x16_bf16 v[40:55], v[104:107], v[20:23], v[56:71]
    s_mov_b64 exec, s[40:41]
    ds_read_b128 v[120:123], v15 offset:35840
    ds_read_b128 v[124:127], v15 offset:36352
    s_mov_b64 exec, -1
    ds_read_b128 v[104:107], v14 offset:36864
    v_exp_f32 v29, v29
    v_exp_f32 v30, v30
    v_exp_f32 v31, v31
    v_exp_f32 v32, v32
    v_exp_f32 v33, v33
    s_waitcnt lgkmcnt(3)
    v_smfmac_f32_32x32x32_bf16 v[72:87], v[108:111], v[24:31], v13
    v_exp_f32 v34, v34
    v_exp_f32 v35, v35
    v_exp_f32 v36, v36
    v_exp_f32 v37, v37
    v_exp_f32 v38, v38
    v_exp_f32 v39, v39
    v_exp_f32 v40, v40
    v_exp_f32 v41, v41
    v_smfmac_f32_32x32x32_bf16 v[72:87], v[112:115], v[32:39], v13
    v_exp_f32 v42, v42
    v_exp_f32 v43, v43
    v_exp_f32 v44, v44
    v_mfma_f32_32x32x16_bf16 v[24:39], v[116:119], v[16:19], v[56:71]
    v_exp_f32 v45, v45
    v_exp_f32 v46, v46
    v_exp_f32 v47, v47
    v_exp_f32 v48, v48
    v_exp_f32 v49, v49
    v_smfmac_f32_32x32x32_bf16 v[88:103], v[108:111], v[40:47], v13
    v_exp_f32 v50, v50
    v_exp_f32 v51, v51
    v_exp_f32 v52, v52
    v_exp_f32 v53, v53
    v_exp_f32 v54, v54
    v_exp_f32 v55, v55
    v_exp_f32 v24, v24
    v_exp_f32 v25, v25
    v_smfmac_f32_32x32x32_bf16 v[88:103], v[112:115], v[48:55], v13
    v_exp_f32 v26, v26
    v_exp_f32 v27, v27
    v_exp_f32 v28, v28
    v_mfma_f32_32x32x16_bf16 v[40:55], v[116:119], v[20:23], v[56:71]
    s_barrier
    s_mov_b64 exec, s[40:41]
    ds_read_b128 v[108:111], v15 offset:37888
    ds_read_b128 v[112:115], v15 offset:38400
    s_mov_b64 exec, -1
    ds_read_b128 v[116:119], v14 offset:38912
    v_exp_f32 v29, v29
    v_exp_f32 v30, v30
    v_exp_f32 v31, v31
    v_exp_f32 v32, v32
    v_exp_f32 v33, v33
    s_waitcnt lgkmcnt(3)
    v_smfmac_f32_32x32x32_bf16 v[72:87], v[120:123], v[24:31], v13
    v_exp_f32 v34, v34
    v_exp_f32 v35, v35
    v_exp_f32 v36, v36
    v_exp_f32 v37, v37
    v_exp_f32 v38, v38
    v_exp_f32 v39, v39
    v_exp_f32 v40, v40
    v_exp_f32 v41, v41
    v_smfmac_f32_32x32x32_bf16 v[72:87], v[124:127], v[32:39], v13
    v_exp_f32 v42, v42
    v_exp_f32 v43, v43
    v_exp_f32 v44, v44
    v_mfma_f32_32x32x16_bf16 v[24:39], v[104:107], v[16:19], v[56:71]
    ds_read_b128 v[224:227], v6 offset:0
    ds_read_b128 v[228:231], v6 offset:1024
    ds_read_b128 v[232:235], v6 offset:2048
    ds_read_b128 v[236:239], v6 offset:3072
    v_exp_f32 v45, v45
    v_exp_f32 v46, v46
    v_exp_f32 v47, v47
    v_exp_f32 v48, v48
    v_exp_f32 v49, v49
    v_smfmac_f32_32x32x32_bf16 v[88:103], v[120:123], v[40:47], v13
    v_exp_f32 v50, v50
    v_exp_f32 v51, v51
    v_exp_f32 v52, v52
    v_exp_f32 v53, v53
    v_exp_f32 v54, v54
    v_exp_f32 v55, v55
    v_exp_f32 v24, v24
    v_exp_f32 v25, v25
    v_smfmac_f32_32x32x32_bf16 v[88:103], v[124:127], v[48:55], v13
    v_exp_f32 v26, v26
    v_exp_f32 v27, v27
    v_exp_f32 v28, v28
    v_mfma_f32_32x32x16_bf16 v[40:55], v[104:107], v[20:23], v[56:71]
    s_mov_b64 exec, s[40:41]
    ds_read_b128 v[120:123], v15 offset:39936
    ds_read_b128 v[124:127], v15 offset:40448
    s_mov_b64 exec, -1
    ds_read_b128 v[104:107], v14 offset:40960
    v_exp_f32 v29, v29
    v_exp_f32 v30, v30
    v_exp_f32 v31, v31
    v_exp_f32 v32, v32
    v_exp_f32 v33, v33
    s_waitcnt lgkmcnt(3)
    v_smfmac_f32_32x32x32_bf16 v[72:87], v[108:111], v[24:31], v13
    v_exp_f32 v34, v34
    v_exp_f32 v35, v35
    v_exp_f32 v36, v36
    v_exp_f32 v37, v37
    v_exp_f32 v38, v38
    v_exp_f32 v39, v39
    v_exp_f32 v40, v40
    v_exp_f32 v41, v41
    v_smfmac_f32_32x32x32_bf16 v[72:87], v[112:115], v[32:39], v13
    v_exp_f32 v42, v42
    v_exp_f32 v43, v43
    v_exp_f32 v44, v44
    v_mfma_f32_32x32x16_bf16 v[24:39], v[116:119], v[16:19], v[56:71]
    ds_read_b128 v[240:243], v6 offset:4096
    ds_read_b128 v[244:247], v6 offset:5120
    ds_read_b128 v[248:251], v6 offset:6144
    ds_read_b128 v[252:255], v6 offset:7168
    v_exp_f32 v45, v45
    v_exp_f32 v46, v46
    v_exp_f32 v47, v47
    v_exp_f32 v48, v48
    v_exp_f32 v49, v49
    v_smfmac_f32_32x32x32_bf16 v[88:103], v[108:111], v[40:47], v13
    v_exp_f32 v50, v50
    v_exp_f32 v51, v51
    v_exp_f32 v52, v52
    v_exp_f32 v53, v53
    v_exp_f32 v54, v54
    v_exp_f32 v55, v55
    v_exp_f32 v24, v24
    v_exp_f32 v25, v25
    v_smfmac_f32_32x32x32_bf16 v[88:103], v[112:115], v[48:55], v13
    v_exp_f32 v26, v26
    v_exp_f32 v27, v27
    v_exp_f32 v28, v28
    v_mfma_f32_32x32x16_bf16 v[40:55], v[116:119], v[20:23], v[56:71]
    s_mov_b64 exec, s[40:41]
    ds_read_b128 v[108:111], v15 offset:41984
    ds_read_b128 v[112:115], v15 offset:42496
    s_mov_b64 exec, -1
    ds_read_b128 v[116:119], v14 offset:43008
    v_exp_f32 v29, v29
    v_exp_f32 v30, v30
    v_exp_f32 v31, v31
    v_exp_f32 v32, v32
    v_exp_f32 v33, v33
    s_waitcnt lgkmcnt(3)
    v_smfmac_f32_32x32x32_bf16 v[72:87], v[120:123], v[24:31], v13
    v_exp_f32 v34, v34
    v_exp_f32 v35, v35
    v_exp_f32 v36, v36
    v_exp_f32 v37, v37
    v_exp_f32 v38, v38
    v_exp_f32 v39, v39
    v_exp_f32 v40, v40
    v_exp_f32 v41, v41
    v_smfmac_f32_32x32x32_bf16 v[72:87], v[124:127], v[32:39], v13
    v_exp_f32 v42, v42
    v_exp_f32 v43, v43
    v_exp_f32 v44, v44
    v_mfma_f32_32x32x16_bf16 v[24:39], v[104:107], v[16:19], v[56:71]
    v_exp_f32 v45, v45
    v_exp_f32 v46, v46
    v_exp_f32 v47, v47
    v_exp_f32 v48, v48
    v_exp_f32 v49, v49
    v_smfmac_f32_32x32x32_bf16 v[88:103], v[120:123], v[40:47], v13
    v_exp_f32 v50, v50
    v_exp_f32 v51, v51
    v_exp_f32 v52, v52
    v_exp_f32 v53, v53
    v_exp_f32 v54, v54
    v_exp_f32 v55, v55
    v_exp_f32 v24, v24
    v_exp_f32 v25, v25
    v_smfmac_f32_32x32x32_bf16 v[88:103], v[124:127], v[48:55], v13
    v_exp_f32 v26, v26
    v_exp_f32 v27, v27
    v_exp_f32 v28, v28
    v_mfma_f32_32x32x16_bf16 v[40:55], v[104:107], v[20:23], v[56:71]
    s_barrier
    s_mov_b64 exec, s[40:41]
    ds_read_b128 v[120:123], v15 offset:44032
    ds_read_b128 v[124:127], v15 offset:44544
    s_mov_b64 exec, -1
    ds_read_b128 v[104:107], v14 offset:45056
    v_exp_f32 v29, v29
    v_exp_f32 v30, v30
    v_exp_f32 v31, v31
    v_exp_f32 v32, v32
    v_exp_f32 v33, v33
    s_waitcnt lgkmcnt(3)
    v_smfmac_f32_32x32x32_bf16 v[72:87], v[108:111], v[24:31], v13
    v_exp_f32 v34, v34
    v_exp_f32 v35, v35
    v_exp_f32 v36, v36
    v_exp_f32 v37, v37
    v_exp_f32 v38, v38
    v_exp_f32 v39, v39
    v_exp_f32 v40, v40
    v_exp_f32 v41, v41
    v_smfmac_f32_32x32x32_bf16 v[72:87], v[112:115], v[32:39], v13
    v_exp_f32 v42, v42
    v_exp_f32 v43, v43
    v_exp_f32 v44, v44
    v_mfma_f32_32x32x16_bf16 v[24:39], v[116:119], v[16:19], v[56:71]
    v_exp_f32 v45, v45
    v_exp_f32 v46, v46
    v_exp_f32 v47, v47
    v_exp_f32 v48, v48
    v_exp_f32 v49, v49
    v_smfmac_f32_32x32x32_bf16 v[88:103], v[108:111], v[40:47], v13
    v_exp_f32 v50, v50
    v_exp_f32 v51, v51
    v_exp_f32 v52, v52
    v_exp_f32 v53, v53
    v_exp_f32 v54, v54
    v_exp_f32 v55, v55
    v_exp_f32 v24, v24
    v_exp_f32 v25, v25
    v_smfmac_f32_32x32x32_bf16 v[88:103], v[112:115], v[48:55], v13
    v_exp_f32 v26, v26
    v_exp_f32 v27, v27
    v_exp_f32 v28, v28
    v_mfma_f32_32x32x16_bf16 v[40:55], v[116:119], v[20:23], v[56:71]
    s_mov_b64 exec, s[40:41]
    ds_read_b128 v[108:111], v15 offset:46080
    ds_read_b128 v[112:115], v15 offset:46592
    s_mov_b64 exec, -1
    ds_read_b128 v[116:119], v14 offset:47104
    v_exp_f32 v29, v29
    v_exp_f32 v30, v30
    v_exp_f32 v31, v31
    v_exp_f32 v32, v32
    v_exp_f32 v33, v33
    s_waitcnt lgkmcnt(3)
    v_smfmac_f32_32x32x32_bf16 v[72:87], v[120:123], v[24:31], v13
    v_exp_f32 v34, v34
    v_exp_f32 v35, v35
    v_exp_f32 v36, v36
    v_exp_f32 v37, v37
    v_exp_f32 v38, v38
    v_exp_f32 v39, v39
    v_exp_f32 v40, v40
    v_exp_f32 v41, v41
    v_smfmac_f32_32x32x32_bf16 v[72:87], v[124:127], v[32:39], v13
    v_exp_f32 v42, v42
    v_exp_f32 v43, v43
    v_exp_f32 v44, v44
    v_mfma_f32_32x32x16_bf16 v[24:39], v[104:107], v[16:19], v[56:71]
    v_exp_f32 v45, v45
    v_exp_f32 v46, v46
    v_exp_f32 v47, v47
    v_exp_f32 v48, v48
    v_exp_f32 v49, v49
    v_smfmac_f32_32x32x32_bf16 v[88:103], v[120:123], v[40:47], v13
    v_exp_f32 v50, v50
    v_exp_f32 v51, v51
    v_exp_f32 v52, v52
    v_exp_f32 v53, v53
    v_exp_f32 v54, v54
    v_exp_f32 v55, v55
    v_exp_f32 v24, v24
    v_exp_f32 v25, v25
    v_smfmac_f32_32x32x32_bf16 v[88:103], v[124:127], v[48:55], v13
    v_exp_f32 v26, v26
    v_exp_f32 v27, v27
    v_exp_f32 v28, v28
    v_mfma_f32_32x32x16_bf16 v[40:55], v[104:107], v[20:23], v[56:71]
    s_mov_b64 exec, s[40:41]
    ds_read_b128 v[120:123], v15 offset:48128
    ds_read_b128 v[124:127], v15 offset:48640
    s_mov_b64 exec, -1
    ds_read_b128 v[104:107], v14 offset:49152
    v_exp_f32 v29, v29
    v_exp_f32 v30, v30
    v_exp_f32 v31, v31
    v_exp_f32 v32, v32
    v_exp_f32 v33, v33
    s_waitcnt lgkmcnt(3)
    v_smfmac_f32_32x32x32_bf16 v[72:87], v[108:111], v[24:31], v13
    v_exp_f32 v34, v34
    v_exp_f32 v35, v35
    v_exp_f32 v36, v36
    v_exp_f32 v37, v37
    v_exp_f32 v38, v38
    v_exp_f32 v39, v39
    v_exp_f32 v40, v40
    v_exp_f32 v41, v41
    v_smfmac_f32_32x32x32_bf16 v[72:87], v[112:115], v[32:39], v13
    v_exp_f32 v42, v42
    v_exp_f32 v43, v43
    v_exp_f32 v44, v44
    v_mfma_f32_32x32x16_bf16 v[24:39], v[116:119], v[16:19], v[56:71]
    v_exp_f32 v45, v45
    v_exp_f32 v46, v46
    v_exp_f32 v47, v47
    v_exp_f32 v48, v48
    v_exp_f32 v49, v49
    v_smfmac_f32_32x32x32_bf16 v[88:103], v[108:111], v[40:47], v13
    v_exp_f32 v50, v50
    v_exp_f32 v51, v51
    v_exp_f32 v52, v52
    v_exp_f32 v53, v53
    v_exp_f32 v54, v54
    v_exp_f32 v55, v55
    v_exp_f32 v24, v24
    v_exp_f32 v25, v25
    v_smfmac_f32_32x32x32_bf16 v[88:103], v[112:115], v[48:55], v13
    v_exp_f32 v26, v26
    v_exp_f32 v27, v27
    v_exp_f32 v28, v28
    v_mfma_f32_32x32x16_bf16 v[40:55], v[116:119], v[20:23], v[56:71]
    s_mov_b64 exec, s[40:41]
    ds_read_b128 v[108:111], v15 offset:50176
    ds_read_b128 v[112:115], v15 offset:50688
    s_mov_b64 exec, -1
    ds_read_b128 v[116:119], v14 offset:51200
    v_exp_f32 v29, v29
    v_exp_f32 v30, v30
    v_exp_f32 v31, v31
    v_exp_f32 v32, v32
    v_exp_f32 v33, v33
    s_waitcnt lgkmcnt(3)
    v_smfmac_f32_32x32x32_bf16 v[72:87], v[120:123], v[24:31], v13
    v_exp_f32 v34, v34
    v_exp_f32 v35, v35
    v_exp_f32 v36, v36
    v_exp_f32 v37, v37
    v_exp_f32 v38, v38
    v_exp_f32 v39, v39
    v_exp_f32 v40, v40
    v_exp_f32 v41, v41
    v_smfmac_f32_32x32x32_bf16 v[72:87], v[124:127], v[32:39], v13
    v_exp_f32 v42, v42
    v_exp_f32 v43, v43
    v_exp_f32 v44, v44
    v_mfma_f32_32x32x16_bf16 v[24:39], v[104:107], v[16:19], v[56:71]
    v_exp_f32 v45, v45
    v_exp_f32 v46, v46
    v_exp_f32 v47, v47
    v_exp_f32 v48, v48
    v_exp_f32 v49, v49
    v_smfmac_f32_32x32x32_bf16 v[88:103], v[120:123], v[40:47], v13
    v_exp_f32 v50, v50
    v_exp_f32 v51, v51
    v_exp_f32 v52, v52
    v_exp_f32 v53, v53
    v_exp_f32 v54, v54
    v_exp_f32 v55, v55
    v_exp_f32 v24, v24
    v_exp_f32 v25, v25
    v_smfmac_f32_32x32x32_bf16 v[88:103], v[124:127], v[48:55], v13
    v_exp_f32 v26, v26
    v_exp_f32 v27, v27
    v_exp_f32 v28, v28
    v_mfma_f32_32x32x16_bf16 v[40:55], v[104:107], v[20:23], v[56:71]
    s_mov_b64 exec, s[40:41]
    ds_read_b128 v[120:123], v15 offset:52224
    ds_read_b128 v[124:127], v15 offset:52736
    s_mov_b64 exec, -1
    ds_read_b128 v[104:107], v14 offset:53248
    v_exp_f32 v29, v29
    v_exp_f32 v30, v30
    v_exp_f32 v31, v31
    v_exp_f32 v32, v32
    v_exp_f32 v33, v33
    s_waitcnt lgkmcnt(3)
    v_smfmac_f32_32x32x32_bf16 v[72:87], v[108:111], v[24:31], v13
    v_exp_f32 v34, v34
    v_exp_f32 v35, v35
    v_exp_f32 v36, v36
    v_exp_f32 v37, v37
    v_exp_f32 v38, v38
    v_exp_f32 v39, v39
    v_exp_f32 v40, v40
    v_exp_f32 v41, v41
    v_smfmac_f32_32x32x32_bf16 v[72:87], v[112:115], v[32:39], v13
    v_exp_f32 v42, v42
    v_exp_f32 v43, v43
    v_exp_f32 v44, v44
    v_mfma_f32_32x32x16_bf16 v[24:39], v[116:119], v[16:19], v[56:71]
    v_exp_f32 v45, v45
    v_exp_f32 v46, v46
    v_exp_f32 v47, v47
    v_exp_f32 v48, v48
    v_exp_f32 v49, v49
    v_smfmac_f32_32x32x32_bf16 v[88:103], v[108:111], v[40:47], v13
    v_exp_f32 v50, v50
    v_exp_f32 v51, v51
    v_exp_f32 v52, v52
    v_exp_f32 v53, v53
    v_exp_f32 v54, v54
    v_exp_f32 v55, v55
    v_exp_f32 v24, v24
    v_exp_f32 v25, v25
    v_smfmac_f32_32x32x32_bf16 v[88:103], v[112:115], v[48:55], v13
    v_exp_f32 v26, v26
    v_exp_f32 v27, v27
    v_exp_f32 v28, v28
    v_mfma_f32_32x32x16_bf16 v[40:55], v[116:119], v[20:23], v[56:71]
    s_mov_b64 exec, s[40:41]
    ds_read_b128 v[108:111], v15 offset:54272
    ds_read_b128 v[112:115], v15 offset:54784
    s_mov_b64 exec, -1
    ds_read_b128 v[116:119], v14 offset:55296
    v_exp_f32 v29, v29
    v_exp_f32 v30, v30
    v_exp_f32 v31, v31
    v_exp_f32 v32, v32
    v_exp_f32 v33, v33
    s_waitcnt lgkmcnt(3)
    v_smfmac_f32_32x32x32_bf16 v[72:87], v[120:123], v[24:31], v13
    v_exp_f32 v34, v34
    v_exp_f32 v35, v35
    v_exp_f32 v36, v36
    v_exp_f32 v37, v37
    v_exp_f32 v38, v38
    v_exp_f32 v39, v39
    v_exp_f32 v40, v40
    v_exp_f32 v41, v41
    v_smfmac_f32_32x32x32_bf16 v[72:87], v[124:127], v[32:39], v13
    v_exp_f32 v42, v42
    v_exp_f32 v43, v43
    v_exp_f32 v44, v44
    v_mfma_f32_32x32x16_bf16 v[24:39], v[104:107], v[16:19], v[56:71]
    v_exp_f32 v45, v45
    v_exp_f32 v46, v46
    v_exp_f32 v47, v47
    v_exp_f32 v48, v48
    v_exp_f32 v49, v49
    v_smfmac_f32_32x32x32_bf16 v[88:103], v[120:123], v[40:47], v13
    v_exp_f32 v50, v50
    v_exp_f32 v51, v51
    v_exp_f32 v52, v52
    v_exp_f32 v53, v53
    v_exp_f32 v54, v54
    v_exp_f32 v55, v55
    v_exp_f32 v24, v24
    v_exp_f32 v25, v25
    v_smfmac_f32_32x32x32_bf16 v[88:103], v[124:127], v[48:55], v13
    v_exp_f32 v26, v26
    v_exp_f32 v27, v27
    v_exp_f32 v28, v28
    v_mfma_f32_32x32x16_bf16 v[40:55], v[104:107], v[20:23], v[56:71]
    s_mov_b64 exec, s[40:41]
    ds_read_b128 v[120:123], v15 offset:56320
    ds_read_b128 v[124:127], v15 offset:56832
    s_mov_b64 exec, -1
    ds_read_b128 v[104:107], v14 offset:57344
    v_exp_f32 v29, v29
    v_exp_f32 v30, v30
    v_exp_f32 v31, v31
    v_exp_f32 v32, v32
    v_exp_f32 v33, v33
    s_waitcnt lgkmcnt(3)
    v_smfmac_f32_32x32x32_bf16 v[72:87], v[108:111], v[24:31], v13
    v_exp_f32 v34, v34
    v_exp_f32 v35, v35
    v_exp_f32 v36, v36
    v_exp_f32 v37, v37
    v_exp_f32 v38, v38
    v_exp_f32 v39, v39
    v_exp_f32 v40, v40
    v_exp_f32 v41, v41
    v_smfmac_f32_32x32x32_bf16 v[72:87], v[112:115], v[32:39], v13
    v_exp_f32 v42, v42
    v_exp_f32 v43, v43
    v_exp_f32 v44, v44
    v_mfma_f32_32x32x16_bf16 v[24:39], v[116:119], v[16:19], v[56:71]
    v_exp_f32 v45, v45
    v_exp_f32 v46, v46
    v_exp_f32 v47, v47
    v_exp_f32 v48, v48
    v_exp_f32 v49, v49
    v_smfmac_f32_32x32x32_bf16 v[88:103], v[108:111], v[40:47], v13
    v_exp_f32 v50, v50
    v_exp_f32 v51, v51
    v_exp_f32 v52, v52
    v_exp_f32 v53, v53
    v_exp_f32 v54, v54
    v_exp_f32 v55, v55
    v_exp_f32 v24, v24
    v_exp_f32 v25, v25
    v_smfmac_f32_32x32x32_bf16 v[88:103], v[112:115], v[48:55], v13
    v_exp_f32 v26, v26
    v_exp_f32 v27, v27
    v_exp_f32 v28, v28
    v_mfma_f32_32x32x16_bf16 v[40:55], v[116:119], v[20:23], v[56:71]
    s_mov_b64 exec, s[40:41]
    ds_read_b128 v[108:111], v15 offset:58368
    ds_read_b128 v[112:115], v15 offset:58880
    s_mov_b64 exec, -1
    ds_read_b128 v[116:119], v14 offset:59392
    v_exp_f32 v29, v29
    v_exp_f32 v30, v30
    v_exp_f32 v31, v31
    v_exp_f32 v32, v32
    v_exp_f32 v33, v33
    s_waitcnt lgkmcnt(3)
    v_smfmac_f32_32x32x32_bf16 v[72:87], v[120:123], v[24:31], v13
    v_exp_f32 v34, v34
    v_exp_f32 v35, v35
    v_exp_f32 v36, v36
    v_exp_f32 v37, v37
    v_exp_f32 v38, v38
    v_exp_f32 v39, v39
    v_exp_f32 v40, v40
    v_exp_f32 v41, v41
    v_smfmac_f32_32x32x32_bf16 v[72:87], v[124:127], v[32:39], v13
    v_exp_f32 v42, v42
    v_exp_f32 v43, v43
    v_exp_f32 v44, v44
    v_mfma_f32_32x32x16_bf16 v[24:39], v[104:107], v[16:19], v[56:71]
    v_exp_f32 v45, v45
    v_exp_f32 v46, v46
    v_exp_f32 v47, v47
    v_exp_f32 v48, v48
    v_exp_f32 v49, v49
    v_smfmac_f32_32x32x32_bf16 v[88:103], v[120:123], v[40:47], v13
    v_exp_f32 v50, v50
    v_exp_f32 v51, v51
    v_exp_f32 v52, v52
    v_exp_f32 v53, v53
    v_exp_f32 v54, v54
    v_exp_f32 v55, v55
    v_exp_f32 v24, v24
    v_exp_f32 v25, v25
    v_smfmac_f32_32x32x32_bf16 v[88:103], v[124:127], v[48:55], v13
    v_exp_f32 v26, v26
    v_exp_f32 v27, v27
    v_exp_f32 v28, v28
    v_mfma_f32_32x32x16_bf16 v[40:55], v[104:107], v[20:23], v[56:71]
    s_mov_b64 exec, s[40:41]
    ds_read_b128 v[120:123], v15 offset:60416
    ds_read_b128 v[124:127], v15 offset:60928
    s_mov_b64 exec, -1
    ds_read_b128 v[104:107], v14 offset:61440
    v_exp_f32 v29, v29
    v_exp_f32 v30, v30
    v_exp_f32 v31, v31
    v_exp_f32 v32, v32
    v_exp_f32 v33, v33
    s_waitcnt lgkmcnt(3)
    v_smfmac_f32_32x32x32_bf16 v[72:87], v[108:111], v[24:31], v13
    v_exp_f32 v34, v34
    v_exp_f32 v35, v35
    v_exp_f32 v36, v36
    v_exp_f32 v37, v37
    v_exp_f32 v38, v38
    v_exp_f32 v39, v39
    v_exp_f32 v40, v40
    v_exp_f32 v41, v41
    v_smfmac_f32_32x32x32_bf16 v[72:87], v[112:115], v[32:39], v13
    v_exp_f32 v42, v42
    v_exp_f32 v43, v43
    v_exp_f32 v44, v44
    v_mfma_f32_32x32x16_bf16 v[24:39], v[116:119], v[16:19], v[56:71]
    v_exp_f32 v45, v45
    v_exp_f32 v46, v46
    v_exp_f32 v47, v47
    v_exp_f32 v48, v48
    v_exp_f32 v49, v49
    v_smfmac_f32_32x32x32_bf16 v[88:103], v[108:111], v[40:47], v13
    v_exp_f32 v50, v50
    v_exp_f32 v51, v51
    v_exp_f32 v52, v52
    v_exp_f32 v53, v53
    v_exp_f32 v54, v54
    v_exp_f32 v55, v55
    v_exp_f32 v24, v24
    v_exp_f32 v25, v25
    v_smfmac_f32_32x32x32_bf16 v[88:103], v[112:115], v[48:55], v13
    v_exp_f32 v26, v26
    v_exp_f32 v27, v27
    v_exp_f32 v28, v28
    v_mfma_f32_32x32x16_bf16 v[40:55], v[116:119], v[20:23], v[56:71]
    s_mov_b64 exec, s[40:41]
    ds_read_b128 v[108:111], v15 offset:62464
    ds_read_b128 v[112:115], v15 offset:62976
    s_mov_b64 exec, -1
    ds_read_b128 v[116:119], v14 offset:63488
    v_exp_f32 v29, v29
    v_exp_f32 v30, v30
    v_exp_f32 v31, v31
    v_exp_f32 v32, v32
    v_exp_f32 v33, v33
    s_waitcnt lgkmcnt(3)
    v_smfmac_f32_32x32x32_bf16 v[72:87], v[120:123], v[24:31], v13
    v_exp_f32 v34, v34
    v_exp_f32 v35, v35
    v_exp_f32 v36, v36
    v_exp_f32 v37, v37
    v_exp_f32 v38, v38
    v_exp_f32 v39, v39
    v_exp_f32 v40, v40
    v_exp_f32 v41, v41
    v_smfmac_f32_32x32x32_bf16 v[72:87], v[124:127], v[32:39], v13
    v_exp_f32 v42, v42
    v_exp_f32 v43, v43
    v_exp_f32 v44, v44
    v_mfma_f32_32x32x16_bf16 v[24:39], v[104:107], v[16:19], v[56:71]
    v_exp_f32 v45, v45
    v_exp_f32 v46, v46
    v_exp_f32 v47, v47
    v_exp_f32 v48, v48
    v_exp_f32 v49, v49
    v_smfmac_f32_32x32x32_bf16 v[88:103], v[120:123], v[40:47], v13
    v_exp_f32 v50, v50
    v_exp_f32 v51, v51
    v_exp_f32 v52, v52
    v_exp_f32 v53, v53
    v_exp_f32 v54, v54
    v_exp_f32 v55, v55
    v_exp_f32 v24, v24
    v_exp_f32 v25, v25
    v_smfmac_f32_32x32x32_bf16 v[88:103], v[124:127], v[48:55], v13
    v_exp_f32 v26, v26
    v_exp_f32 v27, v27
    v_exp_f32 v28, v28
    v_mfma_f32_32x32x16_bf16 v[40:55], v[104:107], v[20:23], v[56:71]
    s_mov_b64 exec, s[40:41]
    ds_read_b128 v[120:123], v15 offset:64512
    ds_read_b128 v[124:127], v15 offset:65024
    s_mov_b64 exec, -1
    v_exp_f32 v29, v29
    v_exp_f32 v30, v30
    v_exp_f32 v31, v31
    v_exp_f32 v32, v32
    v_exp_f32 v33, v33
    s_waitcnt lgkmcnt(2)
    v_smfmac_f32_32x32x32_bf16 v[72:87], v[108:111], v[24:31], v13
    v_exp_f32 v34, v34
    v_exp_f32 v35, v35
    v_exp_f32 v36, v36
    v_exp_f32 v37, v37
    v_exp_f32 v38, v38
    v_exp_f32 v39, v39
    v_exp_f32 v40, v40
    v_exp_f32 v41, v41
    v_smfmac_f32_32x32x32_bf16 v[72:87], v[112:115], v[32:39], v13
    v_exp_f32 v42, v42
    v_exp_f32 v43, v43
    v_exp_f32 v44, v44
    v_mfma_f32_32x32x16_bf16 v[24:39], v[116:119], v[16:19], v[56:71]
    v_exp_f32 v45, v45
    v_exp_f32 v46, v46
    v_exp_f32 v47, v47
    v_exp_f32 v48, v48
    v_exp_f32 v49, v49
    v_smfmac_f32_32x32x32_bf16 v[88:103], v[108:111], v[40:47], v13
    v_exp_f32 v50, v50
    v_exp_f32 v51, v51
    v_exp_f32 v52, v52
    v_exp_f32 v53, v53
    v_exp_f32 v54, v54
    v_exp_f32 v55, v55
    v_exp_f32 v24, v24
    v_exp_f32 v25, v25
    v_smfmac_f32_32x32x32_bf16 v[88:103], v[112:115], v[48:55], v13
    v_exp_f32 v26, v26
    v_exp_f32 v27, v27
    v_exp_f32 v28, v28
    v_mfma_f32_32x32x16_bf16 v[40:55], v[116:119], v[20:23], v[56:71]
    v_exp_f32 v29, v29
    v_exp_f32 v30, v30
    v_exp_f32 v31, v31
    v_exp_f32 v32, v32
    v_exp_f32 v33, v33
    s_waitcnt lgkmcnt(0)
    v_smfmac_f32_32x32x32_bf16 v[72:87], v[120:123], v[24:31], v13
    v_exp_f32 v34, v34
    v_exp_f32 v35, v35
    v_exp_f32 v36, v36
    v_exp_f32 v37, v37
    v_exp_f32 v38, v38
    v_exp_f32 v39, v39
    v_exp_f32 v40, v40
    v_exp_f32 v41, v41
    v_smfmac_f32_32x32x32_bf16 v[72:87], v[124:127], v[32:39], v13
    v_exp_f32 v42, v42
    v_exp_f32 v43, v43
    v_exp_f32 v44, v44
    v_exp_f32 v45, v45
    v_exp_f32 v46, v46
    v_exp_f32 v47, v47
    v_exp_f32 v48, v48
    v_exp_f32 v49, v49
    v_smfmac_f32_32x32x32_bf16 v[88:103], v[120:123], v[40:47], v13
    v_exp_f32 v50, v50
    v_exp_f32 v51, v51
    v_exp_f32 v52, v52
    v_exp_f32 v53, v53
    v_exp_f32 v54, v54
    v_exp_f32 v55, v55
    s_nop 1
    v_smfmac_f32_32x32x32_bf16 v[88:103], v[124:127], v[48:55], v13
    v_lshrrev_b32 v7, 5, v0
    v_lshlrev_b32 v7, 10, v7
    v_and_b32 v8, 31, v0
    v_lshl_add_u32 v10, v8, 4, v7
    s_lshl_b32 s21, s38, 11
    s_add_u32 s21, s21, s31
    s_add_u32 s21, s21, 0x10000
    s_nop 4
    v_min_f32 v6, v80, v96
    v_max_f32 v7, v80, v96
    v_cmp_nle_f32 vcc, 0x17800000, v6
    s_nop 0
    s_mov_b32 s22, vcc_lo
    v_cmp_nge_f32 vcc, 0x67800000, v7
    s_nop 0
    s_or_b32 s22, s22, vcc_lo
    s_cbranch_scc1 attn_redo
attn_done:
    v_mov_b32 v81, v80
    v_mov_b32 v97, v96
    s_nop 0
    v_permlane32_swap_b32 v80, v81
    v_permlane32_swap_b32 v96, v97
    v_rcp_f32 v8, v80
    v_rcp_f32 v12, v96
    v_pk_mul_f32 v[72:73], v[72:73], v[8:9] op_sel_hi:[1,0]
    v_pk_mul_f32 v[74:75], v[74:75], v[8:9] op_sel_hi:[1,0]
    v_pk_mul_f32 v[76:77], v[76:77], v[8:9] op_sel_hi:[1,0]
    v_pk_mul_f32 v[78:79], v[78:79], v[8:9] op_sel_hi:[1,0]
    v_cvt_pk_bf16_f32 v72, v72, v73
    v_cvt_pk_bf16_f32 v73, v74, v75
    v_cvt_pk_bf16_f32 v74, v76, v77
    v_cvt_pk_bf16_f32 v75, v78, v79
    v_pk_mul_f32 v[88:89], v[88:89], v[12:13] op_sel_hi:[1,0]
    v_pk_mul_f32 v[90:91], v[90:91], v[12:13] op_sel_hi:[1,0]
    v_pk_mul_f32 v[92:93], v[92:93], v[12:13] op_sel_hi:[1,0]
    v_pk_mul_f32 v[94:95], v[94:95], v[12:13] op_sel_hi:[1,0]
    v_cvt_pk_bf16_f32 v88, v88, v89
    v_cvt_pk_bf16_f32 v89, v90, v91
    v_cvt_pk_bf16_f32 v90, v92, v93
    v_cvt_pk_bf16_f32 v91, v94, v95
    s_mov_b64 vcc, s[18:19]
    s_cbranch_vccnz L_cs_16
    buffer_store_dwordx4 v[72:75], v10, s[4:7], s21 offen nt
    buffer_store_dwordx4 v[88:91], v10, s[4:7], s21 offen offset:512 nt
L_ce_17:
    s_setprio 0
    s_lshl_b32 s27, s3, 11
    s_add_u32 s26, s31, s27
    s_add_u32 s26, s26, 0x10000
    s_add_u32 s27, s27, 65536
    v_and_b32 v120, 31, v0
    v_lshlrev_b32 v120, 2, v120
    s_add_u32 s20, s30, 0
    v_mov_b32 v6, 1
    s_waitcnt vmcnt(0)
    s_mov_b64 exec, 1
    s_cbranch_vccnz L_cs_18
    buffer_store_dword v6, v4, s[4:7], s20 offen
L_ce_19:
    s_mov_b64 exec, -1
    s_branch M_C_0
.p2align 12,,984
M_C_0:
    v_mov_b32 v112, 0x3f803f80
    v_mov_b32 v113, 0x3f803f80
    v_mov_b32 v114, 0x3f803f80
    v_mov_b32 v115, 0x3f803f80
    s_nop 1
    v_mfma_f32_16x16x32_bf16 v[96:99], v[128:131], v[112:115], 0
    v_mfma_f32_16x16x32_bf16 v[96:99], v[132:135], v[112:115], v[96:99]
    v_mfma_f32_16x16x32_bf16 v[96:99], v[136:139], v[112:115], v[96:99]
    v_mfma_f32_16x16x32_bf16 v[96:99], v[140:143], v[112:115], v[96:99]
    v_mfma_f32_16x16x32_bf16 v[96:99], v[144:147], v[112:115], v[96:99]
    v_mfma_f32_16x16x32_bf16 v[96:99], v[148:151], v[112:115], v[96:99]
    v_mfma_f32_16x16x32_bf16 v[96:99], v[152:155], v[112:115], v[96:99]
    v_mfma_f32_16x16x32_bf16 v[96:99], v[156:159], v[112:115], v[96:99]
    v_mfma_f32_16x16x32_bf16 v[96:99], v[160:163], v[112:115], v[96:99]
    v_mfma_f32_16x16x32_bf16 v[96:99], v[164:167], v[112:115], v[96:99]
    v_mfma_f32_16x16x32_bf16 v[96:99], v[168:171], v[112:115], v[96:99]
    v_mfma_f32_16x16x32_bf16 v[96:99], v[172:175], v[112:115], v[96:99]
    v_mfma_f32_16x16x32_bf16 v[96:99], v[176:179], v[112:115], v[96:99]
    v_mfma_f32_16x16x32_bf16 v[96:99], v[180:183], v[112:115], v[96:99]
    v_mfma_f32_16x16x32_bf16 v[96:99], v[184:187], v[112:115], v[96:99]
    v_mfma_f32_16x16x32_bf16 v[96:99], v[188:191], v[112:115], v[96:99]
    s_add_u32 s20, s30, 0
    s_mov_b32 s29, 0
    buffer_load_dword v121, v120, s[4:7], s20 offen sc1
    v_mov_b32 v112, 0x3f803f80
    v_mov_b32 v113, 0x3f803f80
    v_mov_b32 v114, 0x3f803f80
    v_mov_b32 v115, 0x3f803f80
    s_nop 1
    v_mfma_f32_16x16x32_bf16 v[100:103], v[192:195], v[112:115], 0
    v_mfma_f32_16x16x32_bf16 v[100:103], v[196:199], v[112:115], v[100:103]
    v_mfma_f32_16x16x32_bf16 v[100:103], v[200:203], v[112:115], v[100:103]
    v_mfma_f32_16x16x32_bf16 v[100:103], v[204:207], v[112:115], v[100:103]
    v_mfma_f32_16x16x32_bf16 v[100:103], v[208:211], v[112:115], v[100:103]
    v_mfma_f32_16x16x32_bf16 v[100:103], v[212:215], v[112:115], v[100:103]
    v_mfma_f32_16x16x32_bf16 v[100:103], v[216:219], v[112:115], v[100:103]
    v_mfma_f32_16x16x32_bf16 v[100:103], v[220:223], v[112:115], v[100:103]
    v_mfma_f32_16x16x32_bf16 v[100:103], v[224:227], v[112:115], v[100:103]
    v_mfma_f32_16x16x32_bf16 v[100:103], v[228:231], v[112:115], v[100:103]
    v_mfma_f32_16x16x32_bf16 v[100:103], v[232:235], v[112:115], v[100:103]
    v_mfma_f32_16x16x32_bf16 v[100:103], v[236:239], v[112:115], v[100:103]
    v_mfma_f32_16x16x32_bf16 v[100:103], v[240:243], v[112:115], v[100:103]
    v_mfma_f32_16x16x32_bf16 v[100:103], v[244:247], v[112:115], v[100:103]
    v_mfma_f32_16x16x32_bf16 v[100:103], v[248:251], v[112:115], v[100:103]
    v_mfma_f32_16x16x32_bf16 v[100:103], v[252:255], v[112:115], v[100:103]
    buffer_load_dword v122, v120, s[4:7], s20 offen sc1
    s_waitcnt vmcnt(1)
    v_cmp_ne_u32 vcc, 1, v121
    s_nop 1
    s_cbranch_vccz L_pdone_34
L_poll_33:
    buffer_load_dword v121, v120, s[4:7], s20 offen sc1
    s_waitcnt vmcnt(1)
    v_cmp_ne_u32 vcc, 1, v122
    s_nop 1
    s_cbranch_vccz L_pdone_34
    buffer_load_dword v122, v120, s[4:7], s20 offen sc1
    s_add_u32 s29, s29, 1
    s_cmp_gt_u32 s29, 262144
    s_cbranch_scc1 main_exit
    s_waitcnt vmcnt(1)
    v_cmp_ne_u32 vcc, 1, v121
    s_nop 1
    s_cbranch_vccnz L_poll_33
L_pdone_34:
    s_mov_b64 vcc, s[18:19]
    s_mov_b32 m0, s27
    s_nop 0
    buffer_load_dwordx4 v1, s[4:7], s26 offen sc1 lds
    buffer_load_dwordx4 v1, s[4:7], s26 offen offset:1024 sc1 lds
    s_add_u32 s26, s26, 8192
    s_add_u32 s27, s27, 8192
    s_mov_b32 m0, s27
    s_nop 0
    buffer_load_dwordx4 v1, s[4:7], s26 offen sc1 lds
    buffer_load_dwordx4 v1, s[4:7], s26 offen offset:1024 sc1 lds
    s_add_u32 s26, s26, 8192
    s_add_u32 s27, s27, 8192
    s_mov_b32 m0, s27
    s_nop 0
    buffer_load_dwordx4 v1, s[4:7], s26 offen sc1 lds
    buffer_load_dwordx4 v1, s[4:7], s26 offen offset:1024 sc1 lds
    s_add_u32 s26, s26, 8192
    s_add_u32 s27, s27, 8192
    s_waitcnt vmcnt(4)
    s_barrier
    s_mov_b32 m0, s27
    s_nop 0
    buffer_load_dwordx4 v1, s[4:7], s26 offen sc1 lds
    buffer_load_dwordx4 v1, s[4:7], s26 offen offset:1024 sc1 lds
    s_add_u32 s26, s26, 8192
    s_add_u32 s27, s27, 8192
    s_mov_b32 m0, s27
    s_nop 0
    buffer_load_dwordx4 v1, s[4:7], s26 offen sc1 lds
    buffer_load_dwordx4 v1, s[4:7], s26 offen offset:1024 sc1 lds
    s_add_u32 s26, s26, 8192
    s_add_u32 s27, s27, 8192
    s_waitcnt vmcnt(6)
    s_barrier
    s_mov_b32 m0, s27
    s_nop 0
    buffer_load_dwordx4 v1, s[4:7], s26 offen sc1 lds
    buffer_load_dwordx4 v1, s[4:7], s26 offen offset:1024 sc1 lds
    s_add_u32 s26, s26, 8192
    s_add_u32 s27, s27, 8192
    s_mov_b32 m0, s27
    s_nop 0
    buffer_load_dwordx4 v1, s[4:7], s26 offen sc1 lds
    buffer_load_dwordx4 v1, s[4:7], s26 offen offset:1024 sc1 lds
    s_add_u32 s26, s26, 8192
    s_add_u32 s27, s27, 8192
    s_waitcnt vmcnt(8)
    s_barrier
    s_mov_b32 m0, s27
    s_nop 0
    buffer_load_dwordx4 v1, s[4:7], s26 offen sc1 lds
    buffer_load_dwordx4 v1, s[4:7], s26 offen offset:1024 sc1 lds
    s_add_u32 s26, s26, 8192
    s_add_u32 s27, s27, 8192
    s_waitcnt vmcnt(8)
    s_barrier
    s_waitcnt vmcnt(6)
    s_barrier
    s_waitcnt vmcnt(4)
    s_barrier
    s_waitcnt vmcnt(2)
    s_barrier
    s_waitcnt vmcnt(0)
    s_barrier
    s_lshl_b32 s27, s3, 11
    s_add_u32 s26, s31, s27
    s_add_u32 s26, s26, 0x0
    s_add_u32 s27, s27, 65536
    v_lshlrev_b32 v6, 3, v0
    v_add_u32 v6, 106752, v6
    s_lshl_b32 s22, s17, 3
    s_add_u32 s22, s22, s31
    s_add_u32 s22, s22, 0x49000
    v_lshlrev_b32 v7, 6, v0
    s_lshl_b32 s25, s3, 4
    s_lshl_b64 s[36:37], 0xffff, s25
    s_barrier
    ds_read_b64 v[104:105], v6 offset:0
    ds_read_b64 v[106:107], v6 offset:1024
    ds_read_b64 v[108:109], v6 offset:2048
    ds_read_b64 v[110:111], v6 offset:3072
    s_branch M_C_1
.p2align 12,,852
M_C_1:
    s_add_u32 s20, s30, 8192
    s_mov_b32 s29, 0
    buffer_load_dword v121, v120, s[4:7], s20 offen sc1
    s_waitcnt lgkmcnt(0)
    v_pk_add_f32 v[104:105], v[104:105], v[106:107]
    v_pk_add_f32 v[108:109], v[108:109], v[110:111]
    v_pk_add_f32 v[104:105], v[104:105], v[108:109]
    s_mov_b64 exec, s[36:37]
    s_cbranch_vccnz L_cs_41
    buffer_store_dwordx2 v[104:105], v7, s[4:7], s22 offen
L_ce_42:
    s_mov_b64 exec, -1
    buffer_load_dword v122, v120, s[4:7], s20 offen sc1
    s_waitcnt vmcnt(2)
    v_cmp_ne_u32 vcc, 1, v121
    s_nop 1
    s_cbranch_vccz L_pdone_40
L_poll_39:
    buffer_load_dword v121, v120, s[4:7], s20 offen sc1
    s_waitcnt vmcnt(1)
    v_cmp_ne_u32 vcc, 1, v122
    s_nop 1
    s_cbranch_vccz L_pdone_40
    buffer_load_dword v122, v120, s[4:7], s20 offen sc1
    s_add_u32 s29, s29, 1
    s_cmp_gt_u32 s29, 262144
    s_cbranch_scc1 main_exit
    s_waitcnt vmcnt(1)
    v_cmp_ne_u32 vcc, 1, v121
    s_nop 1
    s_cbranch_vccnz L_poll_39
L_pdone_40:
    s_mov_b64 vcc, s[18:19]
    s_mov_b32 m0, s27
    s_nop 0
    buffer_load_dwordx4 v1, s[4:7], s26 offen sc1 lds
    buffer_load_dwordx4 v1, s[4:7], s26 offen offset:1024 sc1 lds
    s_add_u32 s26, s26, 8192
    s_add_u32 s27, s27, 8192
    s_mov_b32 m0, s27
    s_nop 0
    buffer_load_dwordx4 v1, s[4:7], s26 offen sc1 lds
    buffer_load_dwordx4 v1, s[4:7], s26 offen offset:1024 sc1 lds
    s_add_u32 s26, s26, 8192
    s_add_u32 s27, s27, 8192
    s_mov_b32 m0, s27
    s_nop 0
    buffer_load_dwordx4 v1, s[4:7], s26 offen sc1 lds
    buffer_load_dwordx4 v1, s[4:7], s26 offen offset:1024 sc1 lds
    s_add_u32 s26, s26, 8192
    s_add_u32 s27, s27, 8192
    s_lshl_b32 s21, s3, 10
    s_add_u32 s21, s21, s31
    s_add_u32 s21, s21, 0x49000
    v_and_b32 v9, 0xff, v1
    v_and_b32 v7, 0x30, v0
    v_lshl_add_u32 v7, v9, 2, v7
    s_lshl_b32 s25, s3, 8
    s_add_u32 s25, s25, 65536
    v_add_u32 v8, s25, v9
    buffer_load_dwordx4 v[80:83], v7, s[4:7], s21 offen sc1
    s_waitcnt vmcnt(5)
    s_barrier
    s_mov_b32 m0, s27
    s_nop 0
    buffer_load_dwordx4 v1, s[4:7], s26 offen sc1 lds
    buffer_load_dwordx4 v1, s[4:7], s26 offen offset:1024 sc1 lds
    s_add_u32 s26, s26, 8192
    s_add_u32 s27, s27, 8192
    s_mov_b32 m0, s27
    s_nop 0
    buffer_load_dwordx4 v1, s[4:7], s26 offen sc1 lds
    buffer_load_dwordx4 v1, s[4:7], s26 offen offset:1024 sc1 lds
    s_add_u32 s26, s26, 8192
    s_add_u32 s27, s27, 8192
    s_waitcnt vmcnt(7)
    s_barrier
    s_mov_b32 m0, s27
    s_nop 0
    buffer_load_dwordx4 v1, s[4:7], s26 offen sc1 lds
    buffer_load_dwordx4 v1, s[4:7], s26 offen offset:1024 sc1 lds
    s_add_u32 s26, s26, 8192
    s_add_u32 s27, s27, 8192
    s_mov_b32 m0, s27
    s_nop 0
    buffer_load_dwordx4 v1, s[4:7], s26 offen sc1 lds
    buffer_load_dwordx4 v1, s[4:7], s26 offen offset:1024 sc1 lds
    s_add_u32 s26, s26, 8192
    s_add_u32 s27, s27, 8192
    s_waitcnt vmcnt(9)
    s_barrier
    s_mov_b32 m0, s27
    s_nop 0
    buffer_load_dwordx4 v1, s[4:7], s26 offen sc1 lds
    buffer_load_dwordx4 v1, s[4:7], s26 offen offset:1024 sc1 lds
    s_add_u32 s26, s26, 8192
    s_add_u32 s27, s27, 8192
    s_waitcnt vmcnt(8)
    s_barrier
    s_waitcnt vmcnt(10)
L_schk_43:
    v_max_u32 v84, v81, v83
    v_cmp_eq_u32 vcc, -1, v84
    s_nop 1
    s_cbranch_vccnz L_sre_44
L_sok_45:
    s_mov_b64 vcc, s[18:19]
    v_add_f32 v80, v80, v82
    v_add_f32 v81, v81, v83
    s_nop 1
    v_permlane32_swap_b32 v80, v81
    v_add_f32 v80, v80, v81
    v_mov_b32 v81, v80
    s_nop 1
    v_permlane16_swap_b32 v80, v81
    s_waitcnt vmcnt(6)
    s_barrier
    v_add_f32 v80, v80, v81
    v_mul_f32 v80, 0x3b000000, v80
    v_mov_b32 v81, v80
    s_nop 1
    v_permlane32_swap_b32 v80, v81
    v_mov_b32 v88, v80
    v_fma_f32 v81, -v80, v80, v81
    v_max_f32 v81, 0, v81
    s_waitcnt vmcnt(4)
    s_barrier
    v_add_f32 v82, 0x3727c5ac, v81
    v_rsq_f32 v83, v82
    s_nop 0
    v_mul_f32 v84, v83, v83
    ds_write_b32 v8, v83 offset:1024
    v_mul_f32 v84, v84, v81
    v_add_f32 v84, 0x3727c5ac, v84
    v_rsq_f32 v84, v84
    s_waitcnt vmcnt(2)
    s_barrier
    v_mul_f32 v85, v83, v84
    v_rcp_f32 v89, v85
    v_mul_f32 v90, 0xc0135761, v85
    v_mul_f32 v86, v85, v85
    v_mul_f32 v86, 0x3d372713, v86
    v_mul_f32 v91, v90, v86
    ds_write_b128 v8, v[88:91]
    s_waitcnt vmcnt(0)
    s_waitcnt lgkmcnt(0)
    s_barrier
    s_branch M_C_2
.p2align 12,,1172
M_C_2:
    s_lshl_b32 s27, s3, 11
    s_add_u32 s26, s31, s27
    s_add_u32 s26, s26, 0x10000
    s_add_u32 s27, s27, 65536
    s_lshl_b32 s21, s3, 9
    s_add_u32 s21, s21, s31
    s_add_u32 s21, s21, 0x48000
    v_and_b32 v8, 0x1ff, v1
    s_cmp_eq_u32 s3, 0
    s_cselect_b32 s23, -16, 0
    s_cselect_b32 s24, 0xaaaaaaaa, -1
    s_cmp_eq_u32 s3, 1
    s_cselect_b32 s23, 1008, s23
    s_cselect_b32 s24, 0x55555555, s24
    s_cmp_eq_u32 s3, 3
    s_cselect_b32 s23, 992, s23
    s_lshl_b32 s22, s3, 14
    s_add_u32 s23, s23, s22
    s_add_u32 s23, s23, 65536
    v_lshrrev_b32 v7, 1, v0
    v_lshlrev_b32 v7, 10, v7
    v_and_b32 v9, 1, v0
    v_lshl_add_u32 v7, v9, 4, v7
    v_add_u32 v7, s23, v7
    s_lshl_b32 s28, s17, 3
    s_add_u32 s28, s28, s3
    s_mul_i32 s28, s28, 28672
    s_add_u32 s28, s28, 0x17c5000
    s_lshl_b32 s42, s3, 13
    s_barrier
    s_add_u32 s20, s30, 16384
    s_mov_b32 s29, 0
    buffer_load_dword v121, v120, s[4:7], s20 offen sc1
    buffer_load_dword v122, v120, s[4:7], s20 offen sc1
    s_waitcnt vmcnt(1)
    v_cmp_ne_u32 vcc, 1, v121
    s_nop 1
    s_cbranch_vccz L_pdone_55
L_poll_54:
    buffer_load_dword v121, v120, s[4:7], s20 offen sc1
    s_waitcnt vmcnt(1)
    v_cmp_ne_u32 vcc, 1, v122
    s_nop 1
    s_cbranch_vccz L_pdone_55
    buffer_load_dword v122, v120, s[4:7], s20 offen sc1
    s_add_u32 s29, s29, 1
    s_cmp_gt_u32 s29, 262144
    s_cbranch_scc1 main_exit
    s_waitcnt vmcnt(1)
    v_cmp_ne_u32 vcc, 1, v121
    s_nop 1
    s_cbranch_vccnz L_poll_54
L_pdone_55:
    s_mov_b64 vcc, s[18:19]
    s_mov_b32 m0, s27
    s_add_i32 s26, s26, -16
    s_mov_b32 exec_lo, 0xfffffffe
    buffer_load_dwordx4 v1, s[4:7], s26 offen sc1 lds
    buffer_load_dwordx4 v1, s[4:7], s26 offen offset:1024 sc1 lds
    s_mov_b64 exec, -1
    s_add_u32 s26, s26, 8192
    s_add_u32 s27, s27, 8192
    s_mov_b32 m0, s27
    s_mov_b32 exec_lo, 0xfffffffe
    buffer_load_dwordx4 v1, s[4:7], s26 offen sc1 lds
    buffer_load_dwordx4 v1, s[4:7], s26 offen offset:1024 sc1 lds
    s_mov_b64 exec, -1
    s_add_u32 s26, s26, 8192
    s_add_u32 s27, s27, 8192
    s_mov_b32 m0, s27
    s_add_i32 s26, s26, 32
    s_mov_b32 exec_hi, 0x7fffffff
    buffer_load_dwordx4 v1, s[4:7], s26 offen sc1 lds
    buffer_load_dwordx4 v1, s[4:7], s26 offen offset:1024 sc1 lds
    s_mov_b64 exec, -1
    s_add_u32 s26, s26, 8192
    s_add_u32 s27, s27, 8192
    s_waitcnt vmcnt(4)
    s_barrier
    s_mov_b32 m0, s27
    s_mov_b32 exec_hi, 0x7fffffff
    buffer_load_dwordx4 v1, s[4:7], s26 offen sc1 lds
    buffer_load_dwordx4 v1, s[4:7], s26 offen offset:1024 sc1 lds
    s_mov_b64 exec, -1
    s_add_u32 s26, s26, 8192
    s_add_u32 s27, s27, 8192
    s_mov_b32 m0, s27
    s_add_i32 s26, s26, -48
    s_mov_b32 exec_lo, 0xfffffffc
    buffer_load_dwordx4 v1, s[4:7], s26 offen sc1 lds
    buffer_load_dwordx4 v1, s[4:7], s26 offen offset:1024 sc1 lds
    s_mov_b64 exec, -1
    s_add_u32 s26, s26, 8192
    s_add_u32 s27, s27, 8192
    s_waitcnt vmcnt(6)
    s_barrier
    s_mov_b32 m0, s27
    s_mov_b32 exec_lo, 0xfffffffc
    buffer_load_dwordx4 v1, s[4:7], s26 offen sc1 lds
    buffer_load_dwordx4 v1, s[4:7], s26 offen offset:1024 sc1 lds
    s_mov_b64 exec, -1
    s_add_u32 s26, s26, 8192
    s_add_u32 s27, s27, 8192
    s_mov_b32 m0, s27
    s_add_i32 s26, s26, 64
    s_mov_b32 exec_hi, 0x3fffffff
    buffer_load_dwordx4 v1, s[4:7], s26 offen sc1 lds
    buffer_load_dwordx4 v1, s[4:7], s26 offen offset:1024 sc1 lds
    s_mov_b64 exec, -1
    s_add_u32 s26, s26, 8192
    s_add_u32 s27, s27, 8192
    s_waitcnt vmcnt(8)
    s_barrier
    s_mov_b32 m0, s27
    s_mov_b32 exec_hi, 0x3fffffff
    buffer_load_dwordx4 v1, s[4:7], s26 offen sc1 lds
    buffer_load_dwordx4 v1, s[4:7], s26 offen offset:1024 sc1 lds
    s_mov_b64 exec, -1
    s_add_u32 s26, s26, 8192
    s_add_u32 s27, s27, 8192
    s_mov_b32 m0, s42
    s_nop 0
    buffer_load_dwordx4 v1, s[4:7], s28 offen offset:0 sc1 lds
    s_mov_b32 m0, s42
    s_nop 0
    buffer_load_dwordx4 v1, s[4:7], s28 offen offset:1024 sc1 lds
    s_waitcnt vmcnt(10)
    s_barrier
    s_mov_b32 m0, s42
    s_nop 0
    buffer_load_dwordx4 v1, s[4:7], s28 offen offset:2048 sc1 lds
    s_mov_b32 m0, s42
    s_nop 0
    buffer_load_dwordx4 v1, s[4:7], s28 offen offset:3072 sc1 lds
    s_add_u32 s28, s28, 4096
    s_add_u32 s42, s42, 4096
    buffer_load_dwordx4 v[104:107], v8, s[4:7], s21 offen sc1
    s_waitcnt vmcnt(11)
    s_barrier
    s_waitcnt vmcnt(9)
    s_barrier
    s_waitcnt vmcnt(7)
    s_barrier
    s_waitcnt vmcnt(5)
    s_barrier
    s_waitcnt vmcnt(0)
L_hchk_56:
    v_max_u32 v6, v104, v105
    v_max3_u32 v6, v6, v106, v107
    v_cmp_eq_u32 vcc, -1, v6
    s_nop 1
    s_cbranch_vccnz L_hre_57
L_hok_58:
    s_mov_b64 vcc, s[18:19]
    s_mov_b32 exec_lo, s24
    s_mov_b32 exec_hi, 0
    ds_write_b128 v7, v[104:107]
    s_mov_b64 exec, -1
    s_waitcnt lgkmcnt(0)
    s_barrier
    s_mov_b32 m0, s42
    s_nop 0
    buffer_load_dwordx4 v1, s[4:7], s28 offen offset:0 sc1 lds
    s_mov_b32 m0, s42
    s_nop 0
    buffer_load_dwordx4 v1, s[4:7], s28 offen offset:1024 sc1 lds
    s_mov_b32 m0, s42
    s_nop 0
    buffer_load_dwordx4 v1, s[4:7], s28 offen offset:2048 sc1 lds
    s_mov_b32 m0, s42
    s_nop 0
    buffer_load_dwordx4 v1, s[4:7], s28 offen offset:3072 sc1 lds
    s_add_u32 s28, s28, 4096
    s_add_u32 s42, s42, 4096
    s_add_u32 s28, s28, 106496
    s_add_u32 s42, s42, 24576
    s_mov_b32 m0, s42
    s_nop 0
    buffer_load_dwordx4 v1, s[4:7], s28 offen offset:0 sc1 lds
    s_mov_b32 m0, s42
    s_nop 0
    buffer_load_dwordx4 v1, s[4:7], s28 offen offset:1024 sc1 lds
    s_lshl_b32 s27, s3, 11
    s_add_u32 s26, s31, s27
    s_add_u32 s26, s26, 0x0
    s_add_u32 s27, s27, 65536
    v_lshlrev_b32 v6, 3, v0
    v_add_u32 v6, 106752, v6
    s_lshl_b32 s22, s17, 3
    s_add_u32 s22, s22, s31
    s_add_u32 s22, s22, 0x4a000
    v_lshlrev_b32 v7, 6, v0
    s_lshl_b32 s25, s3, 4
    s_lshl_b64 s[36:37], 0xffff, s25
    s_barrier
    ds_read_b64 v[104:105], v6 offset:0
    ds_read_b64 v[106:107], v6 offset:1024
    ds_read_b64 v[108:109], v6 offset:2048
    ds_read_b64 v[110:111], v6 offset:3072
M_C_3:
    s_add_u32 s20, s30, 24576
    s_mov_b32 s29, 0
    buffer_load_dword v121, v120, s[4:7], s20 offen sc1
    s_waitcnt lgkmcnt(0)
    v_pk_add_f32 v[104:105], v[104:105], v[106:107]
    v_pk_add_f32 v[108:109], v[108:109], v[110:111]
    v_pk_add_f32 v[104:105], v[104:105], v[108:109]
    s_mov_b64 exec, s[36:37]
    s_cbranch_vccnz L_cs_65
    buffer_store_dwordx2 v[104:105], v7, s[4:7], s22 offen
L_ce_66:
    s_mov_b64 exec, -1
    buffer_load_dword v122, v120, s[4:7], s20 offen sc1
    s_waitcnt vmcnt(2)
    v_cmp_ne_u32 vcc, 1, v121
    s_nop 1
    s_cbranch_vccz L_pdone_64
L_poll_63:
    buffer_load_dword v121, v120, s[4:7], s20 offen sc1
    s_waitcnt vmcnt(1)
    v_cmp_ne_u32 vcc, 1, v122
    s_nop 1
    s_cbranch_vccz L_pdone_64
    buffer_load_dword v122, v120, s[4:7], s20 offen sc1
    s_add_u32 s29, s29, 1
    s_cmp_gt_u32 s29, 262144
    s_cbranch_scc1 main_exit
    s_waitcnt vmcnt(1)
    v_cmp_ne_u32 vcc, 1, v121
    s_nop 1
    s_cbranch_vccnz L_poll_63
L_pdone_64:
    s_mov_b64 vcc, s[18:19]
    s_mov_b32 m0, s27
    s_nop 0
    buffer_load_dwordx4 v1, s[4:7], s26 offen sc1 lds
    buffer_load_dwordx4 v1, s[4:7], s26 offen offset:1024 sc1 lds
    s_add_u32 s26, s26, 8192
    s_add_u32 s27, s27, 8192
    s_mov_b32 m0, s27
    s_nop 0
    buffer_load_dwordx4 v1, s[4:7], s26 offen sc1 lds
    buffer_load_dwordx4 v1, s[4:7], s26 offen offset:1024 sc1 lds
    s_add_u32 s26, s26, 8192
    s_add_u32 s27, s27, 8192
    s_mov_b32 m0, s27
    s_nop 0
    buffer_load_dwordx4 v1, s[4:7], s26 offen sc1 lds
    buffer_load_dwordx4 v1, s[4:7], s26 offen offset:1024 sc1 lds
    s_add_u32 s26, s26, 8192
    s_add_u32 s27, s27, 8192
    s_lshl_b32 s21, s3, 10
    s_add_u32 s21, s21, s31
    s_add_u32 s21, s21, 0x4a000
    v_and_b32 v9, 0xff, v1
    v_and_b32 v7, 0x30, v0
    v_lshl_add_u32 v7, v9, 2, v7
    s_lshl_b32 s25, s3, 8
    s_add_u32 s25, s25, 131072
    v_add_u32 v8, s25, v9
    buffer_load_dwordx4 v[80:83], v7, s[4:7], s21 offen sc1
    v_xor_b32 v124, s39, v2
    v_xor_b32 v125, 256, v124
    v_xor_b32 v126, s39, v3
    v_xor_b32 v127, 256, v126
    v_and_b32 v14, 0xff, v1
    v_add_u32 v14, 131072, v14
    v_xor_b32 v14, s39, v14
    v_xor_b32 v15, 256, v14
    s_mul_i32 s32, s17, 28672
    s_add_u32 s32, s32, s31
    s_add_u32 s32, s32, 0x10000
    s_lshr_b32 s33, s3, 1
    s_add_u32 s33, s33, 12
    s_lshl_b32 s33, s33, 11
    s_add_u32 s33, s33, s32
    s_mul_i32 s23, s3, 6144
    s_add_u32 s32, s32, s23
    s_lshl_b32 s43, s17, 3
    s_add_u32 s43, s43, s44
    s_lshl_b32 s23, s43, 2
    v_mov_b32 v4, s23
    s_mul_i32 s43, s43, 28672
    s_add_u32 s43, s43, 0x17c0000
    s_add_u32 s33, s32, 2048
    s_waitcnt vmcnt(5)
    s_barrier
    ds_read_b128 v[48:51], v124 offset:0
    ds_read_b128 v[52:55], v125 offset:0
    ds_read_b128 v[56:59], v124 offset:512
    ds_read_b128 v[60:63], v125 offset:512
    s_waitcnt lgkmcnt(3)
    v_mfma_f32_16x16x32_bf16 v[16:19], v[128:131], v[48:51], 0
    ds_read_b128 v[64:67], v124 offset:4096
    v_mfma_f32_16x16x32_bf16 v[20:23], v[192:195], v[48:51], 0
    s_waitcnt lgkmcnt(3)
    v_mfma_f32_16x16x32_bf16 v[24:27], v[128:131], v[52:55], 0
    ds_read_b128 v[68:71], v125 offset:4096
    s_mov_b32 m0, s27
    s_nop 0
    buffer_load_dwordx4 v1, s[4:7], s26 offen sc1 lds
    buffer_load_dwordx4 v1, s[4:7], s26 offen offset:1024 sc1 lds
    s_add_u32 s26, s26, 8192
    s_add_u32 s27, s27, 8192
    v_mfma_f32_16x16x32_bf16 v[28:31], v[192:195], v[52:55], 0
    s_waitcnt lgkmcnt(3)
    v_mfma_f32_16x16x32_bf16 v[32:35], v[128:131], v[56:59], 0
    ds_read_b128 v[72:75], v124 offset:4608
    v_mfma_f32_16x16x32_bf16 v[36:39], v[192:195], v[56:59], 0
    s_mov_b32 m0, s27
    s_nop 0
    buffer_load_dwordx4 v1, s[4:7], s26 offen sc1 lds
    buffer_load_dwordx4 v1, s[4:7], s26 offen offset:1024 sc1 lds
    s_add_u32 s26, s26, 8192
    s_add_u32 s27, s27, 8192
    s_waitcnt lgkmcnt(3)
    v_mfma_f32_16x16x32_bf16 v[40:43], v[128:131], v[60:63], 0
    ds_read_b128 v[76:79], v125 offset:4608
    v_mfma_f32_16x16x32_bf16 v[44:47], v[192:195], v[60:63], 0
    s_mov_b32 m0, s27
    s_nop 0
    buffer_load_dwordx4 v1, s[4:7], s26 offen sc1 lds
    buffer_load_dwordx4 v1, s[4:7], s26 offen offset:1024 sc1 lds
    s_add_u32 s26, s26, 8192
    s_add_u32 s27, s27, 8192
    s_waitcnt vmcnt(9)
    s_barrier
    s_waitcnt lgkmcnt(3)
    v_mfma_f32_16x16x32_bf16 v[16:19], v[132:135], v[64:67], v[16:19]
    ds_read_b128 v[48:51], v124 offset:8192
    v_mfma_f32_16x16x32_bf16 v[20:23], v[196:199], v[64:67], v[20:23]
    s_waitcnt lgkmcnt(3)
    v_mfma_f32_16x16x32_bf16 v[24:27], v[132:135], v[68:71], v[24:27]
    ds_read_b128 v[52:55], v125 offset:8192
    v_mfma_f32_16x16x32_bf16 v[28:31], v[196:199], v[68:71], v[28:31]
    s_mov_b32 m0, s27
    s_nop 0
    buffer_load_dwordx4 v1, s[4:7], s26 offen sc1 lds
    buffer_load_dwordx4 v1, s[4:7], s26 offen offset:1024 sc1 lds
    s_add_u32 s26, s26, 8192
    s_add_u32 s27, s27, 8192
    s_waitcnt lgkmcnt(3)
    v_mfma_f32_16x16x32_bf16 v[32:35], v[132:135], v[72:75], v[32:35]
    ds_read_b128 v[56:59], v124 offset:8704
    v_mfma_f32_16x16x32_bf16 v[36:39], v[196:199], v[72:75], v[36:39]
    s_waitcnt lgkmcnt(3)
    v_mfma_f32_16x16x32_bf16 v[40:43], v[132:135], v[76:79], v[40:43]
    ds_read_b128 v[60:63], v125 offset:8704
    v_mfma_f32_16x16x32_bf16 v[44:47], v[196:199], v[76:79], v[44:47]
    s_mov_b32 m0, s27
    s_nop 0
    buffer_load_dwordx4 v1, s[4:7], s26 offen sc1 lds
    buffer_load_dwordx4 v1, s[4:7], s26 offen offset:1024 sc1 lds
    s_add_u32 s26, s26, 8192
    s_add_u32 s27, s27, 8192
    s_waitcnt lgkmcnt(3)
    v_mfma_f32_16x16x32_bf16 v[16:19], v[136:139], v[48:51], v[16:19]
    ds_read_b128 v[64:67], v124 offset:12288
    v_mfma_f32_16x16x32_bf16 v[20:23], v[200:203], v[48:51], v[20:23]
    s_mov_b32 m0, s42
    s_nop 0
    buffer_load_dwordx4 v1, s[4:7], s28 offen offset:2048 sc1 lds
    s_waitcnt lgkmcnt(3)
    v_mfma_f32_16x16x32_bf16 v[24:27], v[136:139], v[52:55], v[24:27]
    ds_read_b128 v[68:71], v125 offset:12288
    s_mov_b32 m0, s42
    s_nop 0
    buffer_load_dwordx4 v1, s[4:7], s28 offen offset:3072 sc1 lds
    s_add_u32 s28, s28, 4096
    s_add_u32 s42, s42, 4096
    v_mfma_f32_16x16x32_bf16 v[28:31], v[200:203], v[52:55], v[28:31]
    s_mov_b32 m0, s42
    s_nop 0
    buffer_load_dwordx4 v1, s[4:7], s28 offen offset:0 sc1 lds
    s_waitcnt lgkmcnt(3)
    v_mfma_f32_16x16x32_bf16 v[32:35], v[136:139], v[56:59], v[32:35]
    ds_read_b128 v[72:75], v124 offset:12800
    s_mov_b32 m0, s42
    s_nop 0
    buffer_load_dwordx4 v1, s[4:7], s28 offen offset:1024 sc1 lds
    v_mfma_f32_16x16x32_bf16 v[36:39], v[200:203], v[56:59], v[36:39]
    s_mov_b32 m0, s42
    s_nop 0
    buffer_load_dwordx4 v1, s[4:7], s28 offen offset:2048 sc1 lds
    s_waitcnt lgkmcnt(3)
    v_mfma_f32_16x16x32_bf16 v[40:43], v[136:139], v[60:63], v[40:43]
    ds_read_b128 v[76:79], v125 offset:12800
    s_mov_b32 m0, s42
    s_nop 0
    buffer_load_dwordx4 v1, s[4:7], s28 offen offset:3072 sc1 lds
    s_add_u32 s28, s28, 4096
    s_add_u32 s42, s42, 4096
    v_mfma_f32_16x16x32_bf16 v[44:47], v[200:203], v[60:63], v[44:47]
    s_waitcnt vmcnt(14)
    s_barrier
    s_waitcnt lgkmcnt(3)
    v_mfma_f32_16x16x32_bf16 v[16:19], v[140:143], v[64:67], v[16:19]
    ds_read_b128 v[48:51], v124 offset:16384
    buffer_load_dwordx4 v[128:131], v1, s[4:7], s43 offen offset:0 sc1
    v_mfma_f32_16x16x32_bf16 v[20:23], v[204:207], v[64:67], v[20:23]
    s_waitcnt vmcnt(17)
L_schk_67:
    v_max_u32 v84, v81, v83
    v_cmp_eq_u32 vcc, -1, v84
    s_nop 1
    s_cbranch_vccnz L_sre_68
L_sok_69:
    s_mov_b64 vcc, s[18:19]
    s_waitcnt lgkmcnt(3)
    v_mfma_f32_16x16x32_bf16 v[24:27], v[140:143], v[68:71], v[24:27]
    ds_read_b128 v[52:55], v125 offset:16384
    v_add_f32 v80, v80, v82
    v_mfma_f32_16x16x32_bf16 v[28:31], v[204:207], v[68:71], v[28:31]
    v_add_f32 v81, v81, v83
    s_waitcnt lgkmcnt(3)
    v_mfma_f32_16x16x32_bf16 v[32:35], v[140:143], v[72:75], v[32:35]
    ds_read_b128 v[56:59], v124 offset:16896
    buffer_load_dwordx4 v[192:195], v1, s[4:7], s43 offen offset:1024 sc1
    v_mfma_f32_16x16x32_bf16 v[36:39], v[204:207], v[72:75], v[36:39]
    v_permlane32_swap_b32 v80, v81
    s_waitcnt lgkmcnt(3)
    v_mfma_f32_16x16x32_bf16 v[40:43], v[140:143], v[76:79], v[40:43]
    ds_read_b128 v[60:63], v125 offset:16896
    v_add_f32 v80, v80, v81
    v_mfma_f32_16x16x32_bf16 v[44:47], v[204:207], v[76:79], v[44:47]
    v_mov_b32 v81, v80
    s_nop 1
    v_permlane16_swap_b32 v80, v81
    s_waitcnt lgkmcnt(3)
    v_mfma_f32_16x16x32_bf16 v[16:19], v[144:147], v[48:51], v[16:19]
    ds_read_b128 v[64:67], v124 offset:20480
    buffer_load_dwordx4 v[132:135], v1, s[4:7], s43 offen offset:2048 sc1
    v_mfma_f32_16x16x32_bf16 v[20:23], v[208:211], v[48:51], v[20:23]
    v_add_f32 v80, v80, v81
    s_waitcnt lgkmcnt(3)
    v_mfma_f32_16x16x32_bf16 v[24:27], v[144:147], v[52:55], v[24:27]
    ds_read_b128 v[68:71], v125 offset:20480
    v_mul_f32 v80, 0x3b000000, v80
    v_mfma_f32_16x16x32_bf16 v[28:31], v[208:211], v[52:55], v[28:31]
    v_mov_b32 v81, v80
    s_waitcnt lgkmcnt(3)
    v_mfma_f32_16x16x32_bf16 v[32:35], v[144:147], v[56:59], v[32:35]
    ds_read_b128 v[72:75], v124 offset:20992
    buffer_load_dwordx4 v[196:199], v1, s[4:7], s43 offen offset:3072 sc1
    s_add_u32 s43, s43, 4096
    v_mfma_f32_16x16x32_bf16 v[36:39], v[208:211], v[56:59], v[36:39]
    v_permlane32_swap_b32 v80, v81
    s_waitcnt lgkmcnt(3)
    v_mfma_f32_16x16x32_bf16 v[40:43], v[144:147], v[60:63], v[40:43]
    ds_read_b128 v[76:79], v125 offset:20992
    v_mov_b32 v88, v80
    v_mfma_f32_16x16x32_bf16 v[44:47], v[208:211], v[60:63], v[44:47]
    v_fma_f32 v81, -v80, v80, v81
    v_max_f32 v81, 0, v81
    s_waitcnt lgkmcnt(3)
    v_mfma_f32_16x16x32_bf16 v[16:19], v[148:151], v[64:67], v[16:19]
    ds_read_b128 v[48:51], v124 offset:24576
    buffer_load_dwordx4 v[136:139], v1, s[4:7], s43 offen offset:0 sc1
    v_mfma_f32_16x16x32_bf16 v[20:23], v[212:215], v[64:67], v[20:23]
    v_add_f32 v82, 0x3727c5ac, v81
    s_waitcnt lgkmcnt(3)
    v_mfma_f32_16x16x32_bf16 v[24:27], v[148:151], v[68:71], v[24:27]
    ds_read_b128 v[52:55], v125 offset:24576
    v_rsq_f32 v83, v82
    v_mfma_f32_16x16x32_bf16 v[28:31], v[212:215], v[68:71], v[28:31]
    v_rcp_f32 v89, v83
    v_mul_f32 v90, 0xc0135761, v83
    s_waitcnt lgkmcnt(3)
    v_mfma_f32_16x16x32_bf16 v[32:35], v[148:151], v[72:75], v[32:35]
    ds_read_b128 v[56:59], v124 offset:25088
    buffer_load_dwordx4 v[200:203], v1, s[4:7], s43 offen offset:1024 sc1
    v_mfma_f32_16x16x32_bf16 v[36:39], v[212:215], v[72:75], v[36:39]
    v_mul_f32 v86, v83, v83
    s_waitcnt lgkmcnt(3)
    v_mfma_f32_16x16x32_bf16 v[40:43], v[148:151], v[76:79], v[40:43]
    ds_read_b128 v[60:63], v125 offset:25088
    v_mul_f32 v86, 0x3d372713, v86
    v_mfma_f32_16x16x32_bf16 v[44:47], v[212:215], v[76:79], v[44:47]
    v_mul_f32 v91, v90, v86
    ds_write_b128 v8, v[88:91]
    s_waitcnt lgkmcnt(4)
    v_mfma_f32_16x16x32_bf16 v[16:19], v[152:155], v[48:51], v[16:19]
    ds_read_b128 v[64:67], v124 offset:28672
    v_mfma_f32_16x16x32_bf16 v[20:23], v[216:219], v[48:51], v[20:23]
    s_waitcnt lgkmcnt(4)
    v_mfma_f32_16x16x32_bf16 v[24:27], v[152:155], v[52:55], v[24:27]
    ds_read_b128 v[68:71], v125 offset:28672
    v_mfma_f32_16x16x32_bf16 v[28:31], v[216:219], v[52:55], v[28:31]
    buffer_load_dwordx4 v[140:143], v1, s[4:7], s43 offen offset:2048 sc1
    s_waitcnt lgkmcnt(4)
    v_mfma_f32_16x16x32_bf16 v[32:35], v[152:155], v[56:59], v[32:35]
    ds_read_b128 v[72:75], v124 offset:29184
    v_mfma_f32_16x16x32_bf16 v[36:39], v[216:219], v[56:59], v[36:39]
    s_waitcnt lgkmcnt(4)
    v_mfma_f32_16x16x32_bf16 v[40:43], v[152:155], v[60:63], v[40:43]
    ds_read_b128 v[76:79], v125 offset:29184
    v_mfma_f32_16x16x32_bf16 v[44:47], v[216:219], v[60:63], v[44:47]
    buffer_load_dwordx4 v[204:207], v1, s[4:7], s43 offen offset:3072 sc1
    s_add_u32 s43, s43, 4096
    s_waitcnt vmcnt(8)
    s_waitcnt lgkmcnt(4)
    s_barrier
    s_waitcnt lgkmcnt(3)
    v_mfma_f32_16x16x32_bf16 v[16:19], v[156:159], v[64:67], v[16:19]
    ds_read_b128 v[48:51], v124 offset:32768
    v_mfma_f32_16x16x32_bf16 v[20:23], v[220:223], v[64:67], v[20:23]
    s_waitcnt lgkmcnt(3)
    v_mfma_f32_16x16x32_bf16 v[24:27], v[156:159], v[68:71], v[24:27]
    ds_read_b128 v[52:55], v125 offset:32768
    v_mfma_f32_16x16x32_bf16 v[28:31], v[220:223], v[68:71], v[28:31]
    buffer_load_dwordx4 v[144:147], v1, s[4:7], s43 offen offset:0 sc1
    s_waitcnt lgkmcnt(3)
    v_mfma_f32_16x16x32_bf16 v[32:35], v[156:159], v[72:75], v[32:35]
    ds_read_b128 v[56:59], v124 offset:33280
    v_mfma_f32_16x16x32_bf16 v[36:39], v[220:223], v[72:75], v[36:39]
    s_waitcnt lgkmcnt(3)
    v_mfma_f32_16x16x32_bf16 v[40:43], v[156:159], v[76:79], v[40:43]
    ds_read_b128 v[60:63], v125 offset:33280
    v_mfma_f32_16x16x32_bf16 v[44:47], v[220:223], v[76:79], v[44:47]
    buffer_load_dwordx4 v[208:211], v1, s[4:7], s43 offen offset:1024 sc1
    s_waitcnt lgkmcnt(3)
    v_mfma_f32_16x16x32_bf16 v[16:19], v[160:163], v[48:51], v[16:19]
    ds_read_b128 v[64:67], v124 offset:36864
    v_mfma_f32_16x16x32_bf16 v[20:23], v[224:227], v[48:51], v[20:23]
    buffer_load_dwordx4 v[148:151], v1, s[4:7], s43 offen offset:2048 sc1
    s_waitcnt lgkmcnt(3)
    v_mfma_f32_16x16x32_bf16 v[24:27], v[160:163], v[52:55], v[24:27]
    ds_read_b128 v[68:71], v125 offset:36864
    ds_read_b128 v[80:83], v14 offset:0
    v_mfma_f32_16x16x32_bf16 v[28:31], v[224:227], v[52:55], v[28:31]
    ds_read_b128 v[84:87], v15 offset:0
    s_waitcnt lgkmcnt(5)
    v_mfma_f32_16x16x32_bf16 v[32:35], v[160:163], v[56:59], v[32:35]
    ds_read_b128 v[72:75], v124 offset:37376
    v_mfma_f32_16x16x32_bf16 v[36:39], v[224:227], v[56:59], v[36:39]
    buffer_load_dwordx4 v[212:215], v1, s[4:7], s43 offen offset:3072 sc1
    s_add_u32 s43, s43, 4096
    s_waitcnt lgkmcnt(5)
    v_mfma_f32_16x16x32_bf16 v[40:43], v[160:163], v[60:63], v[40:43]
    ds_read_b128 v[76:79], v125 offset:37376
    ds_read_b128 v[88:91], v14 offset:512
    v_mfma_f32_16x16x32_bf16 v[44:47], v[224:227], v[60:63], v[44:47]
    ds_read_b128 v[92:95], v15 offset:512
    s_waitcnt lgkmcnt(7)
    v_mfma_f32_16x16x32_bf16 v[16:19], v[164:167], v[64:67], v[16:19]
    ds_read_b128 v[48:51], v124 offset:40960
    v_mfma_f32_16x16x32_bf16 v[20:23], v[228:231], v[64:67], v[20:23]
    s_waitcnt lgkmcnt(7)
    v_mfma_f32_16x16x32_bf16 v[24:27], v[164:167], v[68:71], v[24:27]
    ds_read_b128 v[52:55], v125 offset:40960
    v_mfma_f32_16x16x32_bf16 v[28:31], v[228:231], v[68:71], v[28:31]
    buffer_load_dwordx4 v[152:155], v1, s[4:7], s43 offen offset:0 sc1
    s_waitcnt lgkmcnt(5)
    v_mfma_f32_16x16x32_bf16 v[32:35], v[164:167], v[72:75], v[32:35]
    ds_read_b128 v[56:59], v124 offset:41472
    v_mfma_f32_16x16x32_bf16 v[36:39], v[228:231], v[72:75], v[36:39]
    s_waitcnt lgkmcnt(5)
    v_mfma_f32_16x16x32_bf16 v[40:43], v[164:167], v[76:79], v[40:43]
    ds_read_b128 v[60:63], v125 offset:41472
    v_mfma_f32_16x16x32_bf16 v[44:47], v[228:231], v[76:79], v[44:47]
    buffer_load_dwordx4 v[216:219], v1, s[4:7], s43 offen offset:1024 sc1
    s_waitcnt lgkmcnt(3)
    v_mfma_f32_16x16x32_bf16 v[16:19], v[168:171], v[48:51], v[16:19]
    ds_read_b128 v[64:67], v124 offset:45056
    v_mfma_f32_16x16x32_bf16 v[20:23], v[232:235], v[48:51], v[20:23]
    s_waitcnt lgkmcnt(3)
    v_mfma_f32_16x16x32_bf16 v[24:27], v[168:171], v[52:55], v[24:27]
    ds_read_b128 v[68:71], v125 offset:45056
    v_mfma_f32_16x16x32_bf16 v[28:31], v[232:235], v[52:55], v[28:31]
    buffer_load_dwordx4 v[156:159], v1, s[4:7], s43 offen offset:2048 sc1
    s_waitcnt lgkmcnt(3)
    v_mfma_f32_16x16x32_bf16 v[32:35], v[168:171], v[56:59], v[32:35]
    ds_read_b128 v[72:75], v124 offset:45568
    v_mfma_f32_16x16x32_bf16 v[36:39], v[232:235], v[56:59], v[36:39]
    s_waitcnt lgkmcnt(3)
    v_mfma_f32_16x16x32_bf16 v[40:43], v[168:171], v[60:63], v[40:43]
    ds_read_b128 v[76:79], v125 offset:45568
    v_mfma_f32_16x16x32_bf16 v[44:47], v[232:235], v[60:63], v[44:47]
    buffer_load_dwordx4 v[220:223], v1, s[4:7], s43 offen offset:3072 sc1
    s_add_u32 s43, s43, 4096
    s_waitcnt lgkmcnt(3)
    v_mfma_f32_16x16x32_bf16 v[16:19], v[172:175], v[64:67], v[16:19]
    ds_read_b128 v[48:51], v124 offset:49152
    v_mfma_f32_16x16x32_bf16 v[20:23], v[236:239], v[64:67], v[20:23]
    s_waitcnt lgkmcnt(3)
    v_mfma_f32_16x16x32_bf16 v[24:27], v[172:175], v[68:71], v[24:27]
    ds_read_b128 v[52:55], v125 offset:49152
    v_mfma_f32_16x16x32_bf16 v[28:31], v[236:239], v[68:71], v[28:31]
    buffer_load_dwordx4 v[160:163], v1, s[4:7], s43 offen offset:0 sc1
    s_waitcnt lgkmcnt(3)
    v_mfma_f32_16x16x32_bf16 v[32:35], v[172:175], v[72:75], v[32:35]
    ds_read_b128 v[56:59], v124 offset:49664
    v_mfma_f32_16x16x32_bf16 v[36:39], v[236:239], v[72:75], v[36:39]
    s_waitcnt lgkmcnt(3)
    v_mfma_f32_16x16x32_bf16 v[40:43], v[172:175], v[76:79], v[40:43]
    ds_read_b128 v[60:63], v125 offset:49664
    v_mfma_f32_16x16x32_bf16 v[44:47], v[236:239], v[76:79], v[44:47]
    buffer_load_dwordx4 v[224:227], v1, s[4:7], s43 offen offset:1024 sc1
    s_waitcnt lgkmcnt(3)
    v_mfma_f32_16x16x32_bf16 v[16:19], v[176:179], v[48:51], v[16:19]
    ds_read_b128 v[64:67], v124 offset:53248
    v_mfma_f32_16x16x32_bf16 v[20:23], v[240:243], v[48:51], v[20:23]
    s_waitcnt lgkmcnt(3)
    v_mfma_f32_16x16x32_bf16 v[24:27], v[176:179], v[52:55], v[24:27]
    ds_read_b128 v[68:71], v125 offset:53248
    v_mfma_f32_16x16x32_bf16 v[28:31], v[240:243], v[52:55], v[28:31]
    buffer_load_dwordx4 v[164:167], v1, s[4:7], s43 offen offset:2048 sc1
    s_waitcnt lgkmcnt(3)
    v_mfma_f32_16x16x32_bf16 v[32:35], v[176:179], v[56:59], v[32:35]
    ds_read_b128 v[72:75], v124 offset:53760
    v_mfma_f32_16x16x32_bf16 v[36:39], v[240:243], v[56:59], v[36:39]
    s_waitcnt lgkmcnt(3)
    v_mfma_f32_16x16x32_bf16 v[40:43], v[176:179], v[60:63], v[40:43]
    ds_read_b128 v[76:79], v125 offset:53760
    v_mfma_f32_16x16x32_bf16 v[44:47], v[240:243], v[60:63], v[44:47]
    buffer_load_dwordx4 v[228:231], v1, s[4:7], s43 offen offset:3072 sc1
    s_add_u32 s43, s43, 4096
    s_waitcnt lgkmcnt(3)
    v_mfma_f32_16x16x32_bf16 v[16:19], v[180:183], v[64:67], v[16:19]
    ds_read_b128 v[48:51], v124 offset:57344
    v_mfma_f32_16x16x32_bf16 v[20:23], v[244:247], v[64:67], v[20:23]
    s_waitcnt lgkmcnt(3)
    v_mfma_f32_16x16x32_bf16 v[24:27], v[180:183], v[68:71], v[24:27]
    ds_read_b128 v[52:55], v125 offset:57344
    v_mfma_f32_16x16x32_bf16 v[28:31], v[244:247], v[68:71], v[28:31]
    s_lshl_b32 s21, s44, 13
    s_waitcnt lgkmcnt(3)
    v_mfma_f32_16x16x32_bf16 v[32:35], v[180:183], v[72:75], v[32:35]
    ds_read_b128 v[56:59], v124 offset:57856
    v_mfma_f32_16x16x32_bf16 v[36:39], v[244:247], v[72:75], v[36:39]
    s_waitcnt lgkmcnt(3)
    v_mfma_f32_16x16x32_bf16 v[40:43], v[180:183], v[76:79], v[40:43]
    ds_read_b128 v[60:63], v125 offset:57856
    v_mfma_f32_16x16x32_bf16 v[44:47], v[244:247], v[76:79], v[44:47]
    v_add_u32 v7, s21, v1
    s_waitcnt lgkmcnt(3)
    v_mfma_f32_16x16x32_bf16 v[16:19], v[184:187], v[48:51], v[16:19]
    ds_read_b128 v[64:67], v124 offset:61440
    v_mfma_f32_16x16x32_bf16 v[20:23], v[248:251], v[48:51], v[20:23]
    ds_read_b128 v[168:171], v7 offset:0
    s_waitcnt lgkmcnt(4)
    v_mfma_f32_16x16x32_bf16 v[24:27], v[184:187], v[52:55], v[24:27]
    ds_read_b128 v[68:71], v125 offset:61440
    v_mfma_f32_16x16x32_bf16 v[28:31], v[248:251], v[52:55], v[28:31]
    ds_read_b128 v[232:235], v7 offset:1024
    s_waitcnt lgkmcnt(5)
    v_mfma_f32_16x16x32_bf16 v[32:35], v[184:187], v[56:59], v[32:35]
    ds_read_b128 v[72:75], v124 offset:61952
    v_mfma_f32_16x16x32_bf16 v[36:39], v[248:251], v[56:59], v[36:39]
    ds_read_b128 v[172:175], v7 offset:2048
    s_waitcnt lgkmcnt(6)
    v_mfma_f32_16x16x32_bf16 v[40:43], v[184:187], v[60:63], v[40:43]
    ds_read_b128 v[76:79], v125 offset:61952
    v_mfma_f32_16x16x32_bf16 v[44:47], v[248:251], v[60:63], v[44:47]
    ds_read_b128 v[236:239], v7 offset:3072
    s_waitcnt lgkmcnt(7)
    v_mfma_f32_16x16x32_bf16 v[16:19], v[188:191], v[64:67], v[16:19]
    v_mfma_f32_16x16x32_bf16 v[20:23], v[252:255], v[64:67], v[20:23]
    ds_read_b128 v[176:179], v7 offset:4096
    s_waitcnt lgkmcnt(6)
    v_mfma_f32_16x16x32_bf16 v[24:27], v[188:191], v[68:71], v[24:27]
    v_mfma_f32_16x16x32_bf16 v[28:31], v[252:255], v[68:71], v[28:31]
    ds_read_b128 v[240:243], v7 offset:5120
    s_waitcnt lgkmcnt(5)
    v_mfma_f32_16x16x32_bf16 v[32:35], v[188:191], v[72:75], v[32:35]
    v_mfma_f32_16x16x32_bf16 v[36:39], v[252:255], v[72:75], v[36:39]
    ds_read_b128 v[180:183], v7 offset:6144
    s_waitcnt lgkmcnt(4)
    v_mfma_f32_16x16x32_bf16 v[40:43], v[188:191], v[76:79], v[40:43]
    v_mfma_f32_16x16x32_bf16 v[44:47], v[252:255], v[76:79], v[44:47]
    ds_read_b128 v[244:247], v7 offset:7168
    s_setprio 1
    s_mul_i32 s34, s44, 28672
    s_add_u32 s34, s34, s31
    s_add_u32 s34, s34, 0x0
    v_and_b32 v120, 7, v0
    v_lshlrev_b32 v120, 2, v120
    s_lshl_b32 s21, s44, 5
    v_add_u32 v120, s21, v120
    v_pk_fma_f32 v[16:17], v[80:81], v[96:97], v[16:17] op_sel_hi:[0,1,1] neg_lo:[1,0,0] neg_hi:[1,0,0]
    v_pk_fma_f32 v[20:21], v[80:81], v[100:101], v[20:21] op_sel_hi:[0,1,1] neg_lo:[1,0,0] neg_hi:[1,0,0]
    v_pk_fma_f32 v[18:19], v[80:81], v[98:99], v[18:19] op_sel_hi:[0,1,1] neg_lo:[1,0,0] neg_hi:[1,0,0]
    v_pk_fma_f32 v[22:23], v[80:81], v[102:103], v[22:23] op_sel_hi:[0,1,1] neg_lo:[1,0,0] neg_hi:[1,0,0]
    v_pk_mul_f32 v[104:105], v[16:17], v[16:17]
    v_pk_mul_f32 v[108:109], v[20:21], v[20:21]
    v_pk_mul_f32 v[106:107], v[18:19], v[18:19]
    v_pk_mul_f32 v[110:111], v[22:23], v[22:23]
    v_pk_fma_f32 v[104:105], v[82:83], v[104:105], v[82:83] op_sel:[1,0,0] op_sel_hi:[1,1,0]
    v_pk_fma_f32 v[108:109], v[82:83], v[108:109], v[82:83] op_sel:[1,0,0] op_sel_hi:[1,1,0]
    v_pk_fma_f32 v[106:107], v[82:83], v[106:107], v[82:83] op_sel:[1,0,0] op_sel_hi:[1,1,0]
    v_pk_fma_f32 v[110:111], v[82:83], v[110:111], v[82:83] op_sel:[1,0,0] op_sel_hi:[1,1,0]
    v_pk_mul_f32 v[104:105], v[104:105], v[16:17]
    v_pk_mul_f32 v[108:109], v[108:109], v[20:21]
    v_pk_mul_f32 v[106:107], v[106:107], v[18:19]
    v_pk_mul_f32 v[110:111], v[110:111], v[22:23]
    v_exp_f32 v104, v104
    v_exp_f32 v108, v108
    v_exp_f32 v105, v105
    v_exp_f32 v109, v109
    v_exp_f32 v106, v106
    v_exp_f32 v110, v110
    v_exp_f32 v107, v107
    v_exp_f32 v111, v111
    v_pk_fma_f32 v[104:105], v[80:81], v[104:105], v[80:81] op_sel:[1,0,1] op_sel_hi:[1,1,1]
    v_pk_fma_f32 v[108:109], v[80:81], v[108:109], v[80:81] op_sel:[1,0,1] op_sel_hi:[1,1,1]
    v_pk_fma_f32 v[106:107], v[80:81], v[106:107], v[80:81] op_sel:[1,0,1] op_sel_hi:[1,1,1]
    v_pk_fma_f32 v[110:111], v[80:81], v[110:111], v[80:81] op_sel:[1,0,1] op_sel_hi:[1,1,1]
    v_rcp_f32 v104, v104
    v_rcp_f32 v108, v108
    v_rcp_f32 v105, v105
    v_rcp_f32 v109, v109
    v_rcp_f32 v106, v106
    v_rcp_f32 v110, v110
    v_rcp_f32 v107, v107
    v_rcp_f32 v111, v111
    v_pk_mul_f32 v[16:17], v[16:17], v[104:105]
    v_pk_mul_f32 v[20:21], v[20:21], v[108:109]
    v_pk_mul_f32 v[18:19], v[18:19], v[106:107]
    v_pk_mul_f32 v[22:23], v[22:23], v[110:111]
    v_cvt_pk_bf16_f32 v112, v16, v17
    v_cvt_pk_bf16_f32 v114, v20, v21
    v_cvt_pk_bf16_f32 v113, v18, v19
    v_cvt_pk_bf16_f32 v115, v22, v23
    s_cbranch_vccnz L_cs_70
    buffer_store_dwordx2 v[112:113], v126, s[4:7], s32 offen offset:0 nt
    buffer_store_dwordx2 v[114:115], v126, s[4:7], s33 offen offset:0 nt
L_ce_71:
    v_pk_fma_f32 v[24:25], v[84:85], v[96:97], v[24:25] op_sel_hi:[0,1,1] neg_lo:[1,0,0] neg_hi:[1,0,0]
    v_pk_fma_f32 v[28:29], v[84:85], v[100:101], v[28:29] op_sel_hi:[0,1,1] neg_lo:[1,0,0] neg_hi:[1,0,0]
    v_pk_fma_f32 v[26:27], v[84:85], v[98:99], v[26:27] op_sel_hi:[0,1,1] neg_lo:[1,0,0] neg_hi:[1,0,0]
    v_pk_fma_f32 v[30:31], v[84:85], v[102:103], v[30:31] op_sel_hi:[0,1,1] neg_lo:[1,0,0] neg_hi:[1,0,0]
    v_pk_mul_f32 v[104:105], v[24:25], v[24:25]
    v_pk_mul_f32 v[108:109], v[28:29], v[28:29]
    v_pk_mul_f32 v[106:107], v[26:27], v[26:27]
    v_pk_mul_f32 v[110:111], v[30:31], v[30:31]
    v_pk_fma_f32 v[104:105], v[86:87], v[104:105], v[86:87] op_sel:[1,0,0] op_sel_hi:[1,1,0]
    v_pk_fma_f32 v[108:109], v[86:87], v[108:109], v[86:87] op_sel:[1,0,0] op_sel_hi:[1,1,0]
    v_pk_fma_f32 v[106:107], v[86:87], v[106:107], v[86:87] op_sel:[1,0,0] op_sel_hi:[1,1,0]
    v_pk_fma_f32 v[110:111], v[86:87], v[110:111], v[86:87] op_sel:[1,0,0] op_sel_hi:[1,1,0]
    v_pk_mul_f32 v[104:105], v[104:105], v[24:25]
    v_pk_mul_f32 v[108:109], v[108:109], v[28:29]
    v_pk_mul_f32 v[106:107], v[106:107], v[26:27]
    v_pk_mul_f32 v[110:111], v[110:111], v[30:31]
    v_exp_f32 v104, v104
    v_exp_f32 v108, v108
    v_exp_f32 v105, v105
    v_exp_f32 v109, v109
    v_exp_f32 v106, v106
    v_exp_f32 v110, v110
    v_exp_f32 v107, v107
    v_exp_f32 v111, v111
    v_pk_fma_f32 v[104:105], v[84:85], v[104:105], v[84:85] op_sel:[1,0,1] op_sel_hi:[1,1,1]
    v_pk_fma_f32 v[108:109], v[84:85], v[108:109], v[84:85] op_sel:[1,0,1] op_sel_hi:[1,1,1]
    v_pk_fma_f32 v[106:107], v[84:85], v[106:107], v[84:85] op_sel:[1,0,1] op_sel_hi:[1,1,1]
    v_pk_fma_f32 v[110:111], v[84:85], v[110:111], v[84:85] op_sel:[1,0,1] op_sel_hi:[1,1,1]
    v_rcp_f32 v104, v104
    v_rcp_f32 v108, v108
    v_rcp_f32 v105, v105
    v_rcp_f32 v109, v109
    v_rcp_f32 v106, v106
    v_rcp_f32 v110, v110
    v_rcp_f32 v107, v107
    v_rcp_f32 v111, v111
    v_pk_mul_f32 v[24:25], v[24:25], v[104:105]
    v_pk_mul_f32 v[28:29], v[28:29], v[108:109]
    v_pk_mul_f32 v[26:27], v[26:27], v[106:107]
    v_pk_mul_f32 v[30:31], v[30:31], v[110:111]
    v_cvt_pk_bf16_f32 v116, v24, v25
    v_cvt_pk_bf16_f32 v118, v28, v29
    v_cvt_pk_bf16_f32 v117, v26, v27
    v_cvt_pk_bf16_f32 v119, v30, v31
    s_cbranch_vccnz L_cs_72
    buffer_store_dwordx2 v[116:117], v127, s[4:7], s32 offen offset:0 nt
    buffer_store_dwordx2 v[118:119], v127, s[4:7], s33 offen offset:0 nt
L_ce_73:
    s_setprio 0
    v_pk_fma_f32 v[32:33], v[88:89], v[96:97], v[32:33] op_sel_hi:[0,1,1] neg_lo:[1,0,0] neg_hi:[1,0,0]
    v_pk_fma_f32 v[36:37], v[88:89], v[100:101], v[36:37] op_sel_hi:[0,1,1] neg_lo:[1,0,0] neg_hi:[1,0,0]
    v_pk_fma_f32 v[34:35], v[88:89], v[98:99], v[34:35] op_sel_hi:[0,1,1] neg_lo:[1,0,0] neg_hi:[1,0,0]
    v_pk_fma_f32 v[38:39], v[88:89], v[102:103], v[38:39] op_sel_hi:[0,1,1] neg_lo:[1,0,0] neg_hi:[1,0,0]
    v_pk_mul_f32 v[104:105], v[32:33], v[32:33]
    v_pk_mul_f32 v[108:109], v[36:37], v[36:37]
    v_pk_mul_f32 v[106:107], v[34:35], v[34:35]
    v_pk_mul_f32 v[110:111], v[38:39], v[38:39]
    v_pk_fma_f32 v[104:105], v[90:91], v[104:105], v[90:91] op_sel:[1,0,0] op_sel_hi:[1,1,0]
    v_pk_fma_f32 v[108:109], v[90:91], v[108:109], v[90:91] op_sel:[1,0,0] op_sel_hi:[1,1,0]
    v_pk_fma_f32 v[106:107], v[90:91], v[106:107], v[90:91] op_sel:[1,0,0] op_sel_hi:[1,1,0]
    v_pk_fma_f32 v[110:111], v[90:91], v[110:111], v[90:91] op_sel:[1,0,0] op_sel_hi:[1,1,0]
    v_pk_mul_f32 v[104:105], v[104:105], v[32:33]
    v_pk_mul_f32 v[108:109], v[108:109], v[36:37]
    v_pk_mul_f32 v[106:107], v[106:107], v[34:35]
    v_pk_mul_f32 v[110:111], v[110:111], v[38:39]
    v_exp_f32 v104, v104
    v_exp_f32 v108, v108
    v_exp_f32 v105, v105
    v_exp_f32 v109, v109
    v_exp_f32 v106, v106
    v_exp_f32 v110, v110
    v_exp_f32 v107, v107
    v_exp_f32 v111, v111
    v_pk_fma_f32 v[104:105], v[88:89], v[104:105], v[88:89] op_sel:[1,0,1] op_sel_hi:[1,1,1]
    v_pk_fma_f32 v[108:109], v[88:89], v[108:109], v[88:89] op_sel:[1,0,1] op_sel_hi:[1,1,1]
    v_pk_fma_f32 v[106:107], v[88:89], v[106:107], v[88:89] op_sel:[1,0,1] op_sel_hi:[1,1,1]
    v_pk_fma_f32 v[110:111], v[88:89], v[110:111], v[88:89] op_sel:[1,0,1] op_sel_hi:[1,1,1]
    v_rcp_f32 v104, v104
    v_rcp_f32 v108, v108
    v_rcp_f32 v105, v105
    s_add_u32 s20, s30, 32768
    v_mov_b32 v6, 1
    s_waitcnt vmcnt(0)
    s_mov_b64 exec, 1
    s_cbranch_vccnz L_cs_74
    buffer_store_dword v6, v4, s[4:7], s20 offen
L_ce_75:
    s_mov_b64 exec, -1
    v_rcp_f32 v109, v109
    v_rcp_f32 v106, v106
    v_rcp_f32 v110, v110
    v_rcp_f32 v107, v107
    v_rcp_f32 v111, v111
    v_pk_mul_f32 v[32:33], v[32:33], v[104:105]
    v_pk_mul_f32 v[36:37], v[36:37], v[108:109]
    v_pk_mul_f32 v[34:35], v[34:35], v[106:107]
    v_pk_mul_f32 v[38:39], v[38:39], v[110:111]
    v_cvt_pk_bf16_f32 v112, v32, v33
    v_cvt_pk_bf16_f32 v114, v36, v37
    v_cvt_pk_bf16_f32 v113, v34, v35
    v_cvt_pk_bf16_f32 v115, v38, v39
    s_cbranch_vccnz L_cs_76
    buffer_store_dwordx2 v[112:113], v126, s[4:7], s32 offen offset:512 nt
    buffer_store_dwordx2 v[114:115], v126, s[4:7], s33 offen offset:512 nt
L_ce_77:
    v_pk_fma_f32 v[40:41], v[92:93], v[96:97], v[40:41] op_sel_hi:[0,1,1] neg_lo:[1,0,0] neg_hi:[1,0,0]
    v_pk_fma_f32 v[44:45], v[92:93], v[100:101], v[44:45] op_sel_hi:[0,1,1] neg_lo:[1,0,0] neg_hi:[1,0,0]
    v_pk_fma_f32 v[42:43], v[92:93], v[98:99], v[42:43] op_sel_hi:[0,1,1] neg_lo:[1,0,0] neg_hi:[1,0,0]
    v_pk_fma_f32 v[46:47], v[92:93], v[102:103], v[46:47] op_sel_hi:[0,1,1] neg_lo:[1,0,0] neg_hi:[1,0,0]
    v_pk_mul_f32 v[104:105], v[40:41], v[40:41]
    v_pk_mul_f32 v[108:109], v[44:45], v[44:45]
    v_pk_mul_f32 v[106:107], v[42:43], v[42:43]
    v_pk_mul_f32 v[110:111], v[46:47], v[46:47]
    v_pk_fma_f32 v[104:105], v[94:95], v[104:105], v[94:95] op_sel:[1,0,0] op_sel_hi:[1,1,0]
    v_pk_fma_f32 v[108:109], v[94:95], v[108:109], v[94:95] op_sel:[1,0,0] op_sel_hi:[1,1,0]
    v_pk_fma_f32 v[106:107], v[94:95], v[106:107], v[94:95] op_sel:[1,0,0] op_sel_hi:[1,1,0]
    v_pk_fma_f32 v[110:111], v[94:95], v[110:111], v[94:95] op_sel:[1,0,0] op_sel_hi:[1,1,0]
    v_pk_mul_f32 v[104:105], v[104:105], v[40:41]
    v_pk_mul_f32 v[108:109], v[108:109], v[44:45]
    v_pk_mul_f32 v[106:107], v[106:107], v[42:43]
    v_pk_mul_f32 v[110:111], v[110:111], v[46:47]
    v_exp_f32 v104, v104
    v_exp_f32 v108, v108
    v_exp_f32 v105, v105
    v_exp_f32 v109, v109
    v_exp_f32 v106, v106
    v_exp_f32 v110, v110
    v_exp_f32 v107, v107
    v_exp_f32 v111, v111
    v_pk_fma_f32 v[104:105], v[92:93], v[104:105], v[92:93] op_sel:[1,0,1] op_sel_hi:[1,1,1]
    v_pk_fma_f32 v[108:109], v[92:93], v[108:109], v[92:93] op_sel:[1,0,1] op_sel_hi:[1,1,1]
    v_pk_fma_f32 v[106:107], v[92:93], v[106:107], v[92:93] op_sel:[1,0,1] op_sel_hi:[1,1,1]
    v_pk_fma_f32 v[110:111], v[92:93], v[110:111], v[92:93] op_sel:[1,0,1] op_sel_hi:[1,1,1]
    v_rcp_f32 v104, v104
    v_rcp_f32 v108, v108
    v_rcp_f32 v105, v105
    v_rcp_f32 v109, v109
    v_rcp_f32 v106, v106
    v_rcp_f32 v110, v110
    v_rcp_f32 v107, v107
    v_rcp_f32 v111, v111
    v_pk_mul_f32 v[40:41], v[40:41], v[104:105]
    v_pk_mul_f32 v[44:45], v[44:45], v[108:109]
    v_pk_mul_f32 v[42:43], v[42:43], v[106:107]
    v_pk_mul_f32 v[46:47], v[46:47], v[110:111]
    v_cvt_pk_bf16_f32 v116, v40, v41
    v_cvt_pk_bf16_f32 v118, v44, v45
    v_cvt_pk_bf16_f32 v117, v42, v43
    v_cvt_pk_bf16_f32 v119, v46, v47
    s_cbranch_vccnz L_cs_78
    buffer_store_dwordx2 v[116:117], v127, s[4:7], s32 offen offset:512 nt
    buffer_store_dwordx2 v[118:119], v127, s[4:7], s33 offen offset:512 nt
L_ce_79:
    s_branch M_C_4
.p2align 12,,2552
M_C_4:
    s_add_u32 s20, s30, 32768
    s_mov_b32 s29, 0
    buffer_load_dword v121, v120, s[4:7], s20 offen sc1
    v_and_b32 v80, 15, v0
    v_lshrrev_b32 v81, 4, v0
    v_xor_b32 v82, v80, v81
    s_add_u32 s21, s3, 0
    s_and_b32 s21, s21, 3
    s_lshl_b32 s22, s21, 2
    v_xor_b32 v8, s22, v82
    v_lshlrev_b32 v8, 4, v8
    v_lshl_add_u32 v8, v81, 8, v8
    s_lshl_b32 s21, s21, 10
    s_lshl_b32 s22, s44, 12
    s_add_u32 s21, s21, s22
    v_add_u32 v8, s21, v8
    s_add_u32 s21, s3, 1
    s_and_b32 s21, s21, 3
    s_lshl_b32 s22, s21, 2
    v_xor_b32 v9, s22, v82
    v_lshlrev_b32 v9, 4, v9
    v_lshl_add_u32 v9, v81, 8, v9
    s_lshl_b32 s21, s21, 10
    s_lshl_b32 s22, s44, 12
    s_add_u32 s21, s21, s22
    v_add_u32 v9, s21, v9
    s_add_u32 s21, s3, 2
    s_and_b32 s21, s21, 3
    s_lshl_b32 s22, s21, 2
    v_xor_b32 v10, s22, v82
    v_lshlrev_b32 v10, 4, v10
    v_lshl_add_u32 v10, v81, 8, v10
    s_lshl_b32 s21, s21, 10
    s_lshl_b32 s22, s44, 12
    s_add_u32 s21, s21, s22
    v_add_u32 v10, s21, v10
    s_add_u32 s21, s3, 3
    s_and_b32 s21, s21, 3
    s_lshl_b32 s22, s21, 2
    v_xor_b32 v11, s22, v82
    v_lshlrev_b32 v11, 4, v11
    v_lshl_add_u32 v11, v81, 8, v11
    s_lshl_b32 s21, s21, 10
    s_lshl_b32 s22, s44, 12
    s_add_u32 s21, s21, s22
    v_add_u32 v11, s21, v11
    s_lshl_b32 s21, s3, 2
    v_add_u32 v81, s21, v81
    v_xor_b32 v12, v81, v80
    v_lshlrev_b32 v12, 4, v12
    v_lshl_add_u32 v12, v80, 8, v12
    v_lshlrev_b32 v13, 10, v81
    v_lshl_add_u32 v13, v80, 3, v13
    s_lshl_b32 s24, s16, 16
    s_lshl_b32 s21, s17, 7
    s_add_u32 s24, s24, s21
    s_waitcnt lgkmcnt(0)
    buffer_load_dword v122, v120, s[4:7], s20 offen sc1
    s_waitcnt vmcnt(1)
    v_cmp_ne_u32 vcc, 1, v121
    s_nop 1
    s_cbranch_vccz L_pdone_91
L_poll_90:
    buffer_load_dword v121, v120, s[4:7], s20 offen sc1
    s_waitcnt vmcnt(1)
    v_cmp_ne_u32 vcc, 1, v122
    s_nop 1
    s_cbranch_vccz L_pdone_91
    buffer_load_dword v122, v120, s[4:7], s20 offen sc1
    s_add_u32 s29, s29, 1
    s_cmp_gt_u32 s29, 262144
    s_cbranch_scc1 main_exit
    s_waitcnt vmcnt(1)
    v_cmp_ne_u32 vcc, 1, v121
    s_nop 1
    s_cbranch_vccnz L_poll_90
L_pdone_91:
    s_mov_b64 vcc, s[18:19]
    s_add_u32 s20, s30, 49152
    v_mov_b32 v6, 1
    s_waitcnt vmcnt(2)
    s_mov_b64 exec, 1
    s_cbranch_vccnz L_cs_92
    buffer_store_dword v6, v4, s[4:7], s20 offen
L_ce_93:
    s_mov_b64 exec, -1
    buffer_load_dwordx4 v[48:51], v2, s[4:7], s34 offen offset:0 sc1
    s_add_u32 s34, s34, 4096
    buffer_load_dwordx4 v[52:55], v2, s[4:7], s34 offen offset:0 sc1
    s_add_u32 s34, s34, 4096
    buffer_load_dwordx4 v[56:59], v2, s[4:7], s34 offen offset:0 sc1
    s_add_u32 s34, s34, 4096
    buffer_load_dwordx4 v[60:63], v2, s[4:7], s34 offen offset:0 sc1
    s_add_u32 s34, s34, 4096
    s_waitcnt vmcnt(3)
    v_mfma_f32_16x16x32_bf16 v[16:19], v[128:131], v[48:51], 0
    buffer_load_dwordx4 v[64:67], v2, s[4:7], s34 offen offset:0 sc1
    s_add_u32 s34, s34, 4096
    v_mfma_f32_16x16x32_bf16 v[20:23], v[192:195], v[48:51], 0
    v_mfma_f32_16x16x32_bf16 v[24:27], v[132:135], v[48:51], 0
    v_mfma_f32_16x16x32_bf16 v[28:31], v[196:199], v[48:51], 0
    s_waitcnt vmcnt(3)
    v_mfma_f32_16x16x32_bf16 v[16:19], v[136:139], v[52:55], v[16:19]
    buffer_load_dwordx4 v[68:71], v2, s[4:7], s34 offen offset:0 sc1
    s_add_u32 s34, s34, 4096
    v_mfma_f32_16x16x32_bf16 v[20:23], v[200:203], v[52:55], v[20:23]
    v_mfma_f32_16x16x32_bf16 v[24:27], v[140:143], v[52:55], v[24:27]
    v_mfma_f32_16x16x32_bf16 v[28:31], v[204:207], v[52:55], v[28:31]
    s_waitcnt vmcnt(3)
    v_mfma_f32_16x16x32_bf16 v[16:19], v[144:147], v[56:59], v[16:19]
    buffer_load_dwordx4 v[72:75], v2, s[4:7], s34 offen offset:0 sc1
    s_sub_u32 s34, s34, 24576
    v_mfma_f32_16x16x32_bf16 v[20:23], v[208:211], v[56:59], v[20:23]
    v_mfma_f32_16x16x32_bf16 v[24:27], v[148:151], v[56:59], v[24:27]
    v_mfma_f32_16x16x32_bf16 v[28:31], v[212:215], v[56:59], v[28:31]
    s_waitcnt vmcnt(3)
    v_mfma_f32_16x16x32_bf16 v[16:19], v[152:155], v[60:63], v[16:19]
    buffer_load_dwordx4 v[76:79], v2, s[4:7], s34 offen offset:256 sc1
    s_add_u32 s34, s34, 4096
    v_mfma_f32_16x16x32_bf16 v[20:23], v[216:219], v[60:63], v[20:23]
    v_mfma_f32_16x16x32_bf16 v[24:27], v[156:159], v[60:63], v[24:27]
    v_mfma_f32_16x16x32_bf16 v[28:31], v[220:223], v[60:63], v[28:31]
    s_waitcnt vmcnt(3)
    v_mfma_f32_16x16x32_bf16 v[16:19], v[160:163], v[64:67], v[16:19]
    buffer_load_dwordx4 v[48:51], v2, s[4:7], s34 offen offset:256 sc1
    s_add_u32 s34, s34, 4096
    v_mfma_f32_16x16x32_bf16 v[20:23], v[224:227], v[64:67], v[20:23]
    v_mfma_f32_16x16x32_bf16 v[24:27], v[164:167], v[64:67], v[24:27]
    v_mfma_f32_16x16x32_bf16 v[28:31], v[228:231], v[64:67], v[28:31]
    s_waitcnt vmcnt(3)
    v_mfma_f32_16x16x32_bf16 v[16:19], v[168:171], v[68:71], v[16:19]
    buffer_load_dwordx4 v[52:55], v2, s[4:7], s34 offen offset:256 sc1
    s_add_u32 s34, s34, 4096
    v_mfma_f32_16x16x32_bf16 v[20:23], v[232:235], v[68:71], v[20:23]
    buffer_load_dword v121, v120, s[4:7], s20 offen sc1
    v_mfma_f32_16x16x32_bf16 v[24:27], v[172:175], v[68:71], v[24:27]
    v_mfma_f32_16x16x32_bf16 v[28:31], v[236:239], v[68:71], v[28:31]
    s_waitcnt vmcnt(4)
    v_mfma_f32_16x16x32_bf16 v[16:19], v[176:179], v[72:75], v[16:19]
    buffer_load_dwordx4 v[56:59], v2, s[4:7], s34 offen offset:256 sc1
    s_add_u32 s34, s34, 4096
    v_mfma_f32_16x16x32_bf16 v[20:23], v[240:243], v[72:75], v[20:23]
    s_waitcnt lgkmcnt(0)
    s_barrier
    v_mfma_f32_16x16x32_bf16 v[24:27], v[180:183], v[72:75], v[24:27]
    v_mfma_f32_16x16x32_bf16 v[28:31], v[244:247], v[72:75], v[28:31]
    s_waitcnt vmcnt(4)
    v_mfma_f32_16x16x32_bf16 v[32:35], v[128:131], v[76:79], 0
    buffer_load_dwordx4 v[60:63], v2, s[4:7], s34 offen offset:256 sc1
    s_add_u32 s34, s34, 4096
    v_mfma_f32_16x16x32_bf16 v[36:39], v[192:195], v[76:79], 0
    v_mfma_f32_16x16x32_bf16 v[40:43], v[132:135], v[76:79], 0
    v_mfma_f32_16x16x32_bf16 v[44:47], v[196:199], v[76:79], 0
    s_waitcnt vmcnt(4)
    v_mfma_f32_16x16x32_bf16 v[32:35], v[136:139], v[48:51], v[32:35]
    buffer_load_dwordx4 v[64:67], v2, s[4:7], s34 offen offset:256 sc1
    s_add_u32 s34, s34, 4096
    v_mfma_f32_16x16x32_bf16 v[36:39], v[200:203], v[48:51], v[36:39]
    ds_write_b128 v8, v[16:19] offset:0
    ds_write_b128 v9, v[20:23] offset:0
    v_mfma_f32_16x16x32_bf16 v[40:43], v[140:143], v[48:51], v[40:43]
    ds_write_b128 v10, v[24:27] offset:0
    ds_write_b128 v11, v[28:31] offset:0
    v_mfma_f32_16x16x32_bf16 v[44:47], v[204:207], v[48:51], v[44:47]
    s_waitcnt vmcnt(4)
    v_mfma_f32_16x16x32_bf16 v[32:35], v[144:147], v[52:55], v[32:35]
    buffer_load_dwordx4 v[68:71], v2, s[4:7], s34 offen offset:256 sc1
    s_sub_u32 s34, s34, 24576
    v_mfma_f32_16x16x32_bf16 v[36:39], v[208:211], v[52:55], v[36:39]
    s_waitcnt vmcnt(4)
L_bchk_94:
    v_cmp_ne_u32 vcc, 1, v121
    s_nop 1
    s_cbranch_vccnz L_bre_95
    v_mfma_f32_16x16x32_bf16 v[40:43], v[148:151], v[52:55], v[40:43]
    v_mfma_f32_16x16x32_bf16 v[44:47], v[212:215], v[52:55], v[44:47]
    s_waitcnt vmcnt(3)
    v_mfma_f32_16x16x32_bf16 v[32:35], v[152:155], v[56:59], v[32:35]
    buffer_load_dwordx4 v[72:75], v2, s[4:7], s34 offen offset:512 sc1
    s_add_u32 s34, s34, 4096
    v_mfma_f32_16x16x32_bf16 v[36:39], v[216:219], v[56:59], v[36:39]
    v_mfma_f32_16x16x32_bf16 v[40:43], v[156:159], v[56:59], v[40:43]
    v_mfma_f32_16x16x32_bf16 v[44:47], v[220:223], v[56:59], v[44:47]
    s_waitcnt vmcnt(3)
    v_mfma_f32_16x16x32_bf16 v[32:35], v[160:163], v[60:63], v[32:35]
    buffer_load_dwordx4 v[76:79], v2, s[4:7], s34 offen offset:512 sc1
    s_add_u32 s34, s34, 4096
    v_mfma_f32_16x16x32_bf16 v[36:39], v[224:227], v[60:63], v[36:39]
    v_mfma_f32_16x16x32_bf16 v[40:43], v[164:167], v[60:63], v[40:43]
    v_mfma_f32_16x16x32_bf16 v[44:47], v[228:231], v[60:63], v[44:47]
    s_waitcnt vmcnt(3)
    v_mfma_f32_16x16x32_bf16 v[32:35], v[168:171], v[64:67], v[32:35]
    buffer_load_dwordx4 v[48:51], v2, s[4:7], s34 offen offset:512 sc1
    s_add_u32 s34, s34, 4096
    v_mfma_f32_16x16x32_bf16 v[36:39], v[232:235], v[64:67], v[36:39]
    v_mfma_f32_16x16x32_bf16 v[40:43], v[172:175], v[64:67], v[40:43]
    v_mfma_f32_16x16x32_bf16 v[44:47], v[236:239], v[64:67], v[44:47]
    s_waitcnt vmcnt(3)
    v_mfma_f32_16x16x32_bf16 v[32:35], v[176:179], v[68:71], v[32:35]
    buffer_load_dwordx4 v[52:55], v2, s[4:7], s34 offen offset:512 sc1
    s_add_u32 s34, s34, 4096
    v_mfma_f32_16x16x32_bf16 v[36:39], v[240:243], v[68:71], v[36:39]
    v_mfma_f32_16x16x32_bf16 v[40:43], v[180:183], v[68:71], v[40:43]
    v_mfma_f32_16x16x32_bf16 v[44:47], v[244:247], v[68:71], v[44:47]
    s_waitcnt vmcnt(3)
    v_mfma_f32_16x16x32_bf16 v[16:19], v[128:131], v[72:75], 0
    buffer_load_dwordx4 v[56:59], v2, s[4:7], s34 offen offset:512 sc1
    s_add_u32 s34, s34, 4096
    v_mfma_f32_16x16x32_bf16 v[20:23], v[192:195], v[72:75], 0
    v_mfma_f32_16x16x32_bf16 v[24:27], v[132:135], v[72:75], 0
    v_mfma_f32_16x16x32_bf16 v[28:31], v[196:199], v[72:75], 0
    s_waitcnt vmcnt(3)
    v_mfma_f32_16x16x32_bf16 v[16:19], v[136:139], v[76:79], v[16:19]
    buffer_load_dwordx4 v[60:63], v2, s[4:7], s34 offen offset:512 sc1
    s_add_u32 s34, s34, 4096
    v_mfma_f32_16x16x32_bf16 v[20:23], v[200:203], v[76:79], v[20:23]
    ds_write_b128 v8, v[32:35] offset:32768
    ds_write_b128 v9, v[36:39] offset:32768
    v_mfma_f32_16x16x32_bf16 v[24:27], v[140:143], v[76:79], v[24:27]
    ds_write_b128 v10, v[40:43] offset:32768
    ds_write_b128 v11, v[44:47] offset:32768
    v_mfma_f32_16x16x32_bf16 v[28:31], v[204:207], v[76:79], v[28:31]
    s_waitcnt vmcnt(3)
    v_mfma_f32_16x16x32_bf16 v[16:19], v[144:147], v[48:51], v[16:19]
    buffer_load_dwordx4 v[64:67], v2, s[4:7], s34 offen offset:512 sc1
    s_sub_u32 s34, s34, 24576
    v_mfma_f32_16x16x32_bf16 v[20:23], v[208:211], v[48:51], v[20:23]
    s_waitcnt lgkmcnt(0)
    s_barrier
    v_mfma_f32_16x16x32_bf16 v[24:27], v[148:151], v[48:51], v[24:27]
    v_mfma_f32_16x16x32_bf16 v[28:31], v[212:215], v[48:51], v[28:31]
    s_waitcnt vmcnt(3)
    v_mfma_f32_16x16x32_bf16 v[16:19], v[152:155], v[52:55], v[16:19]
    buffer_load_dwordx4 v[68:71], v2, s[4:7], s34 offen offset:768 sc1
    s_add_u32 s34, s34, 4096
    v_mfma_f32_16x16x32_bf16 v[20:23], v[216:219], v[52:55], v[20:23]
    ds_read_b128 v[80:83], v12 offset:0
    ds_read_b128 v[84:87], v12 offset:4096
    ds_read_b128 v[88:91], v12 offset:8192
    v_mfma_f32_16x16x32_bf16 v[24:27], v[156:159], v[52:55], v[24:27]
    ds_read_b128 v[92:95], v12 offset:12288
    ds_read_b128 v[96:99], v12 offset:16384
    ds_read_b128 v[100:103], v12 offset:20480
    v_mfma_f32_16x16x32_bf16 v[28:31], v[220:223], v[52:55], v[28:31]
    ds_read_b128 v[104:107], v12 offset:24576
    ds_read_b128 v[108:111], v12 offset:28672
    s_waitcnt vmcnt(3)
    v_mfma_f32_16x16x32_bf16 v[16:19], v[160:163], v[56:59], v[16:19]
    buffer_load_dwordx4 v[72:75], v2, s[4:7], s34 offen offset:768 sc1
    s_add_u32 s34, s34, 4096
    v_mfma_f32_16x16x32_bf16 v[20:23], v[224:227], v[56:59], v[20:23]
    s_waitcnt lgkmcnt(0)
    v_add_f32 v80, v80, v84
    v_add_f32 v81, v81, v85
    v_add_f32 v82, v82, v86
    v_mfma_f32_16x16x32_bf16 v[24:27], v[164:167], v[56:59], v[24:27]
    v_add_f32 v83, v83, v87
    v_add_f32 v88, v88, v92
    v_add_f32 v89, v89, v93
    v_add_f32 v90, v90, v94
    v_mfma_f32_16x16x32_bf16 v[28:31], v[228:231], v[56:59], v[28:31]
    v_add_f32 v91, v91, v95
    v_add_f32 v96, v96, v100
    v_add_f32 v97, v97, v101
    s_waitcnt vmcnt(3)
    v_mfma_f32_16x16x32_bf16 v[16:19], v[168:171], v[60:63], v[16:19]
    buffer_load_dwordx4 v[76:79], v2, s[4:7], s34 offen offset:768 sc1
    s_add_u32 s34, s34, 4096
    v_mfma_f32_16x16x32_bf16 v[20:23], v[232:235], v[60:63], v[20:23]
    v_add_f32 v98, v98, v102
    v_add_f32 v99, v99, v103
    v_add_f32 v104, v104, v108
    v_add_f32 v105, v105, v109
    v_mfma_f32_16x16x32_bf16 v[24:27], v[172:175], v[60:63], v[24:27]
    v_add_f32 v106, v106, v110
    v_add_f32 v107, v107, v111
    v_add_f32 v80, v80, v88
    v_add_f32 v81, v81, v89
    v_mfma_f32_16x16x32_bf16 v[28:31], v[236:239], v[60:63], v[28:31]
    v_add_f32 v82, v82, v90
    v_add_f32 v83, v83, v91
    v_add_f32 v96, v96, v104
    s_waitcnt vmcnt(3)
    v_mfma_f32_16x16x32_bf16 v[16:19], v[176:179], v[64:67], v[16:19]
    buffer_load_dwordx4 v[48:51], v2, s[4:7], s34 offen offset:768 sc1
    s_add_u32 s34, s34, 4096
    v_mfma_f32_16x16x32_bf16 v[20:23], v[240:243], v[64:67], v[20:23]
    v_add_f32 v97, v97, v105
    v_add_f32 v98, v98, v106
    v_add_f32 v99, v99, v107
    v_add_f32 v80, v80, v96
    v_mfma_f32_16x16x32_bf16 v[24:27], v[180:183], v[64:67], v[24:27]
    v_add_f32 v81, v81, v97
    v_add_f32 v82, v82, v98
    v_add_f32 v83, v83, v99
    v_cvt_pk_bf16_f32 v84, v80, v81
    v_mfma_f32_16x16x32_bf16 v[28:31], v[244:247], v[64:67], v[28:31]
    v_cvt_pk_bf16_f32 v85, v82, v83
    buffer_store_dwordx2 v[84:85], v13, s[12:15], s24 offen nt
    s_add_u32 s24, s24, 32768
    s_waitcnt vmcnt(4)
    v_mfma_f32_16x16x32_bf16 v[32:35], v[128:131], v[68:71], 0
    buffer_load_dwordx4 v[52:55], v2, s[4:7], s34 offen offset:768 sc1
    s_add_u32 s34, s34, 4096
    v_mfma_f32_16x16x32_bf16 v[36:39], v[192:195], v[68:71], 0
    v_mfma_f32_16x16x32_bf16 v[40:43], v[132:135], v[68:71], 0
    v_mfma_f32_16x16x32_bf16 v[44:47], v[196:199], v[68:71], 0
    s_waitcnt vmcnt(4)
    v_mfma_f32_16x16x32_bf16 v[32:35], v[136:139], v[72:75], v[32:35]
    buffer_load_dwordx4 v[56:59], v2, s[4:7], s34 offen offset:768 sc1
    s_add_u32 s34, s34, 4096
    v_mfma_f32_16x16x32_bf16 v[36:39], v[200:203], v[72:75], v[36:39]
    v_add_u32 v8, 0x10000, v8
    ds_write_b128 v8, v[16:19] offset:0
    v_add_u32 v9, 0x10000, v9
    v_mfma_f32_16x16x32_bf16 v[40:43], v[140:143], v[72:75], v[40:43]
    ds_write_b128 v9, v[20:23] offset:0
    v_add_u32 v10, 0x10000, v10
    ds_write_b128 v10, v[24:27] offset:0
    v_mfma_f32_16x16x32_bf16 v[44:47], v[204:207], v[72:75], v[44:47]
    v_add_u32 v11, 0x10000, v11
    ds_write_b128 v11, v[28:31] offset:0
    s_waitcnt vmcnt(4)
    v_mfma_f32_16x16x32_bf16 v[32:35], v[144:147], v[76:79], v[32:35]
    buffer_load_dwordx4 v[60:63], v2, s[4:7], s34 offen offset:768 sc1
    s_sub_u32 s34, s34, 24576
    v_mfma_f32_16x16x32_bf16 v[36:39], v[208:211], v[76:79], v[36:39]
    v_mfma_f32_16x16x32_bf16 v[40:43], v[148:151], v[76:79], v[40:43]
    v_mfma_f32_16x16x32_bf16 v[44:47], v[212:215], v[76:79], v[44:47]
    s_waitcnt vmcnt(4)
    v_mfma_f32_16x16x32_bf16 v[32:35], v[152:155], v[48:51], v[32:35]
    v_mfma_f32_16x16x32_bf16 v[36:39], v[216:219], v[48:51], v[36:39]
    v_mfma_f32_16x16x32_bf16 v[40:43], v[156:159], v[48:51], v[40:43]
    v_mfma_f32_16x16x32_bf16 v[44:47], v[220:223], v[48:51], v[44:47]
    s_waitcnt vmcnt(2)
    v_mfma_f32_16x16x32_bf16 v[32:35], v[160:163], v[52:55], v[32:35]
    v_mfma_f32_16x16x32_bf16 v[36:39], v[224:227], v[52:55], v[36:39]
    v_mfma_f32_16x16x32_bf16 v[40:43], v[164:167], v[52:55], v[40:43]
    v_mfma_f32_16x16x32_bf16 v[44:47], v[228:231], v[52:55], v[44:47]
    s_waitcnt vmcnt(1)
    v_mfma_f32_16x16x32_bf16 v[32:35], v[168:171], v[56:59], v[32:35]
    v_mfma_f32_16x16x32_bf16 v[36:39], v[232:235], v[56:59], v[36:39]
    v_mfma_f32_16x16x32_bf16 v[40:43], v[172:175], v[56:59], v[40:43]
    v_mfma_f32_16x16x32_bf16 v[44:47], v[236:239], v[56:59], v[44:47]
    s_waitcnt vmcnt(0)
    v_mfma_f32_16x16x32_bf16 v[32:35], v[176:179], v[60:63], v[32:35]
    v_mfma_f32_16x16x32_bf16 v[36:39], v[240:243], v[60:63], v[36:39]
    v_mfma_f32_16x16x32_bf16 v[40:43], v[180:183], v[60:63], v[40:43]
    v_mfma_f32_16x16x32_bf16 v[44:47], v[244:247], v[60:63], v[44:47]
    s_nop 4
    ds_write_b128 v8, v[32:35] offset:32768
    ds_write_b128 v9, v[36:39] offset:32768
    ds_write_b128 v10, v[40:43] offset:32768
    ds_write_b128 v11, v[44:47] offset:32768
    s_waitcnt lgkmcnt(0)
    s_barrier
    v_add_u32 v12, 0x10000, v12
    ds_read_b128 v[80:83], v12 offset:0
    ds_read_b128 v[84:87], v12 offset:4096
    ds_read_b128 v[88:91], v12 offset:8192
    ds_read_b128 v[92:95], v12 offset:12288
    ds_read_b128 v[96:99], v12 offset:16384
    ds_read_b128 v[100:103], v12 offset:20480
    ds_read_b128 v[104:107], v12 offset:24576
    ds_read_b128 v[108:111], v12 offset:28672
    s_waitcnt lgkmcnt(0)
    v_pk_add_f32 v[80:81], v[80:81], v[84:85]
    v_pk_add_f32 v[82:83], v[82:83], v[86:87]
    v_pk_add_f32 v[88:89], v[88:89], v[92:93]
    v_pk_add_f32 v[90:91], v[90:91], v[94:95]
    v_pk_add_f32 v[96:97], v[96:97], v[100:101]
    v_pk_add_f32 v[98:99], v[98:99], v[102:103]
    v_pk_add_f32 v[104:105], v[104:105], v[108:109]
    v_pk_add_f32 v[106:107], v[106:107], v[110:111]
    v_pk_add_f32 v[80:81], v[80:81], v[88:89]
    v_pk_add_f32 v[82:83], v[82:83], v[90:91]
    v_pk_add_f32 v[96:97], v[96:97], v[104:105]
    v_pk_add_f32 v[98:99], v[98:99], v[106:107]
    v_pk_add_f32 v[80:81], v[80:81], v[96:97]
    v_pk_add_f32 v[82:83], v[82:83], v[98:99]
    v_cvt_pk_bf16_f32 v84, v80, v81
    v_cvt_pk_bf16_f32 v85, v82, v83
    buffer_store_dwordx2 v[84:85], v13, s[12:15], s24 offen nt
    s_add_u32 s24, s24, 32768
M_C_5:
main_exit:
    s_endpgm
attn_redo:
    v_and_b32 v15, 0x3ff, v15
    v_mov_b32 v6, 0xff800000
    s_mov_b32 s22, 0x1980000
L_fb1_102:
    buffer_load_dwordx4 v[104:107], v1, s[4:7], s22 offen sc1
    s_add_u32 s22, s22, 2048
    s_waitcnt vmcnt(0)
    v_mfma_f32_32x32x16_bf16 v[24:39], v[104:107], v[16:19], 0
    s_nop 11
    v_max3_f32 v6, v6, v24, v25
    v_max3_f32 v6, v6, v26, v27
    v_max3_f32 v6, v6, v28, v29
    v_max3_f32 v6, v6, v30, v31
    v_max3_f32 v6, v6, v32, v33
    v_max3_f32 v6, v6, v34, v35
    v_max3_f32 v6, v6, v36, v37
    v_max3_f32 v6, v6, v38, v39
    s_cmp_lt_u32 s22, 0x19a0000
    s_cbranch_scc1 L_fb1_102
    v_mov_b32 v7, v6
    s_nop 1
    v_permlane32_swap_b32 v6, v7
    v_max_f32 v6, v6, v7
    v_sub_f32 v6, 0, v6
    v_mov_b32 v56, v6
    v_mov_b32 v57, v6
    v_mov_b32 v58, v6
    v_mov_b32 v59, v6
    v_mov_b32 v60, v6
    v_mov_b32 v61, v6
    v_mov_b32 v62, v6
    v_mov_b32 v63, v6
    v_mov_b32 v64, v6
    v_mov_b32 v65, v6
    v_mov_b32 v66, v6
    v_mov_b32 v67, v6
    v_mov_b32 v68, v6
    v_mov_b32 v69, v6
    v_mov_b32 v70, v6
    v_mov_b32 v71, v6
    v_mov_b32 v72, 0
    v_mov_b32 v73, 0
    v_mov_b32 v74, 0
    v_mov_b32 v75, 0
    v_mov_b32 v76, 0
    v_mov_b32 v77, 0
    v_mov_b32 v78, 0
    v_mov_b32 v79, 0
    v_mov_b32 v80, 0
    v_mov_b32 v81, 0
    v_mov_b32 v82, 0
    v_mov_b32 v83, 0
    v_mov_b32 v84, 0
    v_mov_b32 v85, 0
    v_mov_b32 v86, 0
    v_mov_b32 v87, 0
    s_mov_b32 s22, 0x1980000
L_fb2_103:
    buffer_load_dwordx4 v[104:107], v1, s[4:7], s22 offen sc1
    s_mov_b64 exec, s[40:41]
    buffer_load_dwordx4 v[108:111], v15, s[4:7], s22 offen offset:1024 sc1
    buffer_load_dwordx4 v[112:115], v15, s[4:7], s22 offen offset:1536 sc1
    s_mov_b64 exec, -1
    s_add_u32 s22, s22, 2048
    s_waitcnt vmcnt(0)
    v_mfma_f32_32x32x16_bf16 v[24:39], v[104:107], v[16:19], v[56:71]
    s_nop 11
    v_exp_f32 v24, v24
    v_exp_f32 v25, v25
    v_exp_f32 v26, v26
    v_exp_f32 v27, v27
    v_exp_f32 v28, v28
    v_exp_f32 v29, v29
    v_exp_f32 v30, v30
    v_exp_f32 v31, v31
    v_exp_f32 v32, v32
    v_exp_f32 v33, v33
    v_exp_f32 v34, v34
    v_exp_f32 v35, v35
    v_exp_f32 v36, v36
    v_exp_f32 v37, v37
    v_exp_f32 v38, v38
    v_exp_f32 v39, v39
    v_smfmac_f32_32x32x32_bf16 v[72:87], v[108:111], v[24:31], v13
    s_nop 0
    v_smfmac_f32_32x32x32_bf16 v[72:87], v[112:115], v[32:39], v13
    s_nop 15
    s_cmp_lt_u32 s22, 0x19a0000
    s_cbranch_scc1 L_fb2_103
    v_mov_b32 v6, 0xff800000
    s_mov_b32 s22, 0x1980000
L_fb1_104:
    buffer_load_dwordx4 v[104:107], v1, s[4:7], s22 offen sc1
    s_add_u32 s22, s22, 2048
    s_waitcnt vmcnt(0)
    v_mfma_f32_32x32x16_bf16 v[24:39], v[104:107], v[20:23], 0
    s_nop 11
    v_max3_f32 v6, v6, v24, v25
    v_max3_f32 v6, v6, v26, v27
    v_max3_f32 v6, v6, v28, v29
    v_max3_f32 v6, v6, v30, v31
    v_max3_f32 v6, v6, v32, v33
    v_max3_f32 v6, v6, v34, v35
    v_max3_f32 v6, v6, v36, v37
    v_max3_f32 v6, v6, v38, v39
    s_cmp_lt_u32 s22, 0x19a0000
    s_cbranch_scc1 L_fb1_104
    v_mov_b32 v7, v6
    s_nop 1
    v_permlane32_swap_b32 v6, v7
    v_max_f32 v6, v6, v7
    v_sub_f32 v6, 0, v6
    v_mov_b32 v56, v6
    v_mov_b32 v57, v6
    v_mov_b32 v58, v6
    v_mov_b32 v59, v6
    v_mov_b32 v60, v6
    v_mov_b32 v61, v6
    v_mov_b32 v62, v6
    v_mov_b32 v63, v6
    v_mov_b32 v64, v6
    v_mov_b32 v65, v6
    v_mov_b32 v66, v6
    v_mov_b32 v67, v6
    v_mov_b32 v68, v6
    v_mov_b32 v69, v6
    v_mov_b32 v70, v6
    v_mov_b32 v71, v6
    v_mov_b32 v88, 0
    v_mov_b32 v89, 0
    v_mov_b32 v90, 0
    v_mov_b32 v91, 0
    v_mov_b32 v92, 0
    v_mov_b32 v93, 0
    v_mov_b32 v94, 0
    v_mov_b32 v95, 0
    v_mov_b32 v96, 0
    v_mov_b32 v97, 0
    v_mov_b32 v98, 0
    v_mov_b32 v99, 0
    v_mov_b32 v100, 0
    v_mov_b32 v101, 0
    v_mov_b32 v102, 0
    v_mov_b32 v103, 0
    s_mov_b32 s22, 0x1980000
L_fb2_105:
    buffer_load_dwordx4 v[104:107], v1, s[4:7], s22 offen sc1
    s_mov_b64 exec, s[40:41]
    buffer_load_dwordx4 v[108:111], v15, s[4:7], s22 offen offset:1024 sc1
    buffer_load_dwordx4 v[112:115], v15, s[4:7], s22 offen offset:1536 sc1
    s_mov_b64 exec, -1
    s_add_u32 s22, s22, 2048
    s_waitcnt vmcnt(0)
    v_mfma_f32_32x32x16_bf16 v[24:39], v[104:107], v[20:23], v[56:71]
    s_nop 11
    v_exp_f32 v24, v24
    v_exp_f32 v25, v25
    v_exp_f32 v26, v26
    v_exp_f32 v27, v27
    v_exp_f32 v28, v28
    v_exp_f32 v29, v29
    v_exp_f32 v30, v30
    v_exp_f32 v31, v31
    v_exp_f32 v32, v32
    v_exp_f32 v33, v33
    v_exp_f32 v34, v34
    v_exp_f32 v35, v35
    v_exp_f32 v36, v36
    v_exp_f32 v37, v37
    v_exp_f32 v38, v38
    v_exp_f32 v39, v39
    v_smfmac_f32_32x32x32_bf16 v[88:103], v[108:111], v[24:31], v13
    s_nop 0
    v_smfmac_f32_32x32x32_bf16 v[88:103], v[112:115], v[32:39], v13
    s_nop 15
    s_cmp_lt_u32 s22, 0x19a0000
    s_cbranch_scc1 L_fb2_105
    s_nop 15
    s_branch attn_done
L_cs_16:
    buffer_store_dwordx4 v[72:75], v10, s[4:7], s21 offen sc1
    buffer_store_dwordx4 v[88:91], v10, s[4:7], s21 offen offset:512 sc1
    s_branch L_ce_17
L_cs_18:
    buffer_store_dword v6, v4, s[4:7], s20 offen sc1
    s_branch L_ce_19
L_cs_41:
    buffer_store_dwordx2 v[104:105], v7, s[4:7], s22 offen sc1
    s_branch L_ce_42
L_sre_44:
    s_add_u32 s29, s29, 1
    s_cmp_gt_u32 s29, 262144
    s_cbranch_scc1 L_sok_45
    buffer_load_dwordx4 v[80:83], v7, s[4:7], s21 offen sc1
    s_waitcnt vmcnt(0)
    s_branch L_schk_43
L_hre_57:
    s_add_u32 s29, s29, 1
    s_cmp_gt_u32 s29, 262144
    s_cbranch_scc1 L_hok_58
    buffer_load_dwordx4 v[104:107], v8, s[4:7], s21 offen sc1
    s_waitcnt vmcnt(0)
    s_branch L_hchk_56
L_cs_65:
    buffer_store_dwordx2 v[104:105], v7, s[4:7], s22 offen sc1
    s_branch L_ce_66
L_sre_68:
    s_add_u32 s29, s29, 1
    s_cmp_gt_u32 s29, 262144
    s_cbranch_scc1 L_sok_69
    buffer_load_dwordx4 v[80:83], v7, s[4:7], s21 offen sc1
    s_waitcnt vmcnt(0)
    s_branch L_schk_67
L_cs_70:
    buffer_store_dwordx2 v[112:113], v126, s[4:7], s32 offen offset:0 sc1
    buffer_store_dwordx2 v[114:115], v126, s[4:7], s33 offen offset:0 sc1
    s_branch L_ce_71
L_cs_72:
    buffer_store_dwordx2 v[116:117], v127, s[4:7], s32 offen offset:0 sc1
    buffer_store_dwordx2 v[118:119], v127, s[4:7], s33 offen offset:0 sc1
    s_branch L_ce_73
L_cs_74:
    buffer_store_dword v6, v4, s[4:7], s20 offen sc1
    s_branch L_ce_75
L_cs_76:
    buffer_store_dwordx2 v[112:113], v126, s[4:7], s32 offen offset:512 sc1
    buffer_store_dwordx2 v[114:115], v126, s[4:7], s33 offen offset:512 sc1
    s_branch L_ce_77
L_cs_78:
    buffer_store_dwordx2 v[116:117], v127, s[4:7], s32 offen offset:512 sc1
    buffer_store_dwordx2 v[118:119], v127, s[4:7], s33 offen offset:512 sc1
    s_branch L_ce_79
L_cs_92:
    buffer_store_dword v6, v4, s[4:7], s20 offen sc1
    s_branch L_ce_93
L_bre_95:
    s_add_u32 s29, s29, 1
    s_cmp_gt_u32 s29, 262144
    s_cbranch_scc1 main_exit
    buffer_load_dword v121, v120, s[4:7], s20 offen sc1
    s_waitcnt vmcnt(0)
    s_branch L_bchk_94
main_end:

.section .rodata,"a"
.p2align 6
.amdhsa_kernel sequential_preLN__grouped_kv_mqa__mixer_s_mlp__prompt_kernel
  .amdhsa_next_free_vgpr 256
  .amdhsa_next_free_sgpr 102
  .amdhsa_accum_offset 256
  .amdhsa_group_segment_fixed_size 0
  .amdhsa_kernarg_size 104
  .amdhsa_user_sgpr_count 2
  .amdhsa_user_sgpr_kernarg_segment_ptr 1
  .amdhsa_system_sgpr_workgroup_id_x 1
.end_amdhsa_kernel
```
